```python
import torch

def _softmax(x, axis=-1):
    return torch.softmax(x, dim=axis)
def _gelu(x):
    return torch.nn.functional.gelu(x, approximate="tanh")
def _silu(x):
    return torch.nn.functional.silu(x)
def _sigmoid(x):
    return torch.sigmoid(x)
def _layernorm(x, axis=-1, eps=1e-5):
    m = x.mean(dim=axis, keepdim=True)
    v = x.var(dim=axis, keepdim=True, unbiased=False)
    return (x - m) / torch.sqrt(v + eps)
def _scatter_add(tgt, idx, src, axis=0):
    return tgt.clone().index_add_(axis, idx, src)
def _segment_sum(src, seg, n):
    out = torch.zeros((n,) + src.shape[1:], dtype=src.dtype)
    return out.index_add_(0, seg, src)
def _pad(x, pw):
    flat = tuple(v for pair in reversed(pw) for v in pair)
    return torch.nn.functional.pad(x, flat)

kernel_name = 'concat_heads__mha_block_cached__gqa_block_cached__near_ridge'

def setup_inputs():

    _w = (lambda a: (lambda t: t.to(torch.bfloat16) if t.is_floating_point() else t)(torch.as_tensor(a)))
    def _A_setup():
        B, Sq, D = 8, 208, 512
        H, Sk, Dh = 32, 512, 128
        return {
            "x": _w((lambda *s: torch.randn(*s, dtype=torch.bfloat16) * 0.8)(B, Sq, D)),
            "k_cache": _w((lambda *s: torch.randn(*s, dtype=torch.bfloat16) * 0.8)(B, H, Sk, Dh)),
            "v_cache": _w((lambda *s: torch.randn(*s, dtype=torch.bfloat16) * 0.05)(B, H, Sk, Dh)),
            "wq": _w((lambda *s: torch.randn(*s, dtype=torch.bfloat16) * 0.8)(D, H * Dh) * (D ** -0.5)),
            "wo": _w((lambda *s: torch.randn(*s, dtype=torch.bfloat16) * 0.05)(H * Dh, D) * ((H * Dh) ** -0.5)),
        }
    _A_in = _A_setup()

    def _B_setup():
        B, Sq, D = 8, 208, 512
        Hq, Hkv, Sk, Dh = 32, 32, 512, 128
        assert Hq % Hkv == 0, (Hq, Hkv)
        return {
            "x": _w((lambda *s: torch.randn(*s, dtype=torch.bfloat16) * 0.8)(B, Sq, D)),
            "k_cache": _w((lambda *s: torch.randn(*s, dtype=torch.bfloat16) * 0.8)(B, Hkv, Sk, Dh)),
            "v_cache": _w((lambda *s: torch.randn(*s, dtype=torch.bfloat16) * 0.05)(B, Hkv, Sk, Dh)),
            "wq": _w((lambda *s: torch.randn(*s, dtype=torch.bfloat16) * 0.8)(D, Hq * Dh) * (D ** -0.5)),
            "wo": _w((lambda *s: torch.randn(*s, dtype=torch.bfloat16) * 0.05)(Hq * Dh, D) * ((Hq * Dh) ** -0.5)),
        }
    _B_in = _B_setup()

    return {
        "A_x": _A_in["x"],
        "A_k_cache": _A_in["k_cache"],
        "A_v_cache": _A_in["v_cache"],
        "A_wq": _A_in["wq"],
        "A_wo": _A_in["wo"],
        "B_x": _B_in["x"],
        "B_k_cache": _B_in["k_cache"],
        "B_v_cache": _B_in["v_cache"],
        "B_wq": _B_in["wq"],
        "B_wo": _B_in["wo"],
    }

def reference(A_x, A_k_cache, A_v_cache, A_wq, A_wo, B_x, B_k_cache, B_v_cache, B_wq, B_wo):
    def _A_ref(x, k_cache, v_cache, wq, wo):
        B, Sq, D = x.shape
        H, Dh = 32, 128
        q = (lambda x, *d: x.permute(*d))((x @ wq).reshape(B, Sq, H, Dh), 0, 2, 1, 3)
        scores = torch.einsum("bhqd,bhkd->bhqk", q, k_cache) * (Dh ** -0.5)
        p = _softmax(scores, axis=-1)
        o = torch.einsum("bhqk,bhkd->bhqd", p, v_cache)
        return (lambda x, *d: x.permute(*d))(o, 0, 2, 1, 3).reshape(B, Sq, H * Dh) @ wo

    def _B_ref(x, k_cache, v_cache, wq, wo):
        B, Sq, D = x.shape
        Hq, Dh = 32, 128
        Hkv = k_cache.shape[1]
        rep = Hq // Hkv
        q = (lambda x, *d: x.permute(*d))((x @ wq).reshape(B, Sq, Hq, Dh), 0, 2, 1, 3)
        k = (lambda x, n, axis: torch.repeat_interleave(x, n, dim=axis))(k_cache, rep, axis=1)
        v = (lambda x, n, axis: torch.repeat_interleave(x, n, dim=axis))(v_cache, rep, axis=1)
        scores = torch.einsum("bhqd,bhkd->bhqk", q, k) * (Dh ** -0.5)
        p = _softmax(scores, axis=-1)
        o = torch.einsum("bhqk,bhkd->bhqd", p, v)
        return (lambda x, *d: x.permute(*d))(o, 0, 2, 1, 3).reshape(B, Sq, Hq * Dh) @ wo

    a = _A_ref(A_x, A_k_cache, A_v_cache, A_wq, A_wo)
    b = _B_ref(B_x, B_k_cache, B_v_cache, B_wq, B_wo)
    return torch.concatenate([a, b], axis=-1)
```

```asm
; @launch kernel=attn_kernel grid=(512,1,1) block=(256,1,1) lds=81920
; @launch kernel=oproj_kernel grid=(256,1,1) block=(256,1,1) lds=114688
.amdgcn_target "amdgcn-amd-amdhsa--gfx950"
.text
.globl attn_kernel
.p2align 8
.type attn_kernel,@function
attn_kernel:
    s_cmp_ge_u32 s2, 512
    s_cbranch_scc1 L_attn_end
    s_load_dwordx16 s[16:31], s[0:1], 0
    s_load_dwordx8 s[32:39], s[0:1], 64
    s_load_dwordx2 s[40:41], s[0:1], 96
    s_and_b32 s87, s2, 7
    s_lshr_b32 s88, s2, 3
    s_lshr_b32 s68, s87, 2
    s_and_b32 s87, s87, 3
    s_lshl_b32 s87, s87, 3
    s_and_b32 s70, s88, 7
    s_add_u32 s70, s70, s87
    s_lshr_b32 s69, s88, 3
    v_lshrrev_b32 v16, 6, v0
    s_nop 0
    v_readfirstlane_b32 s71, v16
    v_and_b32 v12, 63, v0
    v_lshrrev_b32 v13, 4, v12
    v_bfe_u32 v14, v12, 2, 2
    v_and_b32 v15, 3, v12
    v_lshlrev_b32 v1, 4, v12
    v_mov_b32 v35, v13
    v_and_b32 v16, 15, v12
    v_lshlrev_b32 v17, 1, v13
    v_xor_b32 v16, v16, v17
    v_lshlrev_b32 v16, 4, v16
    v_lshl_add_u32 v2, v13, 8, v16
    v_lshl_add_u32 v3, v13, 13, v16
    v_lshl_add_u32 v25, v13, 10, v16
    v_sub_u32 v16, 0, v13
    v_and_b32 v16, 3, v16
    v_xor_b32 v16, v16, v15
    v_lshlrev_b32 v16, 4, v16
    v_lshrrev_b32 v17, 2, v12
    v_lshl_add_u32 v76, v17, 10, v16
    v_sub_u32 v16, 0, v14
    v_and_b32 v16, 3, v16
    v_xor_b32 v16, v16, v13
    v_lshlrev_b32 v16, 4, v16
    v_and_b32 v17, 15, v12
    v_lshl_add_u32 v16, v17, 6, v16
    v_add_u32 v78, 20992, v16
    s_mul_i32 s87, s71, 3072
    s_add_u32 s87, s87, 8704
    v_add_u32 v77, s87, v16
    v_mul_u32_u24 v16, 1152, v14
    v_lshl_add_u32 v16, v15, 8, v16
    v_and_b32 v17, 1, v13
    v_lshl_add_u32 v16, v17, 4, v16
    v_add_u32 v16, 36864, v16
    v_lshrrev_b32 v17, 1, v13
    v_add_u32 v18, 0, v17
    v_xor_b32 v18, v18, v15
    v_lshl_add_u32 v4, v18, 5, v16
    v_add_u32 v18, 2, v17
    v_xor_b32 v18, v18, v15
    v_lshl_add_u32 v5, v18, 5, v16
    v_mul_u32_u24 v16, 2176, v13
    v_lshl_add_u32 v16, v14, 8, v16
    v_lshl_add_u32 v16, v15, 3, v16
    v_xor_b32 v18, 0, v14
    v_lshl_add_u32 v6, v18, 5, v16
    v_xor_b32 v18, 1, v14
    v_lshl_add_u32 v7, v18, 5, v16
    v_xor_b32 v18, 2, v14
    v_lshl_add_u32 v8, v18, 5, v16
    v_xor_b32 v18, 3, v14
    v_lshl_add_u32 v9, v18, 5, v16
    s_and_b32 s87, s71, 1
    s_lshl_b32 s87, s87, 1
    s_lshr_b32 s88, s71, 1
    s_lshl_b32 s88, s88, 7
    s_add_u32 s89, s87, 0
    v_xor_b32 v18, s89, v14
    v_lshl_add_u32 v10, v18, 5, v16
    v_add_u32 v10, s88, v10
    s_add_u32 s89, s87, 1
    v_xor_b32 v18, s89, v14
    v_lshl_add_u32 v11, v18, 5, v16
    v_add_u32 v11, s88, v11
    v_lshlrev_b32 v16, 10, v13
    v_lshl_add_u32 v16, v14, 8, v16
    v_lshl_add_u32 v16, v15, 3, v16
    v_add_u32 v16, 73728, v16
    s_add_u32 s89, s87, 0
    v_xor_b32 v18, s89, v14
    v_lshl_add_u32 v26, v18, 5, v16
    v_add_u32 v26, s88, v26
    s_add_u32 s89, s87, 1
    v_xor_b32 v18, s89, v14
    v_lshl_add_u32 v27, v18, 5, v16
    v_add_u32 v27, s88, v27
    v_and_b32 v16, 255, v0
    v_lshrrev_b32 v17, 3, v16
    v_and_b32 v18, 7, v16
    v_lshlrev_b32 v18, 7, v18
    v_lshl_add_u32 v20, v17, 10, v18
    v_lshrrev_b32 v17, 1, v16
    v_and_b32 v18, 1, v16
    v_lshlrev_b32 v18, 7, v18
    v_lshl_add_u32 v21, v17, 13, v18
    v_and_b32 v18, 127, v0
    v_lshlrev_b32 v79, 7, v18
    s_mul_i32 s76, s71, 2176
    s_lshl_b32 s77, s71, 16
    s_mul_i32 s93, s71, 3072
    s_lshl_b32 s87, s71, 4
    s_lshl_b64 s[94:95], 0xffff, s87
    s_mul_i32 s78, s71, 4608
    s_lshl_b32 s79, s71, 12
    s_mul_i32 s87, s71, 49152
    s_add_u32 s72, s87, 0
    s_add_u32 s73, s87, 16384
    s_add_u32 s74, s87, 32768
    s_mov_b32 s75, 196608
    s_mov_b32 s82, 0x3e0293ee
    s_mov_b32 s83, 0x4e800000
    s_waitcnt lgkmcnt(0)
    s_cmp_eq_u32 s68, 0
    s_cselect_b64 s[4:5], s[16:17], s[26:27]
    s_cselect_b64 s[6:7], s[18:19], s[28:29]
    s_cselect_b64 s[8:9], s[20:21], s[30:31]
    s_cselect_b64 s[10:11], s[22:23], s[32:33]
    s_cselect_b64 s[12:13], s[24:25], s[34:35]
    s_mul_i32 s87, s69, 212992
    s_add_u32 s44, s4, s87
    s_addc_u32 s45, s5, 0
    s_mov_b32 s46, 212992
    s_mov_b32 s47, 0x00020000
    s_lshl_b32 s87, s70, 8
    s_sub_u32 s88, 4194304, s87
    s_add_u32 s56, s10, s87
    s_addc_u32 s57, s11, 0
    s_mov_b32 s58, s88
    s_mov_b32 s59, 0x00020000
    s_and_b32 s87, s70, 7
    s_mul_i32 s87, s87, 5
    s_lshl_b32 s88, s69, 1
    s_add_u32 s101, s87, s88
    s_add_u32 s43, s101, 0
    s_and_b32 s43, s43, 15
    s_lshl_b32 s42, s43, 18
    s_add_u32 s42, s42, s77
    s_lshl_b32 s43, s43, 6
    s_add_u32 m0, s76, 0
    s_nop 0
    buffer_load_dwordx4 v3, s[56:59], s42 offen lds
    s_add_u32 m0, s76, 1024
    s_add_u32 s42, s42, 32768
    buffer_load_dwordx4 v3, s[56:59], s42 offen lds
    s_add_u32 m0, s93, 8704
    s_add_u32 s87, s72, s43
    buffer_load_dwordx4 v76, s[44:47], s87 offen lds
    s_add_u32 m0, s93, 9728
    s_add_u32 s87, s73, s43
    buffer_load_dwordx4 v76, s[44:47], s87 offen lds
    s_add_u32 m0, s93, 10752
    s_add_u32 s87, s74, s43
    buffer_load_dwordx4 v76, s[44:47], s87 offen lds
    s_mov_b32 m0, 20992
    s_add_u32 s87, s75, s43
    s_mov_b64 exec, s[94:95]
    buffer_load_dwordx4 v76, s[44:47], s87 offen lds
    s_mov_b64 exec, -1
    s_add_u32 s43, s101, 1
    s_and_b32 s43, s43, 15
    s_lshl_b32 s42, s43, 18
    s_add_u32 s42, s42, s77
    s_lshl_b32 s43, s43, 6
    s_add_u32 m0, s76, 22016
    s_nop 0
    buffer_load_dwordx4 v3, s[56:59], s42 offen lds
    s_add_u32 m0, s76, 23040
    s_add_u32 s42, s42, 32768
    buffer_load_dwordx4 v3, s[56:59], s42 offen lds
    s_add_u32 m0, s93, 30720
    s_add_u32 s87, s72, s43
    buffer_load_dwordx4 v76, s[44:47], s87 offen lds
    s_add_u32 m0, s93, 31744
    s_add_u32 s87, s73, s43
    buffer_load_dwordx4 v76, s[44:47], s87 offen lds
    s_add_u32 m0, s93, 32768
    s_add_u32 s87, s74, s43
    buffer_load_dwordx4 v76, s[44:47], s87 offen lds
    s_mov_b32 m0, 43008
    s_add_u32 s87, s75, s43
    s_mov_b64 exec, s[94:95]
    buffer_load_dwordx4 v76, s[44:47], s87 offen lds
    s_mov_b64 exec, -1
    s_lshl_b32 s87, s69, 5
    s_add_u32 s87, s87, s70
    s_lshl_b32 s87, s87, 17
    s_add_u32 s48, s6, s87
    s_addc_u32 s49, s7, 0
    s_mov_b32 s50, 131072
    s_mov_b32 s51, 0x00020000
    s_add_u32 s52, s8, s87
    s_addc_u32 s53, s9, 0
    s_mov_b32 s54, 131072
    s_mov_b32 s55, 0x00020000
    s_lshl_b32 s87, s70, 2
    s_lshr_b32 s88, s69, 1
    s_add_u32 s87, s87, s88
    s_lshl_b32 s88, s68, 7
    s_add_u32 s88, s88, s87
    s_lshl_b32 s88, s88, 5
    s_and_b32 s89, s69, 1
    s_lshl_b32 s89, s89, 4
    s_add_u32 s88, s88, s89
    s_lshl_b32 s89, s71, 1
    s_add_u32 s88, s88, s89
    s_lshl_b32 s88, s88, 10
    s_add_u32 s92, s88, 27262976
    s_lshl_b32 s87, s87, 15
    s_and_b32 s88, s69, 1
    s_lshl_b32 s88, s88, 9
    s_add_u32 s87, s87, s88
    s_sub_u32 s88, 32768, s88
    s_add_u32 s60, s12, s87
    s_addc_u32 s61, s13, 0
    s_mov_b32 s62, s88
    s_mov_b32 s63, 0x00020000
    s_mov_b32 s87, 0
    s_add_u32 s64, s40, s87
    s_addc_u32 s65, s41, 0
    s_mov_b32 s66, 35651584
    s_mov_b32 s67, 0x00020000
    s_lshl_b32 s87, s68, 7
    s_lshl_b32 s88, s70, 2
    s_add_u32 s87, s87, s88
    s_mul_i32 s87, s87, 104
    s_mul_i32 s88, s69, 13
    s_add_u32 s87, s87, s88
    s_lshl_b32 s91, s87, 10
    s_cmp_lt_u32 s71, 2
    s_cselect_b64 s[96:97], s[48:49], s[52:53]
    s_mov_b32 s98, 131072
    s_mov_b32 s99, 0x00020000
    s_mov_b32 s100, 0
    s_lshl_b32 s87, s71, 11
    s_add_u32 m0, s87, 73728
    s_lshl_b32 s87, s71, 13
    s_add_u32 s87, s87, 0
    buffer_load_dwordx4 v25, s[60:63], s87 offen lds
    s_lshl_b32 s87, s71, 11
    s_add_u32 m0, s87, 74752
    s_lshl_b32 s87, s71, 13
    s_add_u32 s87, s87, 4096
    buffer_load_dwordx4 v25, s[60:63], s87 offen lds
    s_waitcnt vmcnt(8)
    s_waitcnt lgkmcnt(0)
    s_barrier
    ds_read_b128 a[116:119], v78 offset:0
    ds_read_b128 a[104:107], v77 offset:0
    ds_read_b128 a[108:111], v77 offset:1024
    ds_read_b128 a[112:115], v77 offset:2048
    ds_read_b64_tr_b16 v[36:37], v10 offset:0
    ds_read_b64_tr_b16 v[38:39], v10 offset:1024
    ds_read_b64_tr_b16 v[40:41], v6 offset:0
    ds_read_b64_tr_b16 v[42:43], v6 offset:1024
    ds_read_b64_tr_b16 v[44:45], v11 offset:0
    ds_read_b64_tr_b16 v[46:47], v11 offset:1024
    ds_read_b64_tr_b16 v[48:49], v7 offset:0
    ds_read_b64_tr_b16 v[50:51], v7 offset:1024
    s_waitcnt lgkmcnt(6)
    v_mfma_f32_16x16x32_bf16 a[96:99], v[36:39], a[116:119], 0
    s_add_u32 s43, s101, 2
    s_and_b32 s43, s43, 15
    s_lshl_b32 s42, s43, 18
    s_add_u32 s42, s42, s77
    s_lshl_b32 s43, s43, 6
    s_add_u32 m0, s76, 44032
    s_nop 0
    buffer_load_dwordx4 v3, s[56:59], s42 offen lds
    ds_read_b64_tr_b16 v[52:53], v8 offset:0
    ds_read_b64_tr_b16 v[54:55], v8 offset:1024
    ds_read_b64_tr_b16 v[56:57], v9 offset:0
    ds_read_b64_tr_b16 v[58:59], v9 offset:1024
    s_waitcnt lgkmcnt(8)
    v_mfma_f32_16x16x32_bf16 a[0:3], v[40:43], a[104:107], 0
    v_mfma_f32_16x16x32_bf16 a[32:35], v[40:43], a[108:111], 0
    v_mfma_f32_16x16x32_bf16 a[64:67], v[40:43], a[112:115], 0
    s_add_u32 m0, s76, 45056
    s_add_u32 s42, s42, 32768
    buffer_load_dwordx4 v3, s[56:59], s42 offen lds
    ds_read_b64_tr_b16 v[60:61], v6 offset:128
    ds_read_b64_tr_b16 v[62:63], v6 offset:1152
    ds_read_b64_tr_b16 v[64:65], v7 offset:128
    ds_read_b64_tr_b16 v[66:67], v7 offset:1152
    s_waitcnt lgkmcnt(10)
    v_mfma_f32_16x16x32_bf16 a[100:103], v[44:47], a[116:119], 0
    s_add_u32 m0, s93, 52736
    s_add_u32 s87, s72, s43
    buffer_load_dwordx4 v76, s[44:47], s87 offen lds
    ds_read_b64_tr_b16 v[68:69], v8 offset:128
    ds_read_b64_tr_b16 v[70:71], v8 offset:1152
    ds_read_b64_tr_b16 v[72:73], v9 offset:128
    ds_read_b64_tr_b16 v[74:75], v9 offset:1152
    s_waitcnt lgkmcnt(12)
    v_mfma_f32_16x16x32_bf16 a[4:7], v[48:51], a[104:107], 0
    v_mfma_f32_16x16x32_bf16 a[36:39], v[48:51], a[108:111], 0
    v_mfma_f32_16x16x32_bf16 a[68:71], v[48:51], a[112:115], 0
    s_add_u32 m0, s93, 53760
    s_add_u32 s87, s73, s43
    buffer_load_dwordx4 v76, s[44:47], s87 offen lds
    s_waitcnt lgkmcnt(10)
    v_mfma_f32_16x16x32_bf16 a[8:11], v[52:55], a[104:107], 0
    v_mfma_f32_16x16x32_bf16 a[40:43], v[52:55], a[108:111], 0
    v_mfma_f32_16x16x32_bf16 a[72:75], v[52:55], a[112:115], 0
    s_add_u32 m0, s93, 54784
    s_add_u32 s87, s74, s43
    buffer_load_dwordx4 v76, s[44:47], s87 offen lds
    s_waitcnt lgkmcnt(8)
    v_mfma_f32_16x16x32_bf16 a[12:15], v[56:59], a[104:107], 0
    v_mfma_f32_16x16x32_bf16 a[44:47], v[56:59], a[108:111], 0
    v_mfma_f32_16x16x32_bf16 a[76:79], v[56:59], a[112:115], 0
    s_mov_b32 m0, 65024
    s_add_u32 s87, s75, s43
    s_mov_b64 exec, s[94:95]
    buffer_load_dwordx4 v76, s[44:47], s87 offen lds
    s_mov_b64 exec, -1
    s_waitcnt lgkmcnt(6)
    v_mfma_f32_16x16x32_bf16 a[16:19], v[60:63], a[104:107], 0
    v_mfma_f32_16x16x32_bf16 a[48:51], v[60:63], a[108:111], 0
    v_mfma_f32_16x16x32_bf16 a[80:83], v[60:63], a[112:115], 0
    s_waitcnt vmcnt(8)
    s_waitcnt lgkmcnt(0)
    s_barrier
    ds_read_b128 a[132:135], v78 offset:22016
    ds_read_b128 a[120:123], v77 offset:22016
    ds_read_b128 a[124:127], v77 offset:23040
    ds_read_b128 a[128:131], v77 offset:24064
    ds_read_b64_tr_b16 v[36:37], v10 offset:22016
    ds_read_b64_tr_b16 v[38:39], v10 offset:23040
    ds_read_b64_tr_b16 v[40:41], v6 offset:22016
    ds_read_b64_tr_b16 v[42:43], v6 offset:23040
    v_mfma_f32_16x16x32_bf16 a[20:23], v[64:67], a[104:107], 0
    v_mfma_f32_16x16x32_bf16 a[52:55], v[64:67], a[108:111], 0
    v_mfma_f32_16x16x32_bf16 a[84:87], v[64:67], a[112:115], 0
    ds_read_b64_tr_b16 v[44:45], v11 offset:22016
    ds_read_b64_tr_b16 v[46:47], v11 offset:23040
    ds_read_b64_tr_b16 v[48:49], v7 offset:22016
    ds_read_b64_tr_b16 v[50:51], v7 offset:23040
    v_mfma_f32_16x16x32_bf16 a[24:27], v[68:71], a[104:107], 0
    v_mfma_f32_16x16x32_bf16 a[56:59], v[68:71], a[108:111], 0
    v_mfma_f32_16x16x32_bf16 a[88:91], v[68:71], a[112:115], 0
    ds_read_b64_tr_b16 v[52:53], v8 offset:22016
    ds_read_b64_tr_b16 v[54:55], v8 offset:23040
    ds_read_b64_tr_b16 v[56:57], v9 offset:22016
    ds_read_b64_tr_b16 v[58:59], v9 offset:23040
    v_mfma_f32_16x16x32_bf16 a[28:31], v[72:75], a[104:107], 0
    v_mfma_f32_16x16x32_bf16 a[60:63], v[72:75], a[108:111], 0
    v_mfma_f32_16x16x32_bf16 a[92:95], v[72:75], a[112:115], 0
    ds_read_b64_tr_b16 v[60:61], v6 offset:22144
    ds_read_b64_tr_b16 v[62:63], v6 offset:23168
    s_waitcnt lgkmcnt(12)
    v_mfma_f32_16x16x32_bf16 a[96:99], v[36:39], a[132:135], a[96:99]
    s_add_u32 s43, s101, 3
    s_and_b32 s43, s43, 15
    s_lshl_b32 s42, s43, 18
    s_add_u32 s42, s42, s77
    s_lshl_b32 s43, s43, 6
    s_add_u32 m0, s76, 0
    s_nop 0
    buffer_load_dwordx4 v3, s[56:59], s42 offen lds
    ds_read_b64_tr_b16 v[64:65], v7 offset:22144
    ds_read_b64_tr_b16 v[66:67], v7 offset:23168
    s_waitcnt lgkmcnt(12)
    v_mfma_f32_16x16x32_bf16 a[0:3], v[40:43], a[120:123], a[0:3]
    v_mfma_f32_16x16x32_bf16 a[32:35], v[40:43], a[124:127], a[32:35]
    v_mfma_f32_16x16x32_bf16 a[64:67], v[40:43], a[128:131], a[64:67]
    s_add_u32 m0, s76, 1024
    s_add_u32 s42, s42, 32768
    buffer_load_dwordx4 v3, s[56:59], s42 offen lds
    ds_read_b64_tr_b16 v[68:69], v8 offset:22144
    ds_read_b64_tr_b16 v[70:71], v8 offset:23168
    s_waitcnt lgkmcnt(12)
    v_mfma_f32_16x16x32_bf16 a[100:103], v[44:47], a[132:135], a[100:103]
    s_add_u32 m0, s93, 8704
    s_add_u32 s87, s72, s43
    buffer_load_dwordx4 v76, s[44:47], s87 offen lds
    ds_read_b64_tr_b16 v[72:73], v9 offset:22144
    ds_read_b64_tr_b16 v[74:75], v9 offset:23168
    s_waitcnt lgkmcnt(12)
    v_mfma_f32_16x16x32_bf16 a[4:7], v[48:51], a[120:123], a[4:7]
    v_mfma_f32_16x16x32_bf16 a[36:39], v[48:51], a[124:127], a[36:39]
    v_mfma_f32_16x16x32_bf16 a[68:71], v[48:51], a[128:131], a[68:71]
    s_add_u32 m0, s93, 9728
    s_add_u32 s87, s73, s43
    buffer_load_dwordx4 v76, s[44:47], s87 offen lds
    s_waitcnt lgkmcnt(10)
    v_mfma_f32_16x16x32_bf16 a[8:11], v[52:55], a[120:123], a[8:11]
    v_mfma_f32_16x16x32_bf16 a[40:43], v[52:55], a[124:127], a[40:43]
    v_mfma_f32_16x16x32_bf16 a[72:75], v[52:55], a[128:131], a[72:75]
    s_add_u32 m0, s93, 10752
    s_add_u32 s87, s74, s43
    buffer_load_dwordx4 v76, s[44:47], s87 offen lds
    s_waitcnt lgkmcnt(8)
    v_mfma_f32_16x16x32_bf16 a[12:15], v[56:59], a[120:123], a[12:15]
    v_mfma_f32_16x16x32_bf16 a[44:47], v[56:59], a[124:127], a[44:47]
    v_mfma_f32_16x16x32_bf16 a[76:79], v[56:59], a[128:131], a[76:79]
    s_mov_b32 m0, 20992
    s_add_u32 s87, s75, s43
    s_mov_b64 exec, s[94:95]
    buffer_load_dwordx4 v76, s[44:47], s87 offen lds
    s_mov_b64 exec, -1
    s_waitcnt lgkmcnt(6)
    v_mfma_f32_16x16x32_bf16 a[16:19], v[60:63], a[120:123], a[16:19]
    v_mfma_f32_16x16x32_bf16 a[48:51], v[60:63], a[124:127], a[48:51]
    v_mfma_f32_16x16x32_bf16 a[80:83], v[60:63], a[128:131], a[80:83]
    s_waitcnt vmcnt(6)
    s_waitcnt lgkmcnt(0)
    s_barrier
    ds_read_b128 a[116:119], v78 offset:44032
    ds_read_b128 a[104:107], v77 offset:44032
    ds_read_b128 a[108:111], v77 offset:45056
    ds_read_b128 a[112:115], v77 offset:46080
    ds_read_b64_tr_b16 v[36:37], v10 offset:44032
    ds_read_b64_tr_b16 v[38:39], v10 offset:45056
    ds_read_b64_tr_b16 v[40:41], v6 offset:44032
    ds_read_b64_tr_b16 v[42:43], v6 offset:45056
    v_mfma_f32_16x16x32_bf16 a[20:23], v[64:67], a[120:123], a[20:23]
    v_mfma_f32_16x16x32_bf16 a[52:55], v[64:67], a[124:127], a[52:55]
    v_mfma_f32_16x16x32_bf16 a[84:87], v[64:67], a[128:131], a[84:87]
    ds_read_b64_tr_b16 v[44:45], v11 offset:44032
    ds_read_b64_tr_b16 v[46:47], v11 offset:45056
    ds_read_b64_tr_b16 v[48:49], v7 offset:44032
    ds_read_b64_tr_b16 v[50:51], v7 offset:45056
    v_mfma_f32_16x16x32_bf16 a[24:27], v[68:71], a[120:123], a[24:27]
    v_mfma_f32_16x16x32_bf16 a[56:59], v[68:71], a[124:127], a[56:59]
    v_mfma_f32_16x16x32_bf16 a[88:91], v[68:71], a[128:131], a[88:91]
    ds_read_b64_tr_b16 v[52:53], v8 offset:44032
    ds_read_b64_tr_b16 v[54:55], v8 offset:45056
    ds_read_b64_tr_b16 v[56:57], v9 offset:44032
    ds_read_b64_tr_b16 v[58:59], v9 offset:45056
    v_mfma_f32_16x16x32_bf16 a[28:31], v[72:75], a[120:123], a[28:31]
    v_mfma_f32_16x16x32_bf16 a[60:63], v[72:75], a[124:127], a[60:63]
    v_mfma_f32_16x16x32_bf16 a[92:95], v[72:75], a[128:131], a[92:95]
    ds_read_b64_tr_b16 v[60:61], v6 offset:44160
    ds_read_b64_tr_b16 v[62:63], v6 offset:45184
    s_waitcnt lgkmcnt(12)
    v_mfma_f32_16x16x32_bf16 a[96:99], v[36:39], a[116:119], a[96:99]
    s_add_u32 s43, s101, 4
    s_and_b32 s43, s43, 15
    s_lshl_b32 s42, s43, 18
    s_add_u32 s42, s42, s77
    s_lshl_b32 s43, s43, 6
    s_add_u32 m0, s76, 22016
    s_nop 0
    buffer_load_dwordx4 v3, s[56:59], s42 offen lds
    ds_read_b64_tr_b16 v[64:65], v7 offset:44160
    ds_read_b64_tr_b16 v[66:67], v7 offset:45184
    s_waitcnt lgkmcnt(12)
    v_mfma_f32_16x16x32_bf16 a[0:3], v[40:43], a[104:107], a[0:3]
    v_mfma_f32_16x16x32_bf16 a[32:35], v[40:43], a[108:111], a[32:35]
    v_mfma_f32_16x16x32_bf16 a[64:67], v[40:43], a[112:115], a[64:67]
    s_add_u32 m0, s76, 23040
    s_add_u32 s42, s42, 32768
    buffer_load_dwordx4 v3, s[56:59], s42 offen lds
    ds_read_b64_tr_b16 v[68:69], v8 offset:44160
    ds_read_b64_tr_b16 v[70:71], v8 offset:45184
    s_waitcnt lgkmcnt(12)
    v_mfma_f32_16x16x32_bf16 a[100:103], v[44:47], a[116:119], a[100:103]
    s_add_u32 m0, s93, 30720
    s_add_u32 s87, s72, s43
    buffer_load_dwordx4 v76, s[44:47], s87 offen lds
    ds_read_b64_tr_b16 v[72:73], v9 offset:44160
    ds_read_b64_tr_b16 v[74:75], v9 offset:45184
    s_waitcnt lgkmcnt(12)
    v_mfma_f32_16x16x32_bf16 a[4:7], v[48:51], a[104:107], a[4:7]
    v_mfma_f32_16x16x32_bf16 a[36:39], v[48:51], a[108:111], a[36:39]
    v_mfma_f32_16x16x32_bf16 a[68:71], v[48:51], a[112:115], a[68:71]
    s_add_u32 m0, s93, 31744
    s_add_u32 s87, s73, s43
    buffer_load_dwordx4 v76, s[44:47], s87 offen lds
    s_waitcnt lgkmcnt(10)
    v_mfma_f32_16x16x32_bf16 a[8:11], v[52:55], a[104:107], a[8:11]
    v_mfma_f32_16x16x32_bf16 a[40:43], v[52:55], a[108:111], a[40:43]
    v_mfma_f32_16x16x32_bf16 a[72:75], v[52:55], a[112:115], a[72:75]
    s_add_u32 m0, s93, 32768
    s_add_u32 s87, s74, s43
    buffer_load_dwordx4 v76, s[44:47], s87 offen lds
    s_waitcnt lgkmcnt(8)
    v_mfma_f32_16x16x32_bf16 a[12:15], v[56:59], a[104:107], a[12:15]
    v_mfma_f32_16x16x32_bf16 a[44:47], v[56:59], a[108:111], a[44:47]
    v_mfma_f32_16x16x32_bf16 a[76:79], v[56:59], a[112:115], a[76:79]
    s_mov_b32 m0, 43008
    s_add_u32 s87, s75, s43
    s_mov_b64 exec, s[94:95]
    buffer_load_dwordx4 v76, s[44:47], s87 offen lds
    s_mov_b64 exec, -1
    s_waitcnt lgkmcnt(6)
    v_mfma_f32_16x16x32_bf16 a[16:19], v[60:63], a[104:107], a[16:19]
    v_mfma_f32_16x16x32_bf16 a[48:51], v[60:63], a[108:111], a[48:51]
    v_mfma_f32_16x16x32_bf16 a[80:83], v[60:63], a[112:115], a[80:83]
    s_waitcnt lgkmcnt(4)
    v_mfma_f32_16x16x32_bf16 a[20:23], v[64:67], a[104:107], a[20:23]
    v_mfma_f32_16x16x32_bf16 a[52:55], v[64:67], a[108:111], a[52:55]
    v_mfma_f32_16x16x32_bf16 a[84:87], v[64:67], a[112:115], a[84:87]
    s_waitcnt lgkmcnt(2)
    v_mfma_f32_16x16x32_bf16 a[24:27], v[68:71], a[104:107], a[24:27]
    v_mfma_f32_16x16x32_bf16 a[56:59], v[68:71], a[108:111], a[56:59]
    v_mfma_f32_16x16x32_bf16 a[88:91], v[68:71], a[112:115], a[88:91]
    s_waitcnt lgkmcnt(0)
    v_mfma_f32_16x16x32_bf16 a[28:31], v[72:75], a[104:107], a[28:31]
    v_mfma_f32_16x16x32_bf16 a[60:63], v[72:75], a[108:111], a[60:63]
    v_mfma_f32_16x16x32_bf16 a[92:95], v[72:75], a[112:115], a[92:95]
    ds_read_b64_tr_b16 a[136:137], v26 offset:0
    ds_read_b64_tr_b16 a[138:139], v26 offset:4096
    ds_read_b64_tr_b16 a[140:141], v27 offset:0
    ds_read_b64_tr_b16 a[142:143], v27 offset:4096
    s_waitcnt lgkmcnt(2)
    s_add_u32 s87, s92, 0
    buffer_store_dwordx4 a[136:139], v1, s[64:67], s87 offen
    s_waitcnt lgkmcnt(0)
    s_add_u32 s87, s92, 1024
    buffer_store_dwordx4 a[140:143], v1, s[64:67], s87 offen
    s_nop 1
    s_waitcnt vmcnt(8)
    s_waitcnt lgkmcnt(0)
    s_barrier
    ds_read_b128 a[132:135], v78 offset:0
    ds_read_b128 a[120:123], v77 offset:0
    ds_read_b128 a[124:127], v77 offset:1024
    ds_read_b128 a[128:131], v77 offset:2048
    ds_read_b64_tr_b16 v[36:37], v10 offset:0
    ds_read_b64_tr_b16 v[38:39], v10 offset:1024
    ds_read_b64_tr_b16 v[40:41], v6 offset:0
    ds_read_b64_tr_b16 v[42:43], v6 offset:1024
    ds_read_b64_tr_b16 v[44:45], v11 offset:0
    ds_read_b64_tr_b16 v[46:47], v11 offset:1024
    ds_read_b64_tr_b16 v[48:49], v7 offset:0
    ds_read_b64_tr_b16 v[50:51], v7 offset:1024
    s_waitcnt lgkmcnt(6)
    v_mfma_f32_16x16x32_bf16 a[96:99], v[36:39], a[132:135], a[96:99]
    s_lshl_b32 s87, s71, 11
    s_add_u32 m0, s87, 73728
    s_lshl_b32 s87, s71, 13
    s_add_u32 s87, s87, 256
    buffer_load_dwordx4 v25, s[60:63], s87 offen lds
    s_lshl_b32 s87, s71, 11
    s_add_u32 m0, s87, 74752
    s_lshl_b32 s87, s71, 13
    s_add_u32 s87, s87, 4352
    buffer_load_dwordx4 v25, s[60:63], s87 offen lds
    ds_read_b64_tr_b16 v[52:53], v8 offset:0
    ds_read_b64_tr_b16 v[54:55], v8 offset:1024
    ds_read_b64_tr_b16 v[56:57], v9 offset:0
    ds_read_b64_tr_b16 v[58:59], v9 offset:1024
    s_waitcnt lgkmcnt(8)
    v_mfma_f32_16x16x32_bf16 a[0:3], v[40:43], a[120:123], a[0:3]
    v_mfma_f32_16x16x32_bf16 a[32:35], v[40:43], a[124:127], a[32:35]
    v_mfma_f32_16x16x32_bf16 a[64:67], v[40:43], a[128:131], a[64:67]
    s_add_u32 s43, s101, 5
    s_and_b32 s43, s43, 15
    s_lshl_b32 s42, s43, 18
    s_add_u32 s42, s42, s77
    s_lshl_b32 s43, s43, 6
    s_add_u32 m0, s76, 44032
    s_nop 0
    buffer_load_dwordx4 v3, s[56:59], s42 offen lds
    ds_read_b64_tr_b16 v[60:61], v6 offset:128
    ds_read_b64_tr_b16 v[62:63], v6 offset:1152
    ds_read_b64_tr_b16 v[64:65], v7 offset:128
    ds_read_b64_tr_b16 v[66:67], v7 offset:1152
    s_waitcnt lgkmcnt(10)
    v_mfma_f32_16x16x32_bf16 a[100:103], v[44:47], a[132:135], a[100:103]
    s_add_u32 m0, s76, 45056
    s_add_u32 s42, s42, 32768
    buffer_load_dwordx4 v3, s[56:59], s42 offen lds
    ds_read_b64_tr_b16 v[68:69], v8 offset:128
    ds_read_b64_tr_b16 v[70:71], v8 offset:1152
    ds_read_b64_tr_b16 v[72:73], v9 offset:128
    ds_read_b64_tr_b16 v[74:75], v9 offset:1152
    s_waitcnt lgkmcnt(12)
    v_mfma_f32_16x16x32_bf16 a[4:7], v[48:51], a[120:123], a[4:7]
    v_mfma_f32_16x16x32_bf16 a[36:39], v[48:51], a[124:127], a[36:39]
    v_mfma_f32_16x16x32_bf16 a[68:71], v[48:51], a[128:131], a[68:71]
    s_add_u32 m0, s93, 52736
    s_add_u32 s87, s72, s43
    buffer_load_dwordx4 v76, s[44:47], s87 offen lds
    s_waitcnt lgkmcnt(10)
    v_mfma_f32_16x16x32_bf16 a[8:11], v[52:55], a[120:123], a[8:11]
    v_mfma_f32_16x16x32_bf16 a[40:43], v[52:55], a[124:127], a[40:43]
    v_mfma_f32_16x16x32_bf16 a[72:75], v[52:55], a[128:131], a[72:75]
    s_add_u32 m0, s93, 53760
    s_add_u32 s87, s73, s43
    buffer_load_dwordx4 v76, s[44:47], s87 offen lds
    s_waitcnt lgkmcnt(8)
    v_mfma_f32_16x16x32_bf16 a[12:15], v[56:59], a[120:123], a[12:15]
    v_mfma_f32_16x16x32_bf16 a[44:47], v[56:59], a[124:127], a[44:47]
    v_mfma_f32_16x16x32_bf16 a[76:79], v[56:59], a[128:131], a[76:79]
    s_add_u32 m0, s93, 54784
    s_add_u32 s87, s74, s43
    buffer_load_dwordx4 v76, s[44:47], s87 offen lds
    s_waitcnt lgkmcnt(6)
    v_mfma_f32_16x16x32_bf16 a[16:19], v[60:63], a[120:123], a[16:19]
    v_mfma_f32_16x16x32_bf16 a[48:51], v[60:63], a[124:127], a[48:51]
    v_mfma_f32_16x16x32_bf16 a[80:83], v[60:63], a[128:131], a[80:83]
    s_mov_b32 m0, 65024
    s_add_u32 s87, s75, s43
    s_mov_b64 exec, s[94:95]
    buffer_load_dwordx4 v76, s[44:47], s87 offen lds
    s_mov_b64 exec, -1
    s_waitcnt vmcnt(10)
    s_waitcnt lgkmcnt(0)
    s_barrier
    ds_read_b128 a[116:119], v78 offset:22016
    ds_read_b128 a[104:107], v77 offset:22016
    ds_read_b128 a[108:111], v77 offset:23040
    ds_read_b128 a[112:115], v77 offset:24064
    ds_read_b64_tr_b16 v[36:37], v10 offset:22016
    ds_read_b64_tr_b16 v[38:39], v10 offset:23040
    ds_read_b64_tr_b16 v[40:41], v6 offset:22016
    ds_read_b64_tr_b16 v[42:43], v6 offset:23040
    v_mfma_f32_16x16x32_bf16 a[20:23], v[64:67], a[120:123], a[20:23]
    v_mfma_f32_16x16x32_bf16 a[52:55], v[64:67], a[124:127], a[52:55]
    v_mfma_f32_16x16x32_bf16 a[84:87], v[64:67], a[128:131], a[84:87]
    ds_read_b64_tr_b16 v[44:45], v11 offset:22016
    ds_read_b64_tr_b16 v[46:47], v11 offset:23040
    ds_read_b64_tr_b16 v[48:49], v7 offset:22016
    ds_read_b64_tr_b16 v[50:51], v7 offset:23040
    v_mfma_f32_16x16x32_bf16 a[24:27], v[68:71], a[120:123], a[24:27]
    v_mfma_f32_16x16x32_bf16 a[56:59], v[68:71], a[124:127], a[56:59]
    v_mfma_f32_16x16x32_bf16 a[88:91], v[68:71], a[128:131], a[88:91]
    ds_read_b64_tr_b16 v[52:53], v8 offset:22016
    ds_read_b64_tr_b16 v[54:55], v8 offset:23040
    ds_read_b64_tr_b16 v[56:57], v9 offset:22016
    ds_read_b64_tr_b16 v[58:59], v9 offset:23040
    v_mfma_f32_16x16x32_bf16 a[28:31], v[72:75], a[120:123], a[28:31]
    v_mfma_f32_16x16x32_bf16 a[60:63], v[72:75], a[124:127], a[60:63]
    v_mfma_f32_16x16x32_bf16 a[92:95], v[72:75], a[128:131], a[92:95]
    ds_read_b64_tr_b16 v[60:61], v6 offset:22144
    ds_read_b64_tr_b16 v[62:63], v6 offset:23168
    s_waitcnt lgkmcnt(12)
    v_mfma_f32_16x16x32_bf16 a[96:99], v[36:39], a[116:119], a[96:99]
    s_add_u32 s43, s101, 6
    s_and_b32 s43, s43, 15
    s_lshl_b32 s42, s43, 18
    s_add_u32 s42, s42, s77
    s_lshl_b32 s43, s43, 6
    s_add_u32 m0, s76, 0
    s_nop 0
    buffer_load_dwordx4 v3, s[56:59], s42 offen lds
    ds_read_b64_tr_b16 v[64:65], v7 offset:22144
    ds_read_b64_tr_b16 v[66:67], v7 offset:23168
    s_waitcnt lgkmcnt(12)
    v_mfma_f32_16x16x32_bf16 a[0:3], v[40:43], a[104:107], a[0:3]
    v_mfma_f32_16x16x32_bf16 a[32:35], v[40:43], a[108:111], a[32:35]
    v_mfma_f32_16x16x32_bf16 a[64:67], v[40:43], a[112:115], a[64:67]
    s_add_u32 m0, s76, 1024
    s_add_u32 s42, s42, 32768
    buffer_load_dwordx4 v3, s[56:59], s42 offen lds
    ds_read_b64_tr_b16 v[68:69], v8 offset:22144
    ds_read_b64_tr_b16 v[70:71], v8 offset:23168
    s_waitcnt lgkmcnt(12)
    v_mfma_f32_16x16x32_bf16 a[100:103], v[44:47], a[116:119], a[100:103]
    s_add_u32 m0, s93, 8704
    s_add_u32 s87, s72, s43
    buffer_load_dwordx4 v76, s[44:47], s87 offen lds
    ds_read_b64_tr_b16 v[72:73], v9 offset:22144
    ds_read_b64_tr_b16 v[74:75], v9 offset:23168
    s_waitcnt lgkmcnt(12)
    v_mfma_f32_16x16x32_bf16 a[4:7], v[48:51], a[104:107], a[4:7]
    v_mfma_f32_16x16x32_bf16 a[36:39], v[48:51], a[108:111], a[36:39]
    v_mfma_f32_16x16x32_bf16 a[68:71], v[48:51], a[112:115], a[68:71]
    s_add_u32 m0, s93, 9728
    s_add_u32 s87, s73, s43
    buffer_load_dwordx4 v76, s[44:47], s87 offen lds
    s_waitcnt lgkmcnt(10)
    v_mfma_f32_16x16x32_bf16 a[8:11], v[52:55], a[104:107], a[8:11]
    v_mfma_f32_16x16x32_bf16 a[40:43], v[52:55], a[108:111], a[40:43]
    v_mfma_f32_16x16x32_bf16 a[72:75], v[52:55], a[112:115], a[72:75]
    s_add_u32 m0, s93, 10752
    s_add_u32 s87, s74, s43
    buffer_load_dwordx4 v76, s[44:47], s87 offen lds
    s_waitcnt lgkmcnt(8)
    v_mfma_f32_16x16x32_bf16 a[12:15], v[56:59], a[104:107], a[12:15]
    v_mfma_f32_16x16x32_bf16 a[44:47], v[56:59], a[108:111], a[44:47]
    v_mfma_f32_16x16x32_bf16 a[76:79], v[56:59], a[112:115], a[76:79]
    s_mov_b32 m0, 20992
    s_add_u32 s87, s75, s43
    s_mov_b64 exec, s[94:95]
    buffer_load_dwordx4 v76, s[44:47], s87 offen lds
    s_mov_b64 exec, -1
    s_waitcnt lgkmcnt(6)
    v_mfma_f32_16x16x32_bf16 a[16:19], v[60:63], a[104:107], a[16:19]
    v_mfma_f32_16x16x32_bf16 a[48:51], v[60:63], a[108:111], a[48:51]
    v_mfma_f32_16x16x32_bf16 a[80:83], v[60:63], a[112:115], a[80:83]
    s_waitcnt vmcnt(6)
    s_waitcnt lgkmcnt(0)
    s_barrier
    ds_read_b128 a[132:135], v78 offset:44032
    ds_read_b128 a[120:123], v77 offset:44032
    ds_read_b128 a[124:127], v77 offset:45056
    ds_read_b128 a[128:131], v77 offset:46080
    ds_read_b64_tr_b16 v[36:37], v10 offset:44032
    ds_read_b64_tr_b16 v[38:39], v10 offset:45056
    ds_read_b64_tr_b16 v[40:41], v6 offset:44032
    ds_read_b64_tr_b16 v[42:43], v6 offset:45056
    v_mfma_f32_16x16x32_bf16 a[20:23], v[64:67], a[104:107], a[20:23]
    v_mfma_f32_16x16x32_bf16 a[52:55], v[64:67], a[108:111], a[52:55]
    v_mfma_f32_16x16x32_bf16 a[84:87], v[64:67], a[112:115], a[84:87]
    ds_read_b64_tr_b16 v[44:45], v11 offset:44032
    ds_read_b64_tr_b16 v[46:47], v11 offset:45056
    ds_read_b64_tr_b16 v[48:49], v7 offset:44032
    ds_read_b64_tr_b16 v[50:51], v7 offset:45056
    v_mfma_f32_16x16x32_bf16 a[24:27], v[68:71], a[104:107], a[24:27]
    v_mfma_f32_16x16x32_bf16 a[56:59], v[68:71], a[108:111], a[56:59]
    v_mfma_f32_16x16x32_bf16 a[88:91], v[68:71], a[112:115], a[88:91]
    ds_read_b64_tr_b16 v[52:53], v8 offset:44032
    ds_read_b64_tr_b16 v[54:55], v8 offset:45056
    ds_read_b64_tr_b16 v[56:57], v9 offset:44032
    ds_read_b64_tr_b16 v[58:59], v9 offset:45056
    v_mfma_f32_16x16x32_bf16 a[28:31], v[72:75], a[104:107], a[28:31]
    v_mfma_f32_16x16x32_bf16 a[60:63], v[72:75], a[108:111], a[60:63]
    v_mfma_f32_16x16x32_bf16 a[92:95], v[72:75], a[112:115], a[92:95]
    ds_read_b64_tr_b16 v[60:61], v6 offset:44160
    ds_read_b64_tr_b16 v[62:63], v6 offset:45184
    s_waitcnt lgkmcnt(12)
    v_mfma_f32_16x16x32_bf16 a[96:99], v[36:39], a[132:135], a[96:99]
    s_add_u32 s43, s101, 7
    s_and_b32 s43, s43, 15
    s_lshl_b32 s42, s43, 18
    s_add_u32 s42, s42, s77
    s_lshl_b32 s43, s43, 6
    s_add_u32 m0, s76, 22016
    s_nop 0
    buffer_load_dwordx4 v3, s[56:59], s42 offen lds
    ds_read_b64_tr_b16 v[64:65], v7 offset:44160
    ds_read_b64_tr_b16 v[66:67], v7 offset:45184
    s_waitcnt lgkmcnt(12)
    v_mfma_f32_16x16x32_bf16 a[0:3], v[40:43], a[120:123], a[0:3]
    v_mfma_f32_16x16x32_bf16 a[32:35], v[40:43], a[124:127], a[32:35]
    v_mfma_f32_16x16x32_bf16 a[64:67], v[40:43], a[128:131], a[64:67]
    s_add_u32 m0, s76, 23040
    s_add_u32 s42, s42, 32768
    buffer_load_dwordx4 v3, s[56:59], s42 offen lds
    ds_read_b64_tr_b16 v[68:69], v8 offset:44160
    ds_read_b64_tr_b16 v[70:71], v8 offset:45184
    s_waitcnt lgkmcnt(12)
    v_mfma_f32_16x16x32_bf16 a[100:103], v[44:47], a[132:135], a[100:103]
    s_add_u32 m0, s93, 30720
    s_add_u32 s87, s72, s43
    buffer_load_dwordx4 v76, s[44:47], s87 offen lds
    ds_read_b64_tr_b16 v[72:73], v9 offset:44160
    ds_read_b64_tr_b16 v[74:75], v9 offset:45184
    s_waitcnt lgkmcnt(12)
    v_mfma_f32_16x16x32_bf16 a[4:7], v[48:51], a[120:123], a[4:7]
    v_mfma_f32_16x16x32_bf16 a[36:39], v[48:51], a[124:127], a[36:39]
    v_mfma_f32_16x16x32_bf16 a[68:71], v[48:51], a[128:131], a[68:71]
    s_add_u32 m0, s93, 31744
    s_add_u32 s87, s73, s43
    buffer_load_dwordx4 v76, s[44:47], s87 offen lds
    s_waitcnt lgkmcnt(10)
    v_mfma_f32_16x16x32_bf16 a[8:11], v[52:55], a[120:123], a[8:11]
    v_mfma_f32_16x16x32_bf16 a[40:43], v[52:55], a[124:127], a[40:43]
    v_mfma_f32_16x16x32_bf16 a[72:75], v[52:55], a[128:131], a[72:75]
    s_add_u32 m0, s93, 32768
    s_add_u32 s87, s74, s43
    buffer_load_dwordx4 v76, s[44:47], s87 offen lds
    s_waitcnt lgkmcnt(8)
    v_mfma_f32_16x16x32_bf16 a[12:15], v[56:59], a[120:123], a[12:15]
    v_mfma_f32_16x16x32_bf16 a[44:47], v[56:59], a[124:127], a[44:47]
    v_mfma_f32_16x16x32_bf16 a[76:79], v[56:59], a[128:131], a[76:79]
    s_mov_b32 m0, 43008
    s_add_u32 s87, s75, s43
    s_mov_b64 exec, s[94:95]
    buffer_load_dwordx4 v76, s[44:47], s87 offen lds
    s_mov_b64 exec, -1
    s_waitcnt lgkmcnt(6)
    v_mfma_f32_16x16x32_bf16 a[16:19], v[60:63], a[120:123], a[16:19]
    v_mfma_f32_16x16x32_bf16 a[48:51], v[60:63], a[124:127], a[48:51]
    v_mfma_f32_16x16x32_bf16 a[80:83], v[60:63], a[128:131], a[80:83]
    s_waitcnt vmcnt(6)
    s_waitcnt lgkmcnt(0)
    s_barrier
    ds_read_b128 a[116:119], v78 offset:0
    ds_read_b128 a[104:107], v77 offset:0
    ds_read_b128 a[108:111], v77 offset:1024
    ds_read_b128 a[112:115], v77 offset:2048
    ds_read_b64_tr_b16 v[36:37], v10 offset:0
    ds_read_b64_tr_b16 v[38:39], v10 offset:1024
    ds_read_b64_tr_b16 v[40:41], v6 offset:0
    ds_read_b64_tr_b16 v[42:43], v6 offset:1024
    v_mfma_f32_16x16x32_bf16 a[20:23], v[64:67], a[120:123], a[20:23]
    v_mfma_f32_16x16x32_bf16 a[52:55], v[64:67], a[124:127], a[52:55]
    v_mfma_f32_16x16x32_bf16 a[84:87], v[64:67], a[128:131], a[84:87]
    ds_read_b64_tr_b16 v[44:45], v11 offset:0
    ds_read_b64_tr_b16 v[46:47], v11 offset:1024
    ds_read_b64_tr_b16 v[48:49], v7 offset:0
    ds_read_b64_tr_b16 v[50:51], v7 offset:1024
    v_mfma_f32_16x16x32_bf16 a[24:27], v[68:71], a[120:123], a[24:27]
    v_mfma_f32_16x16x32_bf16 a[56:59], v[68:71], a[124:127], a[56:59]
    v_mfma_f32_16x16x32_bf16 a[88:91], v[68:71], a[128:131], a[88:91]
    ds_read_b64_tr_b16 v[52:53], v8 offset:0
    ds_read_b64_tr_b16 v[54:55], v8 offset:1024
    ds_read_b64_tr_b16 v[56:57], v9 offset:0
    ds_read_b64_tr_b16 v[58:59], v9 offset:1024
    v_mfma_f32_16x16x32_bf16 a[28:31], v[72:75], a[120:123], a[28:31]
    v_mfma_f32_16x16x32_bf16 a[60:63], v[72:75], a[124:127], a[60:63]
    v_mfma_f32_16x16x32_bf16 a[92:95], v[72:75], a[128:131], a[92:95]
    ds_read_b64_tr_b16 v[60:61], v6 offset:128
    ds_read_b64_tr_b16 v[62:63], v6 offset:1152
    s_waitcnt lgkmcnt(12)
    v_mfma_f32_16x16x32_bf16 a[96:99], v[36:39], a[116:119], a[96:99]
    s_add_u32 s43, s101, 8
    s_and_b32 s43, s43, 15
    s_lshl_b32 s42, s43, 18
    s_add_u32 s42, s42, s77
    s_lshl_b32 s43, s43, 6
    s_add_u32 m0, s76, 44032
    s_nop 0
    buffer_load_dwordx4 v3, s[56:59], s42 offen lds
    ds_read_b64_tr_b16 v[64:65], v7 offset:128
    ds_read_b64_tr_b16 v[66:67], v7 offset:1152
    s_waitcnt lgkmcnt(12)
    v_mfma_f32_16x16x32_bf16 a[0:3], v[40:43], a[104:107], a[0:3]
    v_mfma_f32_16x16x32_bf16 a[32:35], v[40:43], a[108:111], a[32:35]
    v_mfma_f32_16x16x32_bf16 a[64:67], v[40:43], a[112:115], a[64:67]
    s_add_u32 m0, s76, 45056
    s_add_u32 s42, s42, 32768
    buffer_load_dwordx4 v3, s[56:59], s42 offen lds
    ds_read_b64_tr_b16 v[68:69], v8 offset:128
    ds_read_b64_tr_b16 v[70:71], v8 offset:1152
    s_waitcnt lgkmcnt(12)
    v_mfma_f32_16x16x32_bf16 a[100:103], v[44:47], a[116:119], a[100:103]
    s_add_u32 m0, s93, 52736
    s_add_u32 s87, s72, s43
    buffer_load_dwordx4 v76, s[44:47], s87 offen lds
    ds_read_b64_tr_b16 v[72:73], v9 offset:128
    ds_read_b64_tr_b16 v[74:75], v9 offset:1152
    s_waitcnt lgkmcnt(12)
    v_mfma_f32_16x16x32_bf16 a[4:7], v[48:51], a[104:107], a[4:7]
    v_mfma_f32_16x16x32_bf16 a[36:39], v[48:51], a[108:111], a[36:39]
    v_mfma_f32_16x16x32_bf16 a[68:71], v[48:51], a[112:115], a[68:71]
    s_add_u32 m0, s93, 53760
    s_add_u32 s87, s73, s43
    buffer_load_dwordx4 v76, s[44:47], s87 offen lds
    s_waitcnt lgkmcnt(10)
    v_mfma_f32_16x16x32_bf16 a[8:11], v[52:55], a[104:107], a[8:11]
    v_mfma_f32_16x16x32_bf16 a[40:43], v[52:55], a[108:111], a[40:43]
    v_mfma_f32_16x16x32_bf16 a[72:75], v[52:55], a[112:115], a[72:75]
    s_add_u32 m0, s93, 54784
    s_add_u32 s87, s74, s43
    buffer_load_dwordx4 v76, s[44:47], s87 offen lds
    s_waitcnt lgkmcnt(8)
    v_mfma_f32_16x16x32_bf16 a[12:15], v[56:59], a[104:107], a[12:15]
    v_mfma_f32_16x16x32_bf16 a[44:47], v[56:59], a[108:111], a[44:47]
    v_mfma_f32_16x16x32_bf16 a[76:79], v[56:59], a[112:115], a[76:79]
    s_mov_b32 m0, 65024
    s_add_u32 s87, s75, s43
    s_mov_b64 exec, s[94:95]
    buffer_load_dwordx4 v76, s[44:47], s87 offen lds
    s_mov_b64 exec, -1
    s_waitcnt lgkmcnt(6)
    v_mfma_f32_16x16x32_bf16 a[16:19], v[60:63], a[104:107], a[16:19]
    v_mfma_f32_16x16x32_bf16 a[48:51], v[60:63], a[108:111], a[48:51]
    v_mfma_f32_16x16x32_bf16 a[80:83], v[60:63], a[112:115], a[80:83]
    s_waitcnt lgkmcnt(4)
    v_mfma_f32_16x16x32_bf16 a[20:23], v[64:67], a[104:107], a[20:23]
    v_mfma_f32_16x16x32_bf16 a[52:55], v[64:67], a[108:111], a[52:55]
    v_mfma_f32_16x16x32_bf16 a[84:87], v[64:67], a[112:115], a[84:87]
    s_waitcnt lgkmcnt(2)
    v_mfma_f32_16x16x32_bf16 a[24:27], v[68:71], a[104:107], a[24:27]
    v_mfma_f32_16x16x32_bf16 a[56:59], v[68:71], a[108:111], a[56:59]
    v_mfma_f32_16x16x32_bf16 a[88:91], v[68:71], a[112:115], a[88:91]
    s_waitcnt lgkmcnt(0)
    v_mfma_f32_16x16x32_bf16 a[28:31], v[72:75], a[104:107], a[28:31]
    v_mfma_f32_16x16x32_bf16 a[60:63], v[72:75], a[108:111], a[60:63]
    v_mfma_f32_16x16x32_bf16 a[92:95], v[72:75], a[112:115], a[92:95]
    ds_read_b64_tr_b16 a[136:137], v26 offset:0
    ds_read_b64_tr_b16 a[138:139], v26 offset:4096
    ds_read_b64_tr_b16 a[140:141], v27 offset:0
    ds_read_b64_tr_b16 a[142:143], v27 offset:4096
    s_waitcnt lgkmcnt(2)
    s_add_u32 s87, s92, 8192
    buffer_store_dwordx4 a[136:139], v1, s[64:67], s87 offen
    s_waitcnt lgkmcnt(0)
    s_add_u32 s87, s92, 9216
    buffer_store_dwordx4 a[140:143], v1, s[64:67], s87 offen
    s_nop 1
    s_waitcnt vmcnt(8)
    s_waitcnt lgkmcnt(0)
    s_barrier
    ds_read_b128 a[132:135], v78 offset:22016
    ds_read_b128 a[120:123], v77 offset:22016
    ds_read_b128 a[124:127], v77 offset:23040
    ds_read_b128 a[128:131], v77 offset:24064
    ds_read_b64_tr_b16 v[36:37], v10 offset:22016
    ds_read_b64_tr_b16 v[38:39], v10 offset:23040
    ds_read_b64_tr_b16 v[40:41], v6 offset:22016
    ds_read_b64_tr_b16 v[42:43], v6 offset:23040
    ds_read_b64_tr_b16 v[44:45], v11 offset:22016
    ds_read_b64_tr_b16 v[46:47], v11 offset:23040
    ds_read_b64_tr_b16 v[48:49], v7 offset:22016
    ds_read_b64_tr_b16 v[50:51], v7 offset:23040
    s_waitcnt lgkmcnt(6)
    v_mfma_f32_16x16x32_bf16 a[96:99], v[36:39], a[132:135], a[96:99]
    s_add_u32 s43, s101, 9
    s_and_b32 s43, s43, 15
    s_lshl_b32 s42, s43, 18
    s_add_u32 s42, s42, s77
    s_lshl_b32 s43, s43, 6
    s_add_u32 m0, s76, 0
    s_nop 0
    buffer_load_dwordx4 v3, s[56:59], s42 offen lds
    ds_read_b64_tr_b16 v[52:53], v8 offset:22016
    ds_read_b64_tr_b16 v[54:55], v8 offset:23040
    ds_read_b64_tr_b16 v[56:57], v9 offset:22016
    ds_read_b64_tr_b16 v[58:59], v9 offset:23040
    s_waitcnt lgkmcnt(8)
    v_mfma_f32_16x16x32_bf16 a[0:3], v[40:43], a[120:123], a[0:3]
    v_mfma_f32_16x16x32_bf16 a[32:35], v[40:43], a[124:127], a[32:35]
    v_mfma_f32_16x16x32_bf16 a[64:67], v[40:43], a[128:131], a[64:67]
    s_add_u32 m0, s76, 1024
    s_add_u32 s42, s42, 32768
    buffer_load_dwordx4 v3, s[56:59], s42 offen lds
    ds_read_b64_tr_b16 v[60:61], v6 offset:22144
    ds_read_b64_tr_b16 v[62:63], v6 offset:23168
    ds_read_b64_tr_b16 v[64:65], v7 offset:22144
    ds_read_b64_tr_b16 v[66:67], v7 offset:23168
    s_waitcnt lgkmcnt(10)
    v_mfma_f32_16x16x32_bf16 a[100:103], v[44:47], a[132:135], a[100:103]
    s_add_u32 m0, s93, 8704
    s_add_u32 s87, s72, s43
    buffer_load_dwordx4 v76, s[44:47], s87 offen lds
    ds_read_b64_tr_b16 v[68:69], v8 offset:22144
    ds_read_b64_tr_b16 v[70:71], v8 offset:23168
    ds_read_b64_tr_b16 v[72:73], v9 offset:22144
    ds_read_b64_tr_b16 v[74:75], v9 offset:23168
    s_waitcnt lgkmcnt(12)
    v_mfma_f32_16x16x32_bf16 a[4:7], v[48:51], a[120:123], a[4:7]
    v_mfma_f32_16x16x32_bf16 a[36:39], v[48:51], a[124:127], a[36:39]
    v_mfma_f32_16x16x32_bf16 a[68:71], v[48:51], a[128:131], a[68:71]
    s_add_u32 m0, s93, 9728
    s_add_u32 s87, s73, s43
    buffer_load_dwordx4 v76, s[44:47], s87 offen lds
    s_waitcnt lgkmcnt(10)
    v_mfma_f32_16x16x32_bf16 a[8:11], v[52:55], a[120:123], a[8:11]
    v_mfma_f32_16x16x32_bf16 a[40:43], v[52:55], a[124:127], a[40:43]
    v_mfma_f32_16x16x32_bf16 a[72:75], v[52:55], a[128:131], a[72:75]
    s_add_u32 m0, s93, 10752
    s_add_u32 s87, s74, s43
    buffer_load_dwordx4 v76, s[44:47], s87 offen lds
    s_waitcnt lgkmcnt(8)
    v_mfma_f32_16x16x32_bf16 a[12:15], v[56:59], a[120:123], a[12:15]
    v_mfma_f32_16x16x32_bf16 a[44:47], v[56:59], a[124:127], a[44:47]
    v_mfma_f32_16x16x32_bf16 a[76:79], v[56:59], a[128:131], a[76:79]
    s_mov_b32 m0, 20992
    s_add_u32 s87, s75, s43
    s_mov_b64 exec, s[94:95]
    buffer_load_dwordx4 v76, s[44:47], s87 offen lds
    s_mov_b64 exec, -1
    s_waitcnt lgkmcnt(6)
    v_mfma_f32_16x16x32_bf16 a[16:19], v[60:63], a[120:123], a[16:19]
    v_mfma_f32_16x16x32_bf16 a[48:51], v[60:63], a[124:127], a[48:51]
    v_mfma_f32_16x16x32_bf16 a[80:83], v[60:63], a[128:131], a[80:83]
    s_waitcnt vmcnt(8)
    s_waitcnt lgkmcnt(0)
    s_barrier
    ds_read_b128 a[116:119], v78 offset:44032
    ds_read_b128 a[104:107], v77 offset:44032
    ds_read_b128 a[108:111], v77 offset:45056
    ds_read_b128 a[112:115], v77 offset:46080
    ds_read_b64_tr_b16 v[36:37], v10 offset:44032
    ds_read_b64_tr_b16 v[38:39], v10 offset:45056
    ds_read_b64_tr_b16 v[40:41], v6 offset:44032
    ds_read_b64_tr_b16 v[42:43], v6 offset:45056
    v_mfma_f32_16x16x32_bf16 a[20:23], v[64:67], a[120:123], a[20:23]
    v_mfma_f32_16x16x32_bf16 a[52:55], v[64:67], a[124:127], a[52:55]
    v_mfma_f32_16x16x32_bf16 a[84:87], v[64:67], a[128:131], a[84:87]
    ds_read_b64_tr_b16 v[44:45], v11 offset:44032
    ds_read_b64_tr_b16 v[46:47], v11 offset:45056
    ds_read_b64_tr_b16 v[48:49], v7 offset:44032
    ds_read_b64_tr_b16 v[50:51], v7 offset:45056
    v_mfma_f32_16x16x32_bf16 a[24:27], v[68:71], a[120:123], a[24:27]
    v_mfma_f32_16x16x32_bf16 a[56:59], v[68:71], a[124:127], a[56:59]
    v_mfma_f32_16x16x32_bf16 a[88:91], v[68:71], a[128:131], a[88:91]
    ds_read_b64_tr_b16 v[52:53], v8 offset:44032
    ds_read_b64_tr_b16 v[54:55], v8 offset:45056
    ds_read_b64_tr_b16 v[56:57], v9 offset:44032
    ds_read_b64_tr_b16 v[58:59], v9 offset:45056
    v_mfma_f32_16x16x32_bf16 a[28:31], v[72:75], a[120:123], a[28:31]
    v_mfma_f32_16x16x32_bf16 a[60:63], v[72:75], a[124:127], a[60:63]
    v_mfma_f32_16x16x32_bf16 a[92:95], v[72:75], a[128:131], a[92:95]
    ds_read_b64_tr_b16 v[60:61], v6 offset:44160
    ds_read_b64_tr_b16 v[62:63], v6 offset:45184
    s_waitcnt lgkmcnt(12)
    v_mfma_f32_16x16x32_bf16 a[96:99], v[36:39], a[116:119], a[96:99]
    s_add_u32 s43, s101, 10
    s_and_b32 s43, s43, 15
    s_lshl_b32 s42, s43, 18
    s_add_u32 s42, s42, s77
    s_lshl_b32 s43, s43, 6
    s_add_u32 m0, s76, 22016
    s_nop 0
    buffer_load_dwordx4 v3, s[56:59], s42 offen lds
    ds_read_b64_tr_b16 v[64:65], v7 offset:44160
    ds_read_b64_tr_b16 v[66:67], v7 offset:45184
    s_waitcnt lgkmcnt(12)
    v_mfma_f32_16x16x32_bf16 a[0:3], v[40:43], a[104:107], a[0:3]
    v_mfma_f32_16x16x32_bf16 a[32:35], v[40:43], a[108:111], a[32:35]
    v_mfma_f32_16x16x32_bf16 a[64:67], v[40:43], a[112:115], a[64:67]
    s_add_u32 m0, s76, 23040
    s_add_u32 s42, s42, 32768
    buffer_load_dwordx4 v3, s[56:59], s42 offen lds
    ds_read_b64_tr_b16 v[68:69], v8 offset:44160
    ds_read_b64_tr_b16 v[70:71], v8 offset:45184
    s_waitcnt lgkmcnt(12)
    v_mfma_f32_16x16x32_bf16 a[100:103], v[44:47], a[116:119], a[100:103]
    s_add_u32 m0, s93, 30720
    s_add_u32 s87, s72, s43
    buffer_load_dwordx4 v76, s[44:47], s87 offen lds
    ds_read_b64_tr_b16 v[72:73], v9 offset:44160
    ds_read_b64_tr_b16 v[74:75], v9 offset:45184
    s_waitcnt lgkmcnt(12)
    v_mfma_f32_16x16x32_bf16 a[4:7], v[48:51], a[104:107], a[4:7]
    v_mfma_f32_16x16x32_bf16 a[36:39], v[48:51], a[108:111], a[36:39]
    v_mfma_f32_16x16x32_bf16 a[68:71], v[48:51], a[112:115], a[68:71]
    s_add_u32 m0, s93, 31744
    s_add_u32 s87, s73, s43
    buffer_load_dwordx4 v76, s[44:47], s87 offen lds
    s_waitcnt lgkmcnt(10)
    v_mfma_f32_16x16x32_bf16 a[8:11], v[52:55], a[104:107], a[8:11]
    v_mfma_f32_16x16x32_bf16 a[40:43], v[52:55], a[108:111], a[40:43]
    v_mfma_f32_16x16x32_bf16 a[72:75], v[52:55], a[112:115], a[72:75]
    s_add_u32 m0, s93, 32768
    s_add_u32 s87, s74, s43
    buffer_load_dwordx4 v76, s[44:47], s87 offen lds
    s_waitcnt lgkmcnt(8)
    v_mfma_f32_16x16x32_bf16 a[12:15], v[56:59], a[104:107], a[12:15]
    v_mfma_f32_16x16x32_bf16 a[44:47], v[56:59], a[108:111], a[44:47]
    v_mfma_f32_16x16x32_bf16 a[76:79], v[56:59], a[112:115], a[76:79]
    s_mov_b32 m0, 43008
    s_add_u32 s87, s75, s43
    s_mov_b64 exec, s[94:95]
    buffer_load_dwordx4 v76, s[44:47], s87 offen lds
    s_mov_b64 exec, -1
    s_waitcnt lgkmcnt(6)
    v_mfma_f32_16x16x32_bf16 a[16:19], v[60:63], a[104:107], a[16:19]
    v_mfma_f32_16x16x32_bf16 a[48:51], v[60:63], a[108:111], a[48:51]
    v_mfma_f32_16x16x32_bf16 a[80:83], v[60:63], a[112:115], a[80:83]
    s_waitcnt vmcnt(6)
    s_waitcnt lgkmcnt(0)
    s_barrier
    ds_read_b128 a[132:135], v78 offset:0
    ds_read_b128 a[120:123], v77 offset:0
    ds_read_b128 a[124:127], v77 offset:1024
    ds_read_b128 a[128:131], v77 offset:2048
    ds_read_b64_tr_b16 v[36:37], v10 offset:0
    ds_read_b64_tr_b16 v[38:39], v10 offset:1024
    ds_read_b64_tr_b16 v[40:41], v6 offset:0
    ds_read_b64_tr_b16 v[42:43], v6 offset:1024
    v_mfma_f32_16x16x32_bf16 a[20:23], v[64:67], a[104:107], a[20:23]
    v_mfma_f32_16x16x32_bf16 a[52:55], v[64:67], a[108:111], a[52:55]
    v_mfma_f32_16x16x32_bf16 a[84:87], v[64:67], a[112:115], a[84:87]
    ds_read_b64_tr_b16 v[44:45], v11 offset:0
    ds_read_b64_tr_b16 v[46:47], v11 offset:1024
    ds_read_b64_tr_b16 v[48:49], v7 offset:0
    ds_read_b64_tr_b16 v[50:51], v7 offset:1024
    v_mfma_f32_16x16x32_bf16 a[24:27], v[68:71], a[104:107], a[24:27]
    v_mfma_f32_16x16x32_bf16 a[56:59], v[68:71], a[108:111], a[56:59]
    v_mfma_f32_16x16x32_bf16 a[88:91], v[68:71], a[112:115], a[88:91]
    ds_read_b64_tr_b16 v[52:53], v8 offset:0
    ds_read_b64_tr_b16 v[54:55], v8 offset:1024
    ds_read_b64_tr_b16 v[56:57], v9 offset:0
    ds_read_b64_tr_b16 v[58:59], v9 offset:1024
    v_mfma_f32_16x16x32_bf16 a[28:31], v[72:75], a[104:107], a[28:31]
    v_mfma_f32_16x16x32_bf16 a[60:63], v[72:75], a[108:111], a[60:63]
    v_mfma_f32_16x16x32_bf16 a[92:95], v[72:75], a[112:115], a[92:95]
    ds_read_b64_tr_b16 v[60:61], v6 offset:128
    ds_read_b64_tr_b16 v[62:63], v6 offset:1152
    s_waitcnt lgkmcnt(12)
    v_mfma_f32_16x16x32_bf16 a[96:99], v[36:39], a[132:135], a[96:99]
    s_add_u32 s43, s101, 11
    s_and_b32 s43, s43, 15
    s_lshl_b32 s42, s43, 18
    s_add_u32 s42, s42, s77
    s_lshl_b32 s43, s43, 6
    s_add_u32 m0, s76, 44032
    s_nop 0
    buffer_load_dwordx4 v3, s[56:59], s42 offen lds
    ds_read_b64_tr_b16 v[64:65], v7 offset:128
    ds_read_b64_tr_b16 v[66:67], v7 offset:1152
    s_waitcnt lgkmcnt(12)
    v_mfma_f32_16x16x32_bf16 a[0:3], v[40:43], a[120:123], a[0:3]
    v_mfma_f32_16x16x32_bf16 a[32:35], v[40:43], a[124:127], a[32:35]
    v_mfma_f32_16x16x32_bf16 a[64:67], v[40:43], a[128:131], a[64:67]
    s_add_u32 m0, s76, 45056
    s_add_u32 s42, s42, 32768
    buffer_load_dwordx4 v3, s[56:59], s42 offen lds
    ds_read_b64_tr_b16 v[68:69], v8 offset:128
    ds_read_b64_tr_b16 v[70:71], v8 offset:1152
    s_waitcnt lgkmcnt(12)
    v_mfma_f32_16x16x32_bf16 a[100:103], v[44:47], a[132:135], a[100:103]
    s_add_u32 m0, s93, 52736
    s_add_u32 s87, s72, s43
    buffer_load_dwordx4 v76, s[44:47], s87 offen lds
    ds_read_b64_tr_b16 v[72:73], v9 offset:128
    ds_read_b64_tr_b16 v[74:75], v9 offset:1152
    s_waitcnt lgkmcnt(12)
    v_mfma_f32_16x16x32_bf16 a[4:7], v[48:51], a[120:123], a[4:7]
    v_mfma_f32_16x16x32_bf16 a[36:39], v[48:51], a[124:127], a[36:39]
    v_mfma_f32_16x16x32_bf16 a[68:71], v[48:51], a[128:131], a[68:71]
    s_add_u32 m0, s93, 53760
    s_add_u32 s87, s73, s43
    buffer_load_dwordx4 v76, s[44:47], s87 offen lds
    s_waitcnt lgkmcnt(10)
    v_mfma_f32_16x16x32_bf16 a[8:11], v[52:55], a[120:123], a[8:11]
    v_mfma_f32_16x16x32_bf16 a[40:43], v[52:55], a[124:127], a[40:43]
    v_mfma_f32_16x16x32_bf16 a[72:75], v[52:55], a[128:131], a[72:75]
    s_add_u32 m0, s93, 54784
    s_add_u32 s87, s74, s43
    buffer_load_dwordx4 v76, s[44:47], s87 offen lds
    s_waitcnt lgkmcnt(8)
    v_mfma_f32_16x16x32_bf16 a[12:15], v[56:59], a[120:123], a[12:15]
    v_mfma_f32_16x16x32_bf16 a[44:47], v[56:59], a[124:127], a[44:47]
    v_mfma_f32_16x16x32_bf16 a[76:79], v[56:59], a[128:131], a[76:79]
    s_mov_b32 m0, 65024
    s_add_u32 s87, s75, s43
    s_mov_b64 exec, s[94:95]
    buffer_load_dwordx4 v76, s[44:47], s87 offen lds
    s_mov_b64 exec, -1
    s_waitcnt lgkmcnt(6)
    v_mfma_f32_16x16x32_bf16 a[16:19], v[60:63], a[120:123], a[16:19]
    v_mfma_f32_16x16x32_bf16 a[48:51], v[60:63], a[124:127], a[48:51]
    v_mfma_f32_16x16x32_bf16 a[80:83], v[60:63], a[128:131], a[80:83]
    s_waitcnt vmcnt(6)
    s_waitcnt lgkmcnt(0)
    s_barrier
    ds_read_b128 a[116:119], v78 offset:22016
    ds_read_b128 a[104:107], v77 offset:22016
    ds_read_b128 a[108:111], v77 offset:23040
    ds_read_b128 a[112:115], v77 offset:24064
    ds_read_b64_tr_b16 v[36:37], v10 offset:22016
    ds_read_b64_tr_b16 v[38:39], v10 offset:23040
    ds_read_b64_tr_b16 v[40:41], v6 offset:22016
    ds_read_b64_tr_b16 v[42:43], v6 offset:23040
    v_mfma_f32_16x16x32_bf16 a[20:23], v[64:67], a[120:123], a[20:23]
    v_mfma_f32_16x16x32_bf16 a[52:55], v[64:67], a[124:127], a[52:55]
    v_mfma_f32_16x16x32_bf16 a[84:87], v[64:67], a[128:131], a[84:87]
    ds_read_b64_tr_b16 v[44:45], v11 offset:22016
    ds_read_b64_tr_b16 v[46:47], v11 offset:23040
    ds_read_b64_tr_b16 v[48:49], v7 offset:22016
    ds_read_b64_tr_b16 v[50:51], v7 offset:23040
    v_mfma_f32_16x16x32_bf16 a[24:27], v[68:71], a[120:123], a[24:27]
    v_mfma_f32_16x16x32_bf16 a[56:59], v[68:71], a[124:127], a[56:59]
    v_mfma_f32_16x16x32_bf16 a[88:91], v[68:71], a[128:131], a[88:91]
    ds_read_b64_tr_b16 v[52:53], v8 offset:22016
    ds_read_b64_tr_b16 v[54:55], v8 offset:23040
    ds_read_b64_tr_b16 v[56:57], v9 offset:22016
    ds_read_b64_tr_b16 v[58:59], v9 offset:23040
    v_mfma_f32_16x16x32_bf16 a[28:31], v[72:75], a[120:123], a[28:31]
    v_mfma_f32_16x16x32_bf16 a[60:63], v[72:75], a[124:127], a[60:63]
    v_mfma_f32_16x16x32_bf16 a[92:95], v[72:75], a[128:131], a[92:95]
    ds_read_b64_tr_b16 v[60:61], v6 offset:22144
    ds_read_b64_tr_b16 v[62:63], v6 offset:23168
    s_waitcnt lgkmcnt(12)
    v_mfma_f32_16x16x32_bf16 a[96:99], v[36:39], a[116:119], a[96:99]
    s_add_u32 s43, s101, 12
    s_and_b32 s43, s43, 15
    s_lshl_b32 s42, s43, 18
    s_add_u32 s42, s42, s77
    s_lshl_b32 s43, s43, 6
    s_add_u32 m0, s76, 0
    s_nop 0
    buffer_load_dwordx4 v3, s[56:59], s42 offen lds
    ds_read_b64_tr_b16 v[64:65], v7 offset:22144
    ds_read_b64_tr_b16 v[66:67], v7 offset:23168
    s_waitcnt lgkmcnt(12)
    v_mfma_f32_16x16x32_bf16 a[0:3], v[40:43], a[104:107], a[0:3]
    v_mfma_f32_16x16x32_bf16 a[32:35], v[40:43], a[108:111], a[32:35]
    v_mfma_f32_16x16x32_bf16 a[64:67], v[40:43], a[112:115], a[64:67]
    s_add_u32 m0, s76, 1024
    s_add_u32 s42, s42, 32768
    buffer_load_dwordx4 v3, s[56:59], s42 offen lds
    ds_read_b64_tr_b16 v[68:69], v8 offset:22144
    ds_read_b64_tr_b16 v[70:71], v8 offset:23168
    s_waitcnt lgkmcnt(12)
    v_mfma_f32_16x16x32_bf16 a[100:103], v[44:47], a[116:119], a[100:103]
    s_add_u32 m0, s93, 8704
    s_add_u32 s87, s72, s43
    buffer_load_dwordx4 v76, s[44:47], s87 offen lds
    ds_read_b64_tr_b16 v[72:73], v9 offset:22144
    ds_read_b64_tr_b16 v[74:75], v9 offset:23168
    s_waitcnt lgkmcnt(12)
    v_mfma_f32_16x16x32_bf16 a[4:7], v[48:51], a[104:107], a[4:7]
    v_mfma_f32_16x16x32_bf16 a[36:39], v[48:51], a[108:111], a[36:39]
    v_mfma_f32_16x16x32_bf16 a[68:71], v[48:51], a[112:115], a[68:71]
    s_add_u32 m0, s93, 9728
    s_add_u32 s87, s73, s43
    buffer_load_dwordx4 v76, s[44:47], s87 offen lds
    s_waitcnt lgkmcnt(10)
    v_mfma_f32_16x16x32_bf16 a[8:11], v[52:55], a[104:107], a[8:11]
    v_mfma_f32_16x16x32_bf16 a[40:43], v[52:55], a[108:111], a[40:43]
    v_mfma_f32_16x16x32_bf16 a[72:75], v[52:55], a[112:115], a[72:75]
    s_add_u32 m0, s93, 10752
    s_add_u32 s87, s74, s43
    buffer_load_dwordx4 v76, s[44:47], s87 offen lds
    s_waitcnt lgkmcnt(8)
    v_mfma_f32_16x16x32_bf16 a[12:15], v[56:59], a[104:107], a[12:15]
    v_mfma_f32_16x16x32_bf16 a[44:47], v[56:59], a[108:111], a[44:47]
    v_mfma_f32_16x16x32_bf16 a[76:79], v[56:59], a[112:115], a[76:79]
    s_mov_b32 m0, 20992
    s_add_u32 s87, s75, s43
    s_mov_b64 exec, s[94:95]
    buffer_load_dwordx4 v76, s[44:47], s87 offen lds
    s_mov_b64 exec, -1
    s_waitcnt lgkmcnt(6)
    v_mfma_f32_16x16x32_bf16 a[16:19], v[60:63], a[104:107], a[16:19]
    v_mfma_f32_16x16x32_bf16 a[48:51], v[60:63], a[108:111], a[48:51]
    v_mfma_f32_16x16x32_bf16 a[80:83], v[60:63], a[112:115], a[80:83]
    s_waitcnt vmcnt(6)
    s_waitcnt lgkmcnt(0)
    s_barrier
    ds_read_b128 a[132:135], v78 offset:44032
    ds_read_b128 a[120:123], v77 offset:44032
    ds_read_b128 a[124:127], v77 offset:45056
    ds_read_b128 a[128:131], v77 offset:46080
    ds_read_b64_tr_b16 v[36:37], v10 offset:44032
    ds_read_b64_tr_b16 v[38:39], v10 offset:45056
    ds_read_b64_tr_b16 v[40:41], v6 offset:44032
    ds_read_b64_tr_b16 v[42:43], v6 offset:45056
    v_mfma_f32_16x16x32_bf16 a[20:23], v[64:67], a[104:107], a[20:23]
    v_mfma_f32_16x16x32_bf16 a[52:55], v[64:67], a[108:111], a[52:55]
    v_mfma_f32_16x16x32_bf16 a[84:87], v[64:67], a[112:115], a[84:87]
    ds_read_b64_tr_b16 v[44:45], v11 offset:44032
    ds_read_b64_tr_b16 v[46:47], v11 offset:45056
    ds_read_b64_tr_b16 v[48:49], v7 offset:44032
    ds_read_b64_tr_b16 v[50:51], v7 offset:45056
    v_mfma_f32_16x16x32_bf16 a[24:27], v[68:71], a[104:107], a[24:27]
    v_mfma_f32_16x16x32_bf16 a[56:59], v[68:71], a[108:111], a[56:59]
    v_mfma_f32_16x16x32_bf16 a[88:91], v[68:71], a[112:115], a[88:91]
    ds_read_b64_tr_b16 v[52:53], v8 offset:44032
    ds_read_b64_tr_b16 v[54:55], v8 offset:45056
    ds_read_b64_tr_b16 v[56:57], v9 offset:44032
    ds_read_b64_tr_b16 v[58:59], v9 offset:45056
    v_mfma_f32_16x16x32_bf16 a[28:31], v[72:75], a[104:107], a[28:31]
    v_mfma_f32_16x16x32_bf16 a[60:63], v[72:75], a[108:111], a[60:63]
    v_mfma_f32_16x16x32_bf16 a[92:95], v[72:75], a[112:115], a[92:95]
    ds_read_b64_tr_b16 v[60:61], v6 offset:44160
    ds_read_b64_tr_b16 v[62:63], v6 offset:45184
    s_waitcnt lgkmcnt(12)
    v_mfma_f32_16x16x32_bf16 a[96:99], v[36:39], a[132:135], a[96:99]
    s_add_u32 s43, s101, 13
    s_and_b32 s43, s43, 15
    s_lshl_b32 s42, s43, 18
    s_add_u32 s42, s42, s77
    s_lshl_b32 s43, s43, 6
    s_add_u32 m0, s76, 22016
    s_nop 0
    buffer_load_dwordx4 v3, s[56:59], s42 offen lds
    ds_read_b64_tr_b16 v[64:65], v7 offset:44160
    ds_read_b64_tr_b16 v[66:67], v7 offset:45184
    s_waitcnt lgkmcnt(12)
    v_mfma_f32_16x16x32_bf16 a[0:3], v[40:43], a[120:123], a[0:3]
    v_mfma_f32_16x16x32_bf16 a[32:35], v[40:43], a[124:127], a[32:35]
    v_mfma_f32_16x16x32_bf16 a[64:67], v[40:43], a[128:131], a[64:67]
    s_add_u32 m0, s76, 23040
    s_add_u32 s42, s42, 32768
    buffer_load_dwordx4 v3, s[56:59], s42 offen lds
    ds_read_b64_tr_b16 v[68:69], v8 offset:44160
    ds_read_b64_tr_b16 v[70:71], v8 offset:45184
    s_waitcnt lgkmcnt(12)
    v_mfma_f32_16x16x32_bf16 a[100:103], v[44:47], a[132:135], a[100:103]
    s_add_u32 m0, s93, 30720
    s_add_u32 s87, s72, s43
    buffer_load_dwordx4 v76, s[44:47], s87 offen lds
    ds_read_b64_tr_b16 v[72:73], v9 offset:44160
    ds_read_b64_tr_b16 v[74:75], v9 offset:45184
    s_waitcnt lgkmcnt(12)
    v_mfma_f32_16x16x32_bf16 a[4:7], v[48:51], a[120:123], a[4:7]
    v_mfma_f32_16x16x32_bf16 a[36:39], v[48:51], a[124:127], a[36:39]
    v_mfma_f32_16x16x32_bf16 a[68:71], v[48:51], a[128:131], a[68:71]
    s_add_u32 m0, s93, 31744
    s_add_u32 s87, s73, s43
    buffer_load_dwordx4 v76, s[44:47], s87 offen lds
    s_waitcnt lgkmcnt(10)
    v_mfma_f32_16x16x32_bf16 a[8:11], v[52:55], a[120:123], a[8:11]
    v_mfma_f32_16x16x32_bf16 a[40:43], v[52:55], a[124:127], a[40:43]
    v_mfma_f32_16x16x32_bf16 a[72:75], v[52:55], a[128:131], a[72:75]
    s_add_u32 m0, s93, 32768
    s_add_u32 s87, s74, s43
    buffer_load_dwordx4 v76, s[44:47], s87 offen lds
    s_waitcnt lgkmcnt(8)
    v_mfma_f32_16x16x32_bf16 a[12:15], v[56:59], a[120:123], a[12:15]
    v_mfma_f32_16x16x32_bf16 a[44:47], v[56:59], a[124:127], a[44:47]
    v_mfma_f32_16x16x32_bf16 a[76:79], v[56:59], a[128:131], a[76:79]
    s_mov_b32 m0, 43008
    s_add_u32 s87, s75, s43
    s_mov_b64 exec, s[94:95]
    buffer_load_dwordx4 v76, s[44:47], s87 offen lds
    s_mov_b64 exec, -1
    s_waitcnt lgkmcnt(6)
    v_mfma_f32_16x16x32_bf16 a[16:19], v[60:63], a[120:123], a[16:19]
    v_mfma_f32_16x16x32_bf16 a[48:51], v[60:63], a[124:127], a[48:51]
    v_mfma_f32_16x16x32_bf16 a[80:83], v[60:63], a[128:131], a[80:83]
    s_waitcnt vmcnt(6)
    s_waitcnt lgkmcnt(0)
    s_barrier
    ds_read_b128 a[116:119], v78 offset:0
    ds_read_b128 a[104:107], v77 offset:0
    ds_read_b128 a[108:111], v77 offset:1024
    ds_read_b128 a[112:115], v77 offset:2048
    ds_read_b64_tr_b16 v[36:37], v10 offset:0
    ds_read_b64_tr_b16 v[38:39], v10 offset:1024
    ds_read_b64_tr_b16 v[40:41], v6 offset:0
    ds_read_b64_tr_b16 v[42:43], v6 offset:1024
    v_mfma_f32_16x16x32_bf16 a[20:23], v[64:67], a[120:123], a[20:23]
    v_mfma_f32_16x16x32_bf16 a[52:55], v[64:67], a[124:127], a[52:55]
    v_mfma_f32_16x16x32_bf16 a[84:87], v[64:67], a[128:131], a[84:87]
    ds_read_b64_tr_b16 v[44:45], v11 offset:0
    ds_read_b64_tr_b16 v[46:47], v11 offset:1024
    ds_read_b64_tr_b16 v[48:49], v7 offset:0
    ds_read_b64_tr_b16 v[50:51], v7 offset:1024
    v_mfma_f32_16x16x32_bf16 a[24:27], v[68:71], a[120:123], a[24:27]
    v_mfma_f32_16x16x32_bf16 a[56:59], v[68:71], a[124:127], a[56:59]
    v_mfma_f32_16x16x32_bf16 a[88:91], v[68:71], a[128:131], a[88:91]
    ds_read_b64_tr_b16 v[52:53], v8 offset:0
    ds_read_b64_tr_b16 v[54:55], v8 offset:1024
    ds_read_b64_tr_b16 v[56:57], v9 offset:0
    ds_read_b64_tr_b16 v[58:59], v9 offset:1024
    v_mfma_f32_16x16x32_bf16 a[28:31], v[72:75], a[120:123], a[28:31]
    v_mfma_f32_16x16x32_bf16 a[60:63], v[72:75], a[124:127], a[60:63]
    v_mfma_f32_16x16x32_bf16 a[92:95], v[72:75], a[128:131], a[92:95]
    ds_read_b64_tr_b16 v[60:61], v6 offset:128
    ds_read_b64_tr_b16 v[62:63], v6 offset:1152
    s_waitcnt lgkmcnt(12)
    v_mfma_f32_16x16x32_bf16 a[96:99], v[36:39], a[116:119], a[96:99]
    s_add_u32 s43, s101, 14
    s_and_b32 s43, s43, 15
    s_lshl_b32 s42, s43, 18
    s_add_u32 s42, s42, s77
    s_lshl_b32 s43, s43, 6
    s_add_u32 m0, s76, 44032
    s_nop 0
    buffer_load_dwordx4 v3, s[56:59], s42 offen lds
    ds_read_b64_tr_b16 v[64:65], v7 offset:128
    ds_read_b64_tr_b16 v[66:67], v7 offset:1152
    s_waitcnt lgkmcnt(12)
    v_mfma_f32_16x16x32_bf16 a[0:3], v[40:43], a[104:107], a[0:3]
    v_mfma_f32_16x16x32_bf16 a[32:35], v[40:43], a[108:111], a[32:35]
    v_mfma_f32_16x16x32_bf16 a[64:67], v[40:43], a[112:115], a[64:67]
    s_add_u32 m0, s76, 45056
    s_add_u32 s42, s42, 32768
    buffer_load_dwordx4 v3, s[56:59], s42 offen lds
    ds_read_b64_tr_b16 v[68:69], v8 offset:128
    ds_read_b64_tr_b16 v[70:71], v8 offset:1152
    s_waitcnt lgkmcnt(12)
    v_mfma_f32_16x16x32_bf16 a[100:103], v[44:47], a[116:119], a[100:103]
    s_add_u32 m0, s93, 52736
    s_add_u32 s87, s72, s43
    buffer_load_dwordx4 v76, s[44:47], s87 offen lds
    ds_read_b64_tr_b16 v[72:73], v9 offset:128
    ds_read_b64_tr_b16 v[74:75], v9 offset:1152
    s_waitcnt lgkmcnt(12)
    v_mfma_f32_16x16x32_bf16 a[4:7], v[48:51], a[104:107], a[4:7]
    v_mfma_f32_16x16x32_bf16 a[36:39], v[48:51], a[108:111], a[36:39]
    v_mfma_f32_16x16x32_bf16 a[68:71], v[48:51], a[112:115], a[68:71]
    s_add_u32 m0, s93, 53760
    s_add_u32 s87, s73, s43
    buffer_load_dwordx4 v76, s[44:47], s87 offen lds
    s_waitcnt lgkmcnt(10)
    v_mfma_f32_16x16x32_bf16 a[8:11], v[52:55], a[104:107], a[8:11]
    v_mfma_f32_16x16x32_bf16 a[40:43], v[52:55], a[108:111], a[40:43]
    v_mfma_f32_16x16x32_bf16 a[72:75], v[52:55], a[112:115], a[72:75]
    s_add_u32 m0, s93, 54784
    s_add_u32 s87, s74, s43
    buffer_load_dwordx4 v76, s[44:47], s87 offen lds
    s_waitcnt lgkmcnt(8)
    v_mfma_f32_16x16x32_bf16 a[12:15], v[56:59], a[104:107], a[12:15]
    v_mfma_f32_16x16x32_bf16 a[44:47], v[56:59], a[108:111], a[44:47]
    v_mfma_f32_16x16x32_bf16 a[76:79], v[56:59], a[112:115], a[76:79]
    s_mov_b32 m0, 65024
    s_add_u32 s87, s75, s43
    s_mov_b64 exec, s[94:95]
    buffer_load_dwordx4 v76, s[44:47], s87 offen lds
    s_mov_b64 exec, -1
    s_waitcnt lgkmcnt(6)
    v_mfma_f32_16x16x32_bf16 a[16:19], v[60:63], a[104:107], a[16:19]
    v_mfma_f32_16x16x32_bf16 a[48:51], v[60:63], a[108:111], a[48:51]
    v_mfma_f32_16x16x32_bf16 a[80:83], v[60:63], a[112:115], a[80:83]
    s_waitcnt vmcnt(6)
    s_waitcnt lgkmcnt(0)
    s_barrier
    ds_read_b128 a[132:135], v78 offset:22016
    ds_read_b128 a[120:123], v77 offset:22016
    ds_read_b128 a[124:127], v77 offset:23040
    ds_read_b128 a[128:131], v77 offset:24064
    ds_read_b64_tr_b16 v[36:37], v10 offset:22016
    ds_read_b64_tr_b16 v[38:39], v10 offset:23040
    ds_read_b64_tr_b16 v[40:41], v6 offset:22016
    ds_read_b64_tr_b16 v[42:43], v6 offset:23040
    v_mfma_f32_16x16x32_bf16 a[20:23], v[64:67], a[104:107], a[20:23]
    v_mfma_f32_16x16x32_bf16 a[52:55], v[64:67], a[108:111], a[52:55]
    v_mfma_f32_16x16x32_bf16 a[84:87], v[64:67], a[112:115], a[84:87]
    ds_read_b64_tr_b16 v[44:45], v11 offset:22016
    ds_read_b64_tr_b16 v[46:47], v11 offset:23040
    ds_read_b64_tr_b16 v[48:49], v7 offset:22016
    ds_read_b64_tr_b16 v[50:51], v7 offset:23040
    v_mfma_f32_16x16x32_bf16 a[24:27], v[68:71], a[104:107], a[24:27]
    v_mfma_f32_16x16x32_bf16 a[56:59], v[68:71], a[108:111], a[56:59]
    v_mfma_f32_16x16x32_bf16 a[88:91], v[68:71], a[112:115], a[88:91]
    ds_read_b64_tr_b16 v[52:53], v8 offset:22016
    ds_read_b64_tr_b16 v[54:55], v8 offset:23040
    ds_read_b64_tr_b16 v[56:57], v9 offset:22016
    ds_read_b64_tr_b16 v[58:59], v9 offset:23040
    v_mfma_f32_16x16x32_bf16 a[28:31], v[72:75], a[104:107], a[28:31]
    v_mfma_f32_16x16x32_bf16 a[60:63], v[72:75], a[108:111], a[60:63]
    v_mfma_f32_16x16x32_bf16 a[92:95], v[72:75], a[112:115], a[92:95]
    ds_read_b64_tr_b16 v[60:61], v6 offset:22144
    ds_read_b64_tr_b16 v[62:63], v6 offset:23168
    s_waitcnt lgkmcnt(12)
    v_mfma_f32_16x16x32_bf16 a[96:99], v[36:39], a[132:135], a[96:99]
    s_add_u32 s43, s101, 15
    s_and_b32 s43, s43, 15
    s_lshl_b32 s42, s43, 18
    s_add_u32 s42, s42, s77
    s_lshl_b32 s43, s43, 6
    s_add_u32 m0, s76, 0
    s_nop 0
    buffer_load_dwordx4 v3, s[56:59], s42 offen lds
    ds_read_b64_tr_b16 v[64:65], v7 offset:22144
    ds_read_b64_tr_b16 v[66:67], v7 offset:23168
    s_waitcnt lgkmcnt(12)
    v_mfma_f32_16x16x32_bf16 a[0:3], v[40:43], a[120:123], a[0:3]
    v_mfma_f32_16x16x32_bf16 a[32:35], v[40:43], a[124:127], a[32:35]
    v_mfma_f32_16x16x32_bf16 a[64:67], v[40:43], a[128:131], a[64:67]
    s_add_u32 m0, s76, 1024
    s_add_u32 s42, s42, 32768
    buffer_load_dwordx4 v3, s[56:59], s42 offen lds
    ds_read_b64_tr_b16 v[68:69], v8 offset:22144
    ds_read_b64_tr_b16 v[70:71], v8 offset:23168
    s_waitcnt lgkmcnt(12)
    v_mfma_f32_16x16x32_bf16 a[100:103], v[44:47], a[132:135], a[100:103]
    s_add_u32 m0, s93, 8704
    s_add_u32 s87, s72, s43
    buffer_load_dwordx4 v76, s[44:47], s87 offen lds
    ds_read_b64_tr_b16 v[72:73], v9 offset:22144
    ds_read_b64_tr_b16 v[74:75], v9 offset:23168
    s_waitcnt lgkmcnt(12)
    v_mfma_f32_16x16x32_bf16 a[4:7], v[48:51], a[120:123], a[4:7]
    v_mfma_f32_16x16x32_bf16 a[36:39], v[48:51], a[124:127], a[36:39]
    v_mfma_f32_16x16x32_bf16 a[68:71], v[48:51], a[128:131], a[68:71]
    s_add_u32 m0, s93, 9728
    s_add_u32 s87, s73, s43
    buffer_load_dwordx4 v76, s[44:47], s87 offen lds
    s_waitcnt lgkmcnt(10)
    v_mfma_f32_16x16x32_bf16 a[8:11], v[52:55], a[120:123], a[8:11]
    v_mfma_f32_16x16x32_bf16 a[40:43], v[52:55], a[124:127], a[40:43]
    v_mfma_f32_16x16x32_bf16 a[72:75], v[52:55], a[128:131], a[72:75]
    s_add_u32 m0, s93, 10752
    s_add_u32 s87, s74, s43
    buffer_load_dwordx4 v76, s[44:47], s87 offen lds
    s_waitcnt lgkmcnt(8)
    v_mfma_f32_16x16x32_bf16 a[12:15], v[56:59], a[120:123], a[12:15]
    v_mfma_f32_16x16x32_bf16 a[44:47], v[56:59], a[124:127], a[44:47]
    v_mfma_f32_16x16x32_bf16 a[76:79], v[56:59], a[128:131], a[76:79]
    s_mov_b32 m0, 20992
    s_add_u32 s87, s75, s43
    s_mov_b64 exec, s[94:95]
    buffer_load_dwordx4 v76, s[44:47], s87 offen lds
    s_mov_b64 exec, -1
    s_waitcnt lgkmcnt(6)
    v_mfma_f32_16x16x32_bf16 a[16:19], v[60:63], a[120:123], a[16:19]
    v_mfma_f32_16x16x32_bf16 a[48:51], v[60:63], a[124:127], a[48:51]
    v_mfma_f32_16x16x32_bf16 a[80:83], v[60:63], a[128:131], a[80:83]
    s_waitcnt vmcnt(6)
    s_waitcnt lgkmcnt(0)
    s_barrier
    ds_read_b128 a[116:119], v78 offset:44032
    ds_read_b128 a[104:107], v77 offset:44032
    ds_read_b128 a[108:111], v77 offset:45056
    ds_read_b128 a[112:115], v77 offset:46080
    ds_read_b64_tr_b16 v[36:37], v10 offset:44032
    ds_read_b64_tr_b16 v[38:39], v10 offset:45056
    ds_read_b64_tr_b16 v[40:41], v6 offset:44032
    ds_read_b64_tr_b16 v[42:43], v6 offset:45056
    v_mfma_f32_16x16x32_bf16 a[20:23], v[64:67], a[120:123], a[20:23]
    v_mfma_f32_16x16x32_bf16 a[52:55], v[64:67], a[124:127], a[52:55]
    v_mfma_f32_16x16x32_bf16 a[84:87], v[64:67], a[128:131], a[84:87]
    ds_read_b64_tr_b16 v[44:45], v11 offset:44032
    ds_read_b64_tr_b16 v[46:47], v11 offset:45056
    ds_read_b64_tr_b16 v[48:49], v7 offset:44032
    ds_read_b64_tr_b16 v[50:51], v7 offset:45056
    v_mfma_f32_16x16x32_bf16 a[24:27], v[68:71], a[120:123], a[24:27]
    v_mfma_f32_16x16x32_bf16 a[56:59], v[68:71], a[124:127], a[56:59]
    v_mfma_f32_16x16x32_bf16 a[88:91], v[68:71], a[128:131], a[88:91]
    ds_read_b64_tr_b16 v[52:53], v8 offset:44032
    ds_read_b64_tr_b16 v[54:55], v8 offset:45056
    ds_read_b64_tr_b16 v[56:57], v9 offset:44032
    ds_read_b64_tr_b16 v[58:59], v9 offset:45056
    v_mfma_f32_16x16x32_bf16 a[28:31], v[72:75], a[120:123], a[28:31]
    v_mfma_f32_16x16x32_bf16 a[60:63], v[72:75], a[124:127], a[60:63]
    v_mfma_f32_16x16x32_bf16 a[92:95], v[72:75], a[128:131], a[92:95]
    ds_read_b64_tr_b16 v[60:61], v6 offset:44160
    ds_read_b64_tr_b16 v[62:63], v6 offset:45184
    s_waitcnt lgkmcnt(12)
    v_mfma_f32_16x16x32_bf16 a[96:99], v[36:39], a[116:119], a[96:99]
    ds_read_b64_tr_b16 v[64:65], v7 offset:44160
    ds_read_b64_tr_b16 v[66:67], v7 offset:45184
    s_waitcnt lgkmcnt(12)
    v_mfma_f32_16x16x32_bf16 a[0:3], v[40:43], a[104:107], a[0:3]
    v_mfma_f32_16x16x32_bf16 a[32:35], v[40:43], a[108:111], a[32:35]
    v_mfma_f32_16x16x32_bf16 a[64:67], v[40:43], a[112:115], a[64:67]
    ds_read_b64_tr_b16 v[68:69], v8 offset:44160
    ds_read_b64_tr_b16 v[70:71], v8 offset:45184
    s_waitcnt lgkmcnt(12)
    v_mfma_f32_16x16x32_bf16 a[100:103], v[44:47], a[116:119], a[100:103]
    ds_read_b64_tr_b16 v[72:73], v9 offset:44160
    ds_read_b64_tr_b16 v[74:75], v9 offset:45184
    s_waitcnt lgkmcnt(12)
    v_mfma_f32_16x16x32_bf16 a[4:7], v[48:51], a[104:107], a[4:7]
    v_mfma_f32_16x16x32_bf16 a[36:39], v[48:51], a[108:111], a[36:39]
    v_mfma_f32_16x16x32_bf16 a[68:71], v[48:51], a[112:115], a[68:71]
    s_waitcnt lgkmcnt(10)
    v_mfma_f32_16x16x32_bf16 a[8:11], v[52:55], a[104:107], a[8:11]
    v_mfma_f32_16x16x32_bf16 a[40:43], v[52:55], a[108:111], a[40:43]
    v_mfma_f32_16x16x32_bf16 a[72:75], v[52:55], a[112:115], a[72:75]
    s_waitcnt lgkmcnt(8)
    v_mfma_f32_16x16x32_bf16 a[12:15], v[56:59], a[104:107], a[12:15]
    v_mfma_f32_16x16x32_bf16 a[44:47], v[56:59], a[108:111], a[44:47]
    v_mfma_f32_16x16x32_bf16 a[76:79], v[56:59], a[112:115], a[76:79]
    s_waitcnt lgkmcnt(6)
    v_mfma_f32_16x16x32_bf16 a[16:19], v[60:63], a[104:107], a[16:19]
    v_mfma_f32_16x16x32_bf16 a[48:51], v[60:63], a[108:111], a[48:51]
    v_mfma_f32_16x16x32_bf16 a[80:83], v[60:63], a[112:115], a[80:83]
    s_waitcnt vmcnt(0)
    s_waitcnt lgkmcnt(0)
    s_barrier
    ds_read_b128 a[132:135], v78 offset:0
    ds_read_b128 a[120:123], v77 offset:0
    ds_read_b128 a[124:127], v77 offset:1024
    ds_read_b128 a[128:131], v77 offset:2048
    ds_read_b64_tr_b16 v[36:37], v10 offset:0
    ds_read_b64_tr_b16 v[38:39], v10 offset:1024
    ds_read_b64_tr_b16 v[40:41], v6 offset:0
    ds_read_b64_tr_b16 v[42:43], v6 offset:1024
    v_mfma_f32_16x16x32_bf16 a[20:23], v[64:67], a[104:107], a[20:23]
    v_mfma_f32_16x16x32_bf16 a[52:55], v[64:67], a[108:111], a[52:55]
    v_mfma_f32_16x16x32_bf16 a[84:87], v[64:67], a[112:115], a[84:87]
    ds_read_b64_tr_b16 v[44:45], v11 offset:0
    ds_read_b64_tr_b16 v[46:47], v11 offset:1024
    ds_read_b64_tr_b16 v[48:49], v7 offset:0
    ds_read_b64_tr_b16 v[50:51], v7 offset:1024
    v_mfma_f32_16x16x32_bf16 a[24:27], v[68:71], a[104:107], a[24:27]
    v_mfma_f32_16x16x32_bf16 a[56:59], v[68:71], a[108:111], a[56:59]
    v_mfma_f32_16x16x32_bf16 a[88:91], v[68:71], a[112:115], a[88:91]
    ds_read_b64_tr_b16 v[52:53], v8 offset:0
    ds_read_b64_tr_b16 v[54:55], v8 offset:1024
    ds_read_b64_tr_b16 v[56:57], v9 offset:0
    ds_read_b64_tr_b16 v[58:59], v9 offset:1024
    v_mfma_f32_16x16x32_bf16 a[28:31], v[72:75], a[104:107], a[28:31]
    v_mfma_f32_16x16x32_bf16 a[60:63], v[72:75], a[108:111], a[60:63]
    v_mfma_f32_16x16x32_bf16 a[92:95], v[72:75], a[112:115], a[92:95]
    ds_read_b64_tr_b16 v[60:61], v6 offset:128
    ds_read_b64_tr_b16 v[62:63], v6 offset:1152
    s_waitcnt lgkmcnt(12)
    v_mfma_f32_16x16x32_bf16 a[96:99], v[36:39], a[132:135], a[96:99]
    s_add_u32 m0, s78, 36864
    s_nop 0
    buffer_load_dwordx4 v2, s[48:51], s79 offen lds
    ds_read_b64_tr_b16 v[64:65], v7 offset:128
    ds_read_b64_tr_b16 v[66:67], v7 offset:1152
    s_waitcnt lgkmcnt(12)
    v_mfma_f32_16x16x32_bf16 a[0:3], v[40:43], a[120:123], a[0:3]
    v_mfma_f32_16x16x32_bf16 a[32:35], v[40:43], a[124:127], a[32:35]
    v_mfma_f32_16x16x32_bf16 a[64:67], v[40:43], a[128:131], a[64:67]
    s_add_u32 m0, s78, 36992
    s_nop 0
    buffer_load_dwordx4 v2, s[48:51], s79 offen offset:1024 lds
    ds_read_b64_tr_b16 v[68:69], v8 offset:128
    ds_read_b64_tr_b16 v[70:71], v8 offset:1152
    s_waitcnt lgkmcnt(12)
    v_mfma_f32_16x16x32_bf16 a[100:103], v[44:47], a[132:135], a[100:103]
    s_add_u32 m0, s78, 37120
    s_nop 0
    buffer_load_dwordx4 v2, s[48:51], s79 offen offset:2048 lds
    ds_read_b64_tr_b16 v[72:73], v9 offset:128
    ds_read_b64_tr_b16 v[74:75], v9 offset:1152
    s_waitcnt lgkmcnt(12)
    v_mfma_f32_16x16x32_bf16 a[4:7], v[48:51], a[120:123], a[4:7]
    v_mfma_f32_16x16x32_bf16 a[36:39], v[48:51], a[124:127], a[36:39]
    v_mfma_f32_16x16x32_bf16 a[68:71], v[48:51], a[128:131], a[68:71]
    s_add_u32 m0, s78, 37248
    s_nop 0
    buffer_load_dwordx4 v2, s[48:51], s79 offen offset:3072 lds
    s_waitcnt lgkmcnt(10)
    v_mfma_f32_16x16x32_bf16 a[8:11], v[52:55], a[120:123], a[8:11]
    v_mfma_f32_16x16x32_bf16 a[40:43], v[52:55], a[124:127], a[40:43]
    v_mfma_f32_16x16x32_bf16 a[72:75], v[52:55], a[128:131], a[72:75]
    s_add_u32 m0, s78, 55296
    s_nop 0
    buffer_load_dwordx4 v2, s[52:55], s79 offen lds
    s_waitcnt lgkmcnt(8)
    v_mfma_f32_16x16x32_bf16 a[12:15], v[56:59], a[120:123], a[12:15]
    v_mfma_f32_16x16x32_bf16 a[44:47], v[56:59], a[124:127], a[44:47]
    v_mfma_f32_16x16x32_bf16 a[76:79], v[56:59], a[128:131], a[76:79]
    s_add_u32 m0, s78, 55424
    s_nop 0
    buffer_load_dwordx4 v2, s[52:55], s79 offen offset:1024 lds
    s_waitcnt lgkmcnt(6)
    v_mfma_f32_16x16x32_bf16 a[16:19], v[60:63], a[120:123], a[16:19]
    v_mfma_f32_16x16x32_bf16 a[48:51], v[60:63], a[124:127], a[48:51]
    v_mfma_f32_16x16x32_bf16 a[80:83], v[60:63], a[128:131], a[80:83]
    s_add_u32 m0, s78, 55552
    s_nop 0
    buffer_load_dwordx4 v2, s[52:55], s79 offen offset:2048 lds
    s_waitcnt lgkmcnt(4)
    v_mfma_f32_16x16x32_bf16 a[20:23], v[64:67], a[120:123], a[20:23]
    v_mfma_f32_16x16x32_bf16 a[52:55], v[64:67], a[124:127], a[52:55]
    v_mfma_f32_16x16x32_bf16 a[84:87], v[64:67], a[128:131], a[84:87]
    s_add_u32 m0, s78, 55680
    s_nop 0
    buffer_load_dwordx4 v2, s[52:55], s79 offen offset:3072 lds
    s_add_u32 s79, s79, 16384
    s_waitcnt lgkmcnt(2)
    v_mfma_f32_16x16x32_bf16 a[24:27], v[68:71], a[120:123], a[24:27]
    v_mfma_f32_16x16x32_bf16 a[56:59], v[68:71], a[124:127], a[56:59]
    v_mfma_f32_16x16x32_bf16 a[88:91], v[68:71], a[128:131], a[88:91]
    s_waitcnt lgkmcnt(0)
    v_mfma_f32_16x16x32_bf16 a[28:31], v[72:75], a[120:123], a[28:31]
    v_mfma_f32_16x16x32_bf16 a[60:63], v[72:75], a[124:127], a[60:63]
    v_mfma_f32_16x16x32_bf16 a[92:95], v[72:75], a[128:131], a[92:95]
    s_nop 7
    v_accvgpr_read_b32 v36, a96
    v_accvgpr_read_b32 v37, a97
    v_accvgpr_read_b32 v38, a98
    v_accvgpr_read_b32 v39, a99
    v_accvgpr_read_b32 v40, a100
    v_accvgpr_read_b32 v41, a101
    v_accvgpr_read_b32 v42, a102
    v_accvgpr_read_b32 v43, a103
    v_mul_f32 v36, s82, v36
    v_mul_f32 v37, s82, v37
    v_mul_f32 v38, s82, v38
    v_mul_f32 v39, s82, v39
    v_mul_f32 v40, s82, v40
    v_mul_f32 v41, s82, v41
    v_mul_f32 v42, s82, v42
    v_mul_f32 v43, s82, v43
    v_cvt_pk_bf16_f32 v52, v36, v37
    v_cvt_pk_bf16_f32 v53, v38, v39
    v_cvt_pk_bf16_f32 v54, v40, v41
    v_cvt_pk_bf16_f32 v55, v42, v43
    s_nop 1
    v_permlane32_swap_b32 v52, v54
    v_permlane32_swap_b32 v53, v55
    v_accvgpr_read_b32 v44, a0
    v_accvgpr_read_b32 v45, a1
    v_accvgpr_read_b32 v46, a2
    v_accvgpr_read_b32 v47, a3
    v_accvgpr_read_b32 v48, a4
    v_accvgpr_read_b32 v49, a5
    v_accvgpr_read_b32 v50, a6
    v_accvgpr_read_b32 v51, a7
    v_mul_f32 v44, s82, v44
    v_mul_f32 v45, s82, v45
    v_mul_f32 v46, s82, v46
    v_mul_f32 v47, s82, v47
    v_mul_f32 v48, s82, v48
    v_mul_f32 v49, s82, v49
    v_mul_f32 v50, s82, v50
    v_mul_f32 v51, s82, v51
    v_cvt_pk_bf16_f32 v56, v44, v45
    v_cvt_pk_bf16_f32 v57, v46, v47
    v_cvt_pk_bf16_f32 v58, v48, v49
    v_cvt_pk_bf16_f32 v59, v50, v51
    v_permlane16_swap_b32 v52, v54
    v_permlane16_swap_b32 v53, v55
    s_lshl_b32 s87, s71, 10
    s_add_u32 s87, s87, 73728
    v_add_u32 v33, s87, v1
    ds_write_b128 v33, v[52:55]
    v_permlane32_swap_b32 v56, v58
    v_permlane32_swap_b32 v57, v59
    v_accvgpr_read_b32 v36, a8
    v_accvgpr_read_b32 v37, a9
    v_accvgpr_read_b32 v38, a10
    v_accvgpr_read_b32 v39, a11
    v_accvgpr_read_b32 v40, a12
    v_accvgpr_read_b32 v41, a13
    v_accvgpr_read_b32 v42, a14
    v_accvgpr_read_b32 v43, a15
    v_mul_f32 v36, s82, v36
    v_mul_f32 v37, s82, v37
    v_mul_f32 v38, s82, v38
    v_mul_f32 v39, s82, v39
    v_mul_f32 v40, s82, v40
    v_mul_f32 v41, s82, v41
    v_mul_f32 v42, s82, v42
    v_mul_f32 v43, s82, v43
    v_cvt_pk_bf16_f32 v60, v36, v37
    v_cvt_pk_bf16_f32 v61, v38, v39
    v_cvt_pk_bf16_f32 v62, v40, v41
    v_cvt_pk_bf16_f32 v63, v42, v43
    v_permlane16_swap_b32 v56, v58
    v_permlane16_swap_b32 v57, v59
    v_accvgpr_write_b32 a128, v56
    v_accvgpr_write_b32 a129, v57
    v_accvgpr_write_b32 a130, v58
    v_accvgpr_write_b32 a131, v59
    v_permlane32_swap_b32 v60, v62
    v_permlane32_swap_b32 v61, v63
    v_accvgpr_read_b32 v44, a16
    v_accvgpr_read_b32 v45, a17
    v_accvgpr_read_b32 v46, a18
    v_accvgpr_read_b32 v47, a19
    v_accvgpr_read_b32 v48, a20
    v_accvgpr_read_b32 v49, a21
    v_accvgpr_read_b32 v50, a22
    v_accvgpr_read_b32 v51, a23
    v_mul_f32 v44, s82, v44
    v_mul_f32 v45, s82, v45
    v_mul_f32 v46, s82, v46
    v_mul_f32 v47, s82, v47
    v_mul_f32 v48, s82, v48
    v_mul_f32 v49, s82, v49
    v_mul_f32 v50, s82, v50
    v_mul_f32 v51, s82, v51
    v_cvt_pk_bf16_f32 v52, v44, v45
    v_cvt_pk_bf16_f32 v53, v46, v47
    v_cvt_pk_bf16_f32 v54, v48, v49
    v_cvt_pk_bf16_f32 v55, v50, v51
    v_permlane16_swap_b32 v60, v62
    v_permlane16_swap_b32 v61, v63
    v_accvgpr_write_b32 a132, v60
    v_accvgpr_write_b32 a133, v61
    v_accvgpr_write_b32 a134, v62
    v_accvgpr_write_b32 a135, v63
    v_permlane32_swap_b32 v52, v54
    v_permlane32_swap_b32 v53, v55
    v_accvgpr_read_b32 v36, a24
    v_accvgpr_read_b32 v37, a25
    v_accvgpr_read_b32 v38, a26
    v_accvgpr_read_b32 v39, a27
    v_accvgpr_read_b32 v40, a28
    v_accvgpr_read_b32 v41, a29
    v_accvgpr_read_b32 v42, a30
    v_accvgpr_read_b32 v43, a31
    v_mul_f32 v36, s82, v36
    v_mul_f32 v37, s82, v37
    v_mul_f32 v38, s82, v38
    v_mul_f32 v39, s82, v39
    v_mul_f32 v40, s82, v40
    v_mul_f32 v41, s82, v41
    v_mul_f32 v42, s82, v42
    v_mul_f32 v43, s82, v43
    v_cvt_pk_bf16_f32 v56, v36, v37
    v_cvt_pk_bf16_f32 v57, v38, v39
    v_cvt_pk_bf16_f32 v58, v40, v41
    v_cvt_pk_bf16_f32 v59, v42, v43
    v_permlane16_swap_b32 v52, v54
    v_permlane16_swap_b32 v53, v55
    v_accvgpr_write_b32 a136, v52
    v_accvgpr_write_b32 a137, v53
    v_accvgpr_write_b32 a138, v54
    v_accvgpr_write_b32 a139, v55
    v_permlane32_swap_b32 v56, v58
    v_permlane32_swap_b32 v57, v59
    v_accvgpr_read_b32 v44, a32
    v_accvgpr_read_b32 v45, a33
    v_accvgpr_read_b32 v46, a34
    v_accvgpr_read_b32 v47, a35
    v_accvgpr_read_b32 v48, a36
    v_accvgpr_read_b32 v49, a37
    v_accvgpr_read_b32 v50, a38
    v_accvgpr_read_b32 v51, a39
    v_mul_f32 v44, s82, v44
    v_mul_f32 v45, s82, v45
    v_mul_f32 v46, s82, v46
    v_mul_f32 v47, s82, v47
    v_mul_f32 v48, s82, v48
    v_mul_f32 v49, s82, v49
    v_mul_f32 v50, s82, v50
    v_mul_f32 v51, s82, v51
    v_cvt_pk_bf16_f32 v60, v44, v45
    v_cvt_pk_bf16_f32 v61, v46, v47
    v_cvt_pk_bf16_f32 v62, v48, v49
    v_cvt_pk_bf16_f32 v63, v50, v51
    v_permlane16_swap_b32 v56, v58
    v_permlane16_swap_b32 v57, v59
    v_accvgpr_write_b32 a140, v56
    v_accvgpr_write_b32 a141, v57
    v_accvgpr_write_b32 a142, v58
    v_accvgpr_write_b32 a143, v59
    v_permlane32_swap_b32 v60, v62
    v_permlane32_swap_b32 v61, v63
    v_accvgpr_read_b32 v36, a40
    v_accvgpr_read_b32 v37, a41
    v_accvgpr_read_b32 v38, a42
    v_accvgpr_read_b32 v39, a43
    v_accvgpr_read_b32 v40, a44
    v_accvgpr_read_b32 v41, a45
    v_accvgpr_read_b32 v42, a46
    v_accvgpr_read_b32 v43, a47
    v_mul_f32 v36, s82, v36
    v_mul_f32 v37, s82, v37
    v_mul_f32 v38, s82, v38
    v_mul_f32 v39, s82, v39
    v_mul_f32 v40, s82, v40
    v_mul_f32 v41, s82, v41
    v_mul_f32 v42, s82, v42
    v_mul_f32 v43, s82, v43
    v_cvt_pk_bf16_f32 v52, v36, v37
    v_cvt_pk_bf16_f32 v53, v38, v39
    v_cvt_pk_bf16_f32 v54, v40, v41
    v_cvt_pk_bf16_f32 v55, v42, v43
    v_permlane16_swap_b32 v60, v62
    v_permlane16_swap_b32 v61, v63
    v_accvgpr_write_b32 a144, v60
    v_accvgpr_write_b32 a145, v61
    v_accvgpr_write_b32 a146, v62
    v_accvgpr_write_b32 a147, v63
    v_permlane32_swap_b32 v52, v54
    v_permlane32_swap_b32 v53, v55
    v_accvgpr_read_b32 v44, a48
    v_accvgpr_read_b32 v45, a49
    v_accvgpr_read_b32 v46, a50
    v_accvgpr_read_b32 v47, a51
    v_accvgpr_read_b32 v48, a52
    v_accvgpr_read_b32 v49, a53
    v_accvgpr_read_b32 v50, a54
    v_accvgpr_read_b32 v51, a55
    v_mul_f32 v44, s82, v44
    v_mul_f32 v45, s82, v45
    v_mul_f32 v46, s82, v46
    v_mul_f32 v47, s82, v47
    v_mul_f32 v48, s82, v48
    v_mul_f32 v49, s82, v49
    v_mul_f32 v50, s82, v50
    v_mul_f32 v51, s82, v51
    v_cvt_pk_bf16_f32 v56, v44, v45
    v_cvt_pk_bf16_f32 v57, v46, v47
    v_cvt_pk_bf16_f32 v58, v48, v49
    v_cvt_pk_bf16_f32 v59, v50, v51
    v_permlane16_swap_b32 v52, v54
    v_permlane16_swap_b32 v53, v55
    v_accvgpr_write_b32 a148, v52
    v_accvgpr_write_b32 a149, v53
    v_accvgpr_write_b32 a150, v54
    v_accvgpr_write_b32 a151, v55
    v_permlane32_swap_b32 v56, v58
    v_permlane32_swap_b32 v57, v59
    v_accvgpr_read_b32 v36, a56
    v_accvgpr_read_b32 v37, a57
    v_accvgpr_read_b32 v38, a58
    v_accvgpr_read_b32 v39, a59
    v_accvgpr_read_b32 v40, a60
    v_accvgpr_read_b32 v41, a61
    v_accvgpr_read_b32 v42, a62
    v_accvgpr_read_b32 v43, a63
    v_mul_f32 v36, s82, v36
    v_mul_f32 v37, s82, v37
    v_mul_f32 v38, s82, v38
    v_mul_f32 v39, s82, v39
    v_mul_f32 v40, s82, v40
    v_mul_f32 v41, s82, v41
    v_mul_f32 v42, s82, v42
    v_mul_f32 v43, s82, v43
    v_cvt_pk_bf16_f32 v60, v36, v37
    v_cvt_pk_bf16_f32 v61, v38, v39
    v_cvt_pk_bf16_f32 v62, v40, v41
    v_cvt_pk_bf16_f32 v63, v42, v43
    v_permlane16_swap_b32 v56, v58
    v_permlane16_swap_b32 v57, v59
    v_accvgpr_write_b32 a152, v56
    v_accvgpr_write_b32 a153, v57
    v_accvgpr_write_b32 a154, v58
    v_accvgpr_write_b32 a155, v59
    v_permlane32_swap_b32 v60, v62
    v_permlane32_swap_b32 v61, v63
    v_accvgpr_read_b32 v44, a64
    v_accvgpr_read_b32 v45, a65
    v_accvgpr_read_b32 v46, a66
    v_accvgpr_read_b32 v47, a67
    v_accvgpr_read_b32 v48, a68
    v_accvgpr_read_b32 v49, a69
    v_accvgpr_read_b32 v50, a70
    v_accvgpr_read_b32 v51, a71
    v_mul_f32 v44, s82, v44
    v_mul_f32 v45, s82, v45
    v_mul_f32 v46, s82, v46
    v_mul_f32 v47, s82, v47
    v_mul_f32 v48, s82, v48
    v_mul_f32 v49, s82, v49
    v_mul_f32 v50, s82, v50
    v_mul_f32 v51, s82, v51
    v_cvt_pk_bf16_f32 v52, v44, v45
    v_cvt_pk_bf16_f32 v53, v46, v47
    v_cvt_pk_bf16_f32 v54, v48, v49
    v_cvt_pk_bf16_f32 v55, v50, v51
    v_permlane16_swap_b32 v60, v62
    v_permlane16_swap_b32 v61, v63
    v_accvgpr_write_b32 a156, v60
    v_accvgpr_write_b32 a157, v61
    v_accvgpr_write_b32 a158, v62
    v_accvgpr_write_b32 a159, v63
    v_permlane32_swap_b32 v52, v54
    v_permlane32_swap_b32 v53, v55
    v_accvgpr_read_b32 v36, a72
    v_accvgpr_read_b32 v37, a73
    v_accvgpr_read_b32 v38, a74
    v_accvgpr_read_b32 v39, a75
    v_accvgpr_read_b32 v40, a76
    v_accvgpr_read_b32 v41, a77
    v_accvgpr_read_b32 v42, a78
    v_accvgpr_read_b32 v43, a79
    v_mul_f32 v36, s82, v36
    v_mul_f32 v37, s82, v37
    v_mul_f32 v38, s82, v38
    v_mul_f32 v39, s82, v39
    v_mul_f32 v40, s82, v40
    v_mul_f32 v41, s82, v41
    v_mul_f32 v42, s82, v42
    v_mul_f32 v43, s82, v43
    v_cvt_pk_bf16_f32 v56, v36, v37
    v_cvt_pk_bf16_f32 v57, v38, v39
    v_cvt_pk_bf16_f32 v58, v40, v41
    v_cvt_pk_bf16_f32 v59, v42, v43
    v_permlane16_swap_b32 v52, v54
    v_permlane16_swap_b32 v53, v55
    v_accvgpr_write_b32 a160, v52
    v_accvgpr_write_b32 a161, v53
    v_accvgpr_write_b32 a162, v54
    v_accvgpr_write_b32 a163, v55
    v_permlane32_swap_b32 v56, v58
    v_permlane32_swap_b32 v57, v59
    v_accvgpr_read_b32 v44, a80
    v_accvgpr_read_b32 v45, a81
    v_accvgpr_read_b32 v46, a82
    v_accvgpr_read_b32 v47, a83
    v_accvgpr_read_b32 v48, a84
    v_accvgpr_read_b32 v49, a85
    v_accvgpr_read_b32 v50, a86
    v_accvgpr_read_b32 v51, a87
    v_mul_f32 v44, s82, v44
    v_mul_f32 v45, s82, v45
    v_mul_f32 v46, s82, v46
    v_mul_f32 v47, s82, v47
    v_mul_f32 v48, s82, v48
    v_mul_f32 v49, s82, v49
    v_mul_f32 v50, s82, v50
    v_mul_f32 v51, s82, v51
    v_cvt_pk_bf16_f32 v60, v44, v45
    v_cvt_pk_bf16_f32 v61, v46, v47
    v_cvt_pk_bf16_f32 v62, v48, v49
    v_cvt_pk_bf16_f32 v63, v50, v51
    v_permlane16_swap_b32 v56, v58
    v_permlane16_swap_b32 v57, v59
    v_accvgpr_write_b32 a164, v56
    v_accvgpr_write_b32 a165, v57
    v_accvgpr_write_b32 a166, v58
    v_accvgpr_write_b32 a167, v59
    v_permlane32_swap_b32 v60, v62
    v_permlane32_swap_b32 v61, v63
    v_accvgpr_read_b32 v36, a88
    v_accvgpr_read_b32 v37, a89
    v_accvgpr_read_b32 v38, a90
    v_accvgpr_read_b32 v39, a91
    v_accvgpr_read_b32 v40, a92
    v_accvgpr_read_b32 v41, a93
    v_accvgpr_read_b32 v42, a94
    v_accvgpr_read_b32 v43, a95
    v_mul_f32 v36, s82, v36
    v_mul_f32 v37, s82, v37
    v_mul_f32 v38, s82, v38
    v_mul_f32 v39, s82, v39
    v_mul_f32 v40, s82, v40
    v_mul_f32 v41, s82, v41
    v_mul_f32 v42, s82, v42
    v_mul_f32 v43, s82, v43
    v_cvt_pk_bf16_f32 v52, v36, v37
    v_cvt_pk_bf16_f32 v53, v38, v39
    v_cvt_pk_bf16_f32 v54, v40, v41
    v_cvt_pk_bf16_f32 v55, v42, v43
    v_permlane16_swap_b32 v60, v62
    v_permlane16_swap_b32 v61, v63
    v_accvgpr_write_b32 a168, v60
    v_accvgpr_write_b32 a169, v61
    v_accvgpr_write_b32 a170, v62
    v_accvgpr_write_b32 a171, v63
    v_permlane32_swap_b32 v52, v54
    v_permlane32_swap_b32 v53, v55
    s_nop 1
    v_permlane16_swap_b32 v52, v54
    v_permlane16_swap_b32 v53, v55
    v_accvgpr_write_b32 a172, v52
    v_accvgpr_write_b32 a173, v53
    v_accvgpr_write_b32 a174, v54
    v_accvgpr_write_b32 a175, v55
    v_add_u32 v3, 73728, v1
    v_lshlrev_b32 v33, 10, v35
    v_sub_u32 v33, 55296, v33
    v_add_u32 v6, v6, v33
    v_add_u32 v7, v7, v33
    v_add_u32 v8, v8, v33
    v_add_u32 v9, v9, v33
    v_mov_b32 v12, 0
    v_mov_b32 v13, 0
    v_mov_b32 v14, 0
    v_mov_b32 v15, 0
    v_mov_b32 v16, 0
    v_mov_b32 v17, 0
    v_mov_b32 v18, 0
    v_mov_b32 v19, 0
    v_mov_b32 v20, 0
    v_mov_b32 v21, 0
    v_mov_b32 v22, 0
    v_mov_b32 v23, 0
    v_mov_b32 v24, 0
    v_mov_b32 v25, 0
    v_mov_b32 v26, 0
    v_mov_b32 v27, 0
    v_mov_b32 v28, 0
    s_mov_b32 s84, 1
    s_mov_b32 s85, 1
    s_mov_b32 s90, 0x7f800000
    s_mov_b32 s86, 0
    s_mov_b32 s80, 0
    s_mov_b32 s81, -36864
    s_and_b32 s87, s71, 1
    s_lshl_b32 s87, s87, 13
    s_add_u32 s100, s100, s87
    s_cmp_ge_u32 s2, 256
    s_cbranch_scc0 L_pr1
    s_setprio 2
L_pr1:
    s_waitcnt vmcnt(0) lgkmcnt(0)
    s_barrier
    s_add_u32 s88, s78, s80
    ds_read_b128 v[36:39], v4 offset:0
    v_add_u32 v10, s78, v4
    ds_read_b128 v[40:43], v10 offset:0
    ds_read_b128 v[44:47], v3 offset:0
    ds_read_b128 v[48:51], v5 offset:0
L_redo0A:
    s_waitcnt lgkmcnt(3)
    v_mfma_f32_16x16x32_bf16 v[52:55], v[36:39], a[128:131], v[12:15]
    v_mfma_f32_16x16x32_bf16 v[60:63], v[36:39], a[144:147], v[16:19]
    v_mfma_f32_16x16x32_bf16 v[68:71], v[36:39], a[160:163], v[20:23]
    s_add_u32 m0, s88, 0
    s_nop 0
    buffer_load_dwordx4 v2, s[48:51], s79 offen lds
    ds_read_b128 v[36:39], v4 offset:128
    s_waitcnt lgkmcnt(2)
    v_mfma_f32_16x16x32_bf16 v[76:79], v[40:43], v[44:47], 0
    v_add_u32 v11, s78, v5
    ds_read_b128 v[40:43], v11 offset:0
    ds_read_b128 v[44:47], v3 offset:1024
    s_waitcnt lgkmcnt(3)
    v_mfma_f32_16x16x32_bf16 v[52:55], v[48:51], a[132:135], v[52:55]
    v_mfma_f32_16x16x32_bf16 v[60:63], v[48:51], a[148:151], v[60:63]
    v_mfma_f32_16x16x32_bf16 v[68:71], v[48:51], a[164:167], v[68:71]
    s_add_u32 m0, s88, 128
    s_nop 0
    buffer_load_dwordx4 v2, s[48:51], s79 offen offset:1024 lds
    ds_read_b128 v[48:51], v5 offset:128
    s_waitcnt lgkmcnt(3)
    v_mfma_f32_16x16x32_bf16 v[52:55], v[36:39], a[136:139], v[52:55]
    v_mfma_f32_16x16x32_bf16 v[60:63], v[36:39], a[152:155], v[60:63]
    v_mfma_f32_16x16x32_bf16 v[68:71], v[36:39], a[168:171], v[68:71]
    s_add_u32 m0, s88, 256
    s_nop 0
    buffer_load_dwordx4 v2, s[48:51], s79 offen offset:2048 lds
    ds_read_b128 v[36:39], v4 offset:4608
    s_waitcnt lgkmcnt(2)
    v_mfma_f32_16x16x32_bf16 v[76:79], v[40:43], v[44:47], v[76:79]
    v_add_u32 v10, s78, v4
    ds_read_b128 v[40:43], v10 offset:128
    ds_read_b128 v[44:47], v3 offset:2048
    s_waitcnt lgkmcnt(3)
    v_mfma_f32_16x16x32_bf16 v[52:55], v[48:51], a[140:143], v[52:55]
    v_mfma_f32_16x16x32_bf16 v[60:63], v[48:51], a[156:159], v[60:63]
    v_mfma_f32_16x16x32_bf16 v[68:71], v[48:51], a[172:175], v[68:71]
    s_add_u32 m0, s88, 384
    s_nop 0
    buffer_load_dwordx4 v2, s[48:51], s79 offen offset:3072 lds
    ds_read_b128 v[48:51], v5 offset:4608
    s_waitcnt lgkmcnt(3)
    v_mfma_f32_16x16x32_bf16 v[56:59], v[36:39], a[128:131], v[12:15]
    v_mfma_f32_16x16x32_bf16 v[64:67], v[36:39], a[144:147], v[16:19]
    v_mfma_f32_16x16x32_bf16 v[72:75], v[36:39], a[160:163], v[20:23]
    s_add_u32 m0, s88, 18432
    s_nop 0
    buffer_load_dwordx4 v2, s[52:55], s79 offen lds
    ds_read_b128 v[36:39], v4 offset:4736
    s_waitcnt lgkmcnt(2)
    v_mfma_f32_16x16x32_bf16 v[76:79], v[40:43], v[44:47], v[76:79]
    v_add_u32 v11, s78, v5
    ds_read_b128 v[40:43], v11 offset:128
    ds_read_b128 v[44:47], v3 offset:3072
    s_waitcnt lgkmcnt(3)
    v_mfma_f32_16x16x32_bf16 v[56:59], v[48:51], a[132:135], v[56:59]
    v_mfma_f32_16x16x32_bf16 v[64:67], v[48:51], a[148:151], v[64:67]
    v_mfma_f32_16x16x32_bf16 v[72:75], v[48:51], a[164:167], v[72:75]
    s_add_u32 m0, s88, 18560
    s_nop 0
    buffer_load_dwordx4 v2, s[52:55], s79 offen offset:1024 lds
    ds_read_b128 v[48:51], v5 offset:4736
    s_waitcnt lgkmcnt(3)
    v_mfma_f32_16x16x32_bf16 v[56:59], v[36:39], a[136:139], v[56:59]
    v_mfma_f32_16x16x32_bf16 v[64:67], v[36:39], a[152:155], v[64:67]
    v_mfma_f32_16x16x32_bf16 v[72:75], v[36:39], a[168:171], v[72:75]
    s_add_u32 m0, s88, 18688
    s_nop 0
    buffer_load_dwordx4 v2, s[52:55], s79 offen offset:2048 lds
    ds_read_b64_tr_b16 v[36:37], v6 offset:0
    ds_read_b64_tr_b16 v[38:39], v6 offset:4608
    s_waitcnt lgkmcnt(3)
    v_mfma_f32_16x16x32_bf16 v[76:79], v[40:43], v[44:47], v[76:79]
    ds_read_b64_tr_b16 v[40:41], v7 offset:0
    ds_read_b64_tr_b16 v[42:43], v7 offset:4608
    v_add_u32 v10, s78, v6
    ds_read_b64_tr_b16 v[44:45], v10 offset:0
    v_add_u32 v11, s78, v7
    ds_read_b64_tr_b16 v[46:47], v11 offset:0
    s_waitcnt lgkmcnt(6)
    v_mfma_f32_16x16x32_bf16 v[56:59], v[48:51], a[140:143], v[56:59]
    v_mfma_f32_16x16x32_bf16 v[64:67], v[48:51], a[156:159], v[64:67]
    v_mfma_f32_16x16x32_bf16 v[72:75], v[48:51], a[172:175], v[72:75]
    s_add_u32 m0, s88, 18816
    s_nop 0
    buffer_load_dwordx4 v2, s[52:55], s79 offen offset:3072 lds
    ds_read_b64_tr_b16 v[48:49], v8 offset:0
    ds_read_b64_tr_b16 v[50:51], v8 offset:4608
    s_cmp_lg_u32 s84, 0
    s_cbranch_scc1 L_exact0A
L_exret0A:
    v_add_f32 v76, v76, v24
    v_add_f32 v77, v77, v24
    v_add_f32 v78, v78, v24
    v_add_f32 v79, v79, v24
    v_exp_f32 v76, v76
    v_exp_f32 v77, v77
    v_exp_f32 v78, v78
    v_exp_f32 v79, v79
    v_add_f32 v32, v76, v77
    v_add_f32 v32, v32, v78
    v_add_f32 v32, v32, v79
    v_cvt_pk_bf16_f32 v76, v76, v77
    v_cvt_pk_bf16_f32 v77, v78, v79
    v_exp_f32 v52, v52
    v_exp_f32 v53, v53
    v_exp_f32 v54, v54
    v_exp_f32 v55, v55
    v_exp_f32 v56, v56
    v_exp_f32 v57, v57
    v_exp_f32 v58, v58
    v_exp_f32 v59, v59
    v_add_f32 v29, v52, v53
    v_add_f32 v29, v29, v54
    v_add_f32 v29, v29, v55
    v_add_f32 v29, v29, v56
    v_add_f32 v29, v29, v57
    v_add_f32 v29, v29, v58
    v_add_f32 v29, v29, v59
    v_cvt_pk_bf16_f32 v52, v52, v53
    v_cvt_pk_bf16_f32 v53, v54, v55
    v_cvt_pk_bf16_f32 v54, v56, v57
    v_cvt_pk_bf16_f32 v55, v58, v59
    v_exp_f32 v60, v60
    v_exp_f32 v61, v61
    v_exp_f32 v62, v62
    v_exp_f32 v63, v63
    v_exp_f32 v64, v64
    v_exp_f32 v65, v65
    v_exp_f32 v66, v66
    v_exp_f32 v67, v67
    v_add_f32 v30, v60, v61
    v_add_f32 v30, v30, v62
    v_add_f32 v30, v30, v63
    v_add_f32 v30, v30, v64
    v_add_f32 v30, v30, v65
    v_add_f32 v30, v30, v66
    v_add_f32 v30, v30, v67
    v_cvt_pk_bf16_f32 v60, v60, v61
    v_cvt_pk_bf16_f32 v61, v62, v63
    v_cvt_pk_bf16_f32 v62, v64, v65
    v_cvt_pk_bf16_f32 v63, v66, v67
    v_exp_f32 v68, v68
    v_exp_f32 v69, v69
    v_exp_f32 v70, v70
    v_exp_f32 v71, v71
    v_exp_f32 v72, v72
    v_exp_f32 v73, v73
    v_exp_f32 v74, v74
    v_exp_f32 v75, v75
    v_add_f32 v31, v68, v69
    v_add_f32 v31, v31, v70
    v_add_f32 v31, v31, v71
    v_add_f32 v31, v31, v72
    v_add_f32 v31, v31, v73
    v_add_f32 v31, v31, v74
    v_add_f32 v31, v31, v75
    v_cvt_pk_bf16_f32 v68, v68, v69
    v_cvt_pk_bf16_f32 v69, v70, v71
    v_cvt_pk_bf16_f32 v70, v72, v73
    v_cvt_pk_bf16_f32 v71, v74, v75
    v_max3_f32 v33, v29, v30, v31
    v_max_f32 v33, v33, v32
    v_cmp_lt_f32 vcc, s83, v33
    s_cbranch_vccnz L_fix0A
L_fixret0A:
    s_mov_b32 s84, 0
    v_add_f32 v28, v28, v32
    v_add_f32 v25, v25, v29
    v_add_f32 v26, v26, v30
    v_add_f32 v27, v27, v31
    s_waitcnt lgkmcnt(6)
    v_mfma_f32_16x16x32_bf16 a[0:3], v[36:39], v[52:55], 0
    v_mfma_f32_16x16x32_bf16 a[32:35], v[36:39], v[60:63], 0
    v_mfma_f32_16x16x32_bf16 a[64:67], v[36:39], v[68:71], 0
    ds_read_b64_tr_b16 v[36:37], v9 offset:0
    ds_read_b64_tr_b16 v[38:39], v9 offset:4608
    s_waitcnt lgkmcnt(6)
    v_mfma_f32_16x16x32_bf16 a[4:7], v[40:43], v[52:55], 0
    v_mfma_f32_16x16x32_bf16 a[36:39], v[40:43], v[60:63], 0
    v_mfma_f32_16x16x32_bf16 a[68:71], v[40:43], v[68:71], 0
    v_add_u32 v10, s78, v8
    ds_read_b64_tr_b16 v[40:41], v10 offset:0
    v_add_u32 v11, s78, v9
    ds_read_b64_tr_b16 v[42:43], v11 offset:0
    s_waitcnt lgkmcnt(6)
    v_mfma_f32_16x16x16_bf16 a[96:99], v[44:45], v[76:77], 0
    v_mfma_f32_16x16x16_bf16 a[100:103], v[46:47], v[76:77], 0
    ds_read_b64_tr_b16 v[44:45], v6 offset:128
    ds_read_b64_tr_b16 v[46:47], v6 offset:4736
    s_waitcnt lgkmcnt(6)
    v_mfma_f32_16x16x32_bf16 a[8:11], v[48:51], v[52:55], 0
    v_mfma_f32_16x16x32_bf16 a[40:43], v[48:51], v[60:63], 0
    v_mfma_f32_16x16x32_bf16 a[72:75], v[48:51], v[68:71], 0
    ds_read_b64_tr_b16 v[48:49], v7 offset:128
    ds_read_b64_tr_b16 v[50:51], v7 offset:4736
    s_waitcnt lgkmcnt(6)
    v_mfma_f32_16x16x32_bf16 a[12:15], v[36:39], v[52:55], 0
    v_mfma_f32_16x16x32_bf16 a[44:47], v[36:39], v[60:63], 0
    v_mfma_f32_16x16x32_bf16 a[76:79], v[36:39], v[68:71], 0
    v_add_u32 v10, s78, v6
    ds_read_b64_tr_b16 v[36:37], v10 offset:128
    v_add_u32 v11, s78, v7
    ds_read_b64_tr_b16 v[38:39], v11 offset:128
    s_waitcnt lgkmcnt(6)
    v_mfma_f32_16x16x16_bf16 a[104:107], v[40:41], v[76:77], 0
    v_mfma_f32_16x16x16_bf16 a[108:111], v[42:43], v[76:77], 0
    ds_read_b64_tr_b16 v[40:41], v8 offset:128
    ds_read_b64_tr_b16 v[42:43], v8 offset:4736
    s_waitcnt lgkmcnt(6)
    v_mfma_f32_16x16x32_bf16 a[16:19], v[44:47], v[52:55], 0
    v_mfma_f32_16x16x32_bf16 a[48:51], v[44:47], v[60:63], 0
    v_mfma_f32_16x16x32_bf16 a[80:83], v[44:47], v[68:71], 0
    ds_read_b64_tr_b16 v[44:45], v9 offset:128
    ds_read_b64_tr_b16 v[46:47], v9 offset:4736
    s_waitcnt lgkmcnt(6)
    v_mfma_f32_16x16x32_bf16 a[20:23], v[48:51], v[52:55], 0
    v_mfma_f32_16x16x32_bf16 a[52:55], v[48:51], v[60:63], 0
    v_mfma_f32_16x16x32_bf16 a[84:87], v[48:51], v[68:71], 0
    v_add_u32 v10, s78, v8
    ds_read_b64_tr_b16 v[48:49], v10 offset:128
    v_add_u32 v11, s78, v9
    ds_read_b64_tr_b16 v[50:51], v11 offset:128
    s_waitcnt lgkmcnt(6)
    v_mfma_f32_16x16x16_bf16 a[112:115], v[36:37], v[76:77], 0
    v_mfma_f32_16x16x16_bf16 a[116:119], v[38:39], v[76:77], 0
    ds_read_b128 v[36:39], v4 offset:9216
    s_waitcnt lgkmcnt(5)
    v_mfma_f32_16x16x32_bf16 a[24:27], v[40:43], v[52:55], 0
    v_mfma_f32_16x16x32_bf16 a[56:59], v[40:43], v[60:63], 0
    v_mfma_f32_16x16x32_bf16 a[88:91], v[40:43], v[68:71], 0
    ds_read_b128 v[40:43], v5 offset:9216
    s_waitcnt lgkmcnt(4)
    v_mfma_f32_16x16x32_bf16 a[28:31], v[44:47], v[52:55], 0
    v_mfma_f32_16x16x32_bf16 a[60:63], v[44:47], v[60:63], 0
    v_mfma_f32_16x16x32_bf16 a[92:95], v[44:47], v[68:71], 0
    ds_read_b128 v[44:47], v4 offset:9344
    s_waitcnt lgkmcnt(3)
    v_mfma_f32_16x16x16_bf16 a[120:123], v[48:49], v[76:77], 0
    v_mfma_f32_16x16x16_bf16 a[124:127], v[50:51], v[76:77], 0
    ds_read_b128 v[48:51], v5 offset:9344
L_redo1A:
    s_waitcnt lgkmcnt(3)
    v_mfma_f32_16x16x32_bf16 v[52:55], v[36:39], a[128:131], v[12:15]
    v_mfma_f32_16x16x32_bf16 v[60:63], v[36:39], a[144:147], v[16:19]
    v_mfma_f32_16x16x32_bf16 v[68:71], v[36:39], a[160:163], v[20:23]
    ds_read_b128 v[36:39], v4 offset:13824
    s_waitcnt lgkmcnt(3)
    v_mfma_f32_16x16x32_bf16 v[52:55], v[40:43], a[132:135], v[52:55]
    v_mfma_f32_16x16x32_bf16 v[60:63], v[40:43], a[148:151], v[60:63]
    v_mfma_f32_16x16x32_bf16 v[68:71], v[40:43], a[164:167], v[68:71]
    ds_read_b128 v[40:43], v5 offset:13824
    s_waitcnt lgkmcnt(3)
    v_mfma_f32_16x16x32_bf16 v[52:55], v[44:47], a[136:139], v[52:55]
    v_mfma_f32_16x16x32_bf16 v[60:63], v[44:47], a[152:155], v[60:63]
    v_mfma_f32_16x16x32_bf16 v[68:71], v[44:47], a[168:171], v[68:71]
    ds_read_b128 v[44:47], v4 offset:13952
    s_waitcnt lgkmcnt(3)
    v_mfma_f32_16x16x32_bf16 v[52:55], v[48:51], a[140:143], v[52:55]
    v_mfma_f32_16x16x32_bf16 v[60:63], v[48:51], a[156:159], v[60:63]
    v_mfma_f32_16x16x32_bf16 v[68:71], v[48:51], a[172:175], v[68:71]
    ds_read_b128 v[48:51], v5 offset:13952
    s_waitcnt lgkmcnt(3)
    v_mfma_f32_16x16x32_bf16 v[56:59], v[36:39], a[128:131], v[12:15]
    v_mfma_f32_16x16x32_bf16 v[64:67], v[36:39], a[144:147], v[16:19]
    v_mfma_f32_16x16x32_bf16 v[72:75], v[36:39], a[160:163], v[20:23]
    ds_read_b64_tr_b16 v[36:37], v6 offset:9216
    ds_read_b64_tr_b16 v[38:39], v6 offset:13824
    s_waitcnt lgkmcnt(4)
    v_mfma_f32_16x16x32_bf16 v[56:59], v[40:43], a[132:135], v[56:59]
    v_mfma_f32_16x16x32_bf16 v[64:67], v[40:43], a[148:151], v[64:67]
    v_mfma_f32_16x16x32_bf16 v[72:75], v[40:43], a[164:167], v[72:75]
    ds_read_b64_tr_b16 v[40:41], v7 offset:9216
    ds_read_b64_tr_b16 v[42:43], v7 offset:13824
    s_waitcnt lgkmcnt(5)
    v_mfma_f32_16x16x32_bf16 v[56:59], v[44:47], a[136:139], v[56:59]
    v_mfma_f32_16x16x32_bf16 v[64:67], v[44:47], a[152:155], v[64:67]
    v_mfma_f32_16x16x32_bf16 v[72:75], v[44:47], a[168:171], v[72:75]
    ds_read_b64_tr_b16 v[44:45], v8 offset:9216
    ds_read_b64_tr_b16 v[46:47], v8 offset:13824
    s_waitcnt lgkmcnt(6)
    v_mfma_f32_16x16x32_bf16 v[56:59], v[48:51], a[140:143], v[56:59]
    v_mfma_f32_16x16x32_bf16 v[64:67], v[48:51], a[156:159], v[64:67]
    v_mfma_f32_16x16x32_bf16 v[72:75], v[48:51], a[172:175], v[72:75]
    ds_read_b64_tr_b16 v[48:49], v9 offset:9216
    ds_read_b64_tr_b16 v[50:51], v9 offset:13824
    s_cmp_lg_u32 s84, 0
    s_cbranch_scc1 L_exact1A
L_exret1A:
    s_nop 1
    v_exp_f32 v52, v52
    v_exp_f32 v53, v53
    v_exp_f32 v54, v54
    v_exp_f32 v55, v55
    v_exp_f32 v56, v56
    v_exp_f32 v57, v57
    v_exp_f32 v58, v58
    v_exp_f32 v59, v59
    v_add_f32 v29, v52, v53
    v_add_f32 v29, v29, v54
    v_add_f32 v29, v29, v55
    v_add_f32 v29, v29, v56
    v_add_f32 v29, v29, v57
    v_add_f32 v29, v29, v58
    v_add_f32 v29, v29, v59
    v_cvt_pk_bf16_f32 v52, v52, v53
    v_cvt_pk_bf16_f32 v53, v54, v55
    v_cvt_pk_bf16_f32 v54, v56, v57
    v_cvt_pk_bf16_f32 v55, v58, v59
    v_exp_f32 v60, v60
    v_exp_f32 v61, v61
    v_exp_f32 v62, v62
    v_exp_f32 v63, v63
    v_exp_f32 v64, v64
    v_exp_f32 v65, v65
    v_exp_f32 v66, v66
    v_exp_f32 v67, v67
    v_add_f32 v30, v60, v61
    v_add_f32 v30, v30, v62
    v_add_f32 v30, v30, v63
    v_add_f32 v30, v30, v64
    v_add_f32 v30, v30, v65
    v_add_f32 v30, v30, v66
    v_add_f32 v30, v30, v67
    v_cvt_pk_bf16_f32 v60, v60, v61
    v_cvt_pk_bf16_f32 v61, v62, v63
    v_cvt_pk_bf16_f32 v62, v64, v65
    v_cvt_pk_bf16_f32 v63, v66, v67
    v_exp_f32 v68, v68
    v_exp_f32 v69, v69
    v_exp_f32 v70, v70
    v_exp_f32 v71, v71
    v_exp_f32 v72, v72
    v_exp_f32 v73, v73
    v_exp_f32 v74, v74
    v_exp_f32 v75, v75
    v_add_f32 v31, v68, v69
    v_add_f32 v31, v31, v70
    v_add_f32 v31, v31, v71
    v_add_f32 v31, v31, v72
    v_add_f32 v31, v31, v73
    v_add_f32 v31, v31, v74
    v_add_f32 v31, v31, v75
    v_cvt_pk_bf16_f32 v68, v68, v69
    v_cvt_pk_bf16_f32 v69, v70, v71
    v_cvt_pk_bf16_f32 v70, v72, v73
    v_cvt_pk_bf16_f32 v71, v74, v75
    v_max3_f32 v33, v29, v30, v31
    v_cmp_lt_f32 vcc, s83, v33
    s_cbranch_vccnz L_fix1A
L_fixret1A:
    s_mov_b32 s84, 0
    v_add_f32 v25, v25, v29
    v_add_f32 v26, v26, v30
    v_add_f32 v27, v27, v31
    s_waitcnt lgkmcnt(6)
    v_mfma_f32_16x16x32_bf16 a[0:3], v[36:39], v[52:55], a[0:3]
    v_mfma_f32_16x16x32_bf16 a[32:35], v[36:39], v[60:63], a[32:35]
    v_mfma_f32_16x16x32_bf16 a[64:67], v[36:39], v[68:71], a[64:67]
    ds_read_b64_tr_b16 v[36:37], v6 offset:9344
    ds_read_b64_tr_b16 v[38:39], v6 offset:13952
    s_waitcnt lgkmcnt(6)
    v_mfma_f32_16x16x32_bf16 a[4:7], v[40:43], v[52:55], a[4:7]
    v_mfma_f32_16x16x32_bf16 a[36:39], v[40:43], v[60:63], a[36:39]
    v_mfma_f32_16x16x32_bf16 a[68:71], v[40:43], v[68:71], a[68:71]
    ds_read_b64_tr_b16 v[40:41], v7 offset:9344
    ds_read_b64_tr_b16 v[42:43], v7 offset:13952
    s_waitcnt lgkmcnt(6)
    v_mfma_f32_16x16x32_bf16 a[8:11], v[44:47], v[52:55], a[8:11]
    v_mfma_f32_16x16x32_bf16 a[40:43], v[44:47], v[60:63], a[40:43]
    v_mfma_f32_16x16x32_bf16 a[72:75], v[44:47], v[68:71], a[72:75]
    ds_read_b64_tr_b16 v[44:45], v8 offset:9344
    ds_read_b64_tr_b16 v[46:47], v8 offset:13952
    s_waitcnt lgkmcnt(6)
    v_mfma_f32_16x16x32_bf16 a[12:15], v[48:51], v[52:55], a[12:15]
    v_mfma_f32_16x16x32_bf16 a[44:47], v[48:51], v[60:63], a[44:47]
    v_mfma_f32_16x16x32_bf16 a[76:79], v[48:51], v[68:71], a[76:79]
    ds_read_b64_tr_b16 v[48:49], v9 offset:9344
    ds_read_b64_tr_b16 v[50:51], v9 offset:13952
    s_waitcnt lgkmcnt(6)
    v_mfma_f32_16x16x32_bf16 a[16:19], v[36:39], v[52:55], a[16:19]
    v_mfma_f32_16x16x32_bf16 a[48:51], v[36:39], v[60:63], a[48:51]
    v_mfma_f32_16x16x32_bf16 a[80:83], v[36:39], v[68:71], a[80:83]
    s_waitcnt lgkmcnt(4)
    v_mfma_f32_16x16x32_bf16 a[20:23], v[40:43], v[52:55], a[20:23]
    v_mfma_f32_16x16x32_bf16 a[52:55], v[40:43], v[60:63], a[52:55]
    v_mfma_f32_16x16x32_bf16 a[84:87], v[40:43], v[68:71], a[84:87]
    s_waitcnt lgkmcnt(2)
    v_mfma_f32_16x16x32_bf16 a[24:27], v[44:47], v[52:55], a[24:27]
    v_mfma_f32_16x16x32_bf16 a[56:59], v[44:47], v[60:63], a[56:59]
    v_mfma_f32_16x16x32_bf16 a[88:91], v[44:47], v[68:71], a[88:91]
    s_waitcnt lgkmcnt(0)
    v_mfma_f32_16x16x32_bf16 a[28:31], v[48:51], v[52:55], a[28:31]
    v_mfma_f32_16x16x32_bf16 a[60:63], v[48:51], v[60:63], a[60:63]
    v_mfma_f32_16x16x32_bf16 a[92:95], v[48:51], v[68:71], a[92:95]
    v_add_u32 v4, s81, v4
    v_add_u32 v5, s81, v5
    v_add_u32 v6, s81, v6
    v_add_u32 v7, s81, v7
    v_add_u32 v8, s81, v8
    v_add_u32 v9, s81, v9
    s_add_u32 s79, s79, 16384
    s_sub_u32 s80, 36864, s80
    s_sub_u32 s81, 0, s81
L_blk:
    s_waitcnt vmcnt(0) lgkmcnt(0)
    s_barrier
    s_add_u32 s88, s78, s80
    ds_read_b128 v[36:39], v4 offset:0
    v_add_u32 v10, s78, v4
    ds_read_b128 v[40:43], v10 offset:0
    ds_read_b128 v[44:47], v3 offset:0
    ds_read_b128 v[48:51], v5 offset:0
L_redo0B:
    s_waitcnt lgkmcnt(3)
    v_mfma_f32_16x16x32_bf16 v[52:55], v[36:39], a[128:131], v[12:15]
    v_mfma_f32_16x16x32_bf16 v[60:63], v[36:39], a[144:147], v[16:19]
    v_mfma_f32_16x16x32_bf16 v[68:71], v[36:39], a[160:163], v[20:23]
    s_add_u32 m0, s88, 0
    s_nop 0
    buffer_load_dwordx4 v2, s[48:51], s79 offen lds
    ds_read_b128 v[36:39], v4 offset:128
    s_waitcnt lgkmcnt(2)
    v_mfma_f32_16x16x32_bf16 v[76:79], v[40:43], v[44:47], 0
    v_add_u32 v11, s78, v5
    ds_read_b128 v[40:43], v11 offset:0
    ds_read_b128 v[44:47], v3 offset:1024
    s_waitcnt lgkmcnt(3)
    v_mfma_f32_16x16x32_bf16 v[52:55], v[48:51], a[132:135], v[52:55]
    v_mfma_f32_16x16x32_bf16 v[60:63], v[48:51], a[148:151], v[60:63]
    v_mfma_f32_16x16x32_bf16 v[68:71], v[48:51], a[164:167], v[68:71]
    s_add_u32 m0, s88, 128
    s_nop 0
    buffer_load_dwordx4 v2, s[48:51], s79 offen offset:1024 lds
    ds_read_b128 v[48:51], v5 offset:128
    s_waitcnt lgkmcnt(3)
    v_mfma_f32_16x16x32_bf16 v[52:55], v[36:39], a[136:139], v[52:55]
    v_mfma_f32_16x16x32_bf16 v[60:63], v[36:39], a[152:155], v[60:63]
    v_mfma_f32_16x16x32_bf16 v[68:71], v[36:39], a[168:171], v[68:71]
    s_add_u32 m0, s88, 256
    s_nop 0
    buffer_load_dwordx4 v2, s[48:51], s79 offen offset:2048 lds
    ds_read_b128 v[36:39], v4 offset:4608
    s_waitcnt lgkmcnt(2)
    v_mfma_f32_16x16x32_bf16 v[76:79], v[40:43], v[44:47], v[76:79]
    v_add_u32 v10, s78, v4
    ds_read_b128 v[40:43], v10 offset:128
    ds_read_b128 v[44:47], v3 offset:2048
    s_waitcnt lgkmcnt(3)
    v_mfma_f32_16x16x32_bf16 v[52:55], v[48:51], a[140:143], v[52:55]
    v_mfma_f32_16x16x32_bf16 v[60:63], v[48:51], a[156:159], v[60:63]
    v_mfma_f32_16x16x32_bf16 v[68:71], v[48:51], a[172:175], v[68:71]
    s_add_u32 m0, s88, 384
    s_nop 0
    buffer_load_dwordx4 v2, s[48:51], s79 offen offset:3072 lds
    ds_read_b128 v[48:51], v5 offset:4608
    s_waitcnt lgkmcnt(3)
    v_mfma_f32_16x16x32_bf16 v[56:59], v[36:39], a[128:131], v[12:15]
    v_mfma_f32_16x16x32_bf16 v[64:67], v[36:39], a[144:147], v[16:19]
    v_mfma_f32_16x16x32_bf16 v[72:75], v[36:39], a[160:163], v[20:23]
    s_add_u32 m0, s88, 18432
    s_nop 0
    buffer_load_dwordx4 v2, s[52:55], s79 offen lds
    ds_read_b128 v[36:39], v4 offset:4736
    s_waitcnt lgkmcnt(2)
    v_mfma_f32_16x16x32_bf16 v[76:79], v[40:43], v[44:47], v[76:79]
    v_add_u32 v11, s78, v5
    ds_read_b128 v[40:43], v11 offset:128
    ds_read_b128 v[44:47], v3 offset:3072
    s_waitcnt lgkmcnt(3)
    v_mfma_f32_16x16x32_bf16 v[56:59], v[48:51], a[132:135], v[56:59]
    v_mfma_f32_16x16x32_bf16 v[64:67], v[48:51], a[148:151], v[64:67]
    v_mfma_f32_16x16x32_bf16 v[72:75], v[48:51], a[164:167], v[72:75]
    s_add_u32 m0, s88, 18560
    s_nop 0
    buffer_load_dwordx4 v2, s[52:55], s79 offen offset:1024 lds
    ds_read_b128 v[48:51], v5 offset:4736
    s_waitcnt lgkmcnt(3)
    v_mfma_f32_16x16x32_bf16 v[56:59], v[36:39], a[136:139], v[56:59]
    v_mfma_f32_16x16x32_bf16 v[64:67], v[36:39], a[152:155], v[64:67]
    v_mfma_f32_16x16x32_bf16 v[72:75], v[36:39], a[168:171], v[72:75]
    s_add_u32 m0, s88, 18688
    s_nop 0
    buffer_load_dwordx4 v2, s[52:55], s79 offen offset:2048 lds
    ds_read_b64_tr_b16 v[36:37], v6 offset:0
    ds_read_b64_tr_b16 v[38:39], v6 offset:4608
    s_waitcnt lgkmcnt(3)
    v_mfma_f32_16x16x32_bf16 v[76:79], v[40:43], v[44:47], v[76:79]
    ds_read_b64_tr_b16 v[40:41], v7 offset:0
    ds_read_b64_tr_b16 v[42:43], v7 offset:4608
    v_add_u32 v10, s78, v6
    ds_read_b64_tr_b16 v[44:45], v10 offset:0
    v_add_u32 v11, s78, v7
    ds_read_b64_tr_b16 v[46:47], v11 offset:0
    s_waitcnt lgkmcnt(6)
    v_mfma_f32_16x16x32_bf16 v[56:59], v[48:51], a[140:143], v[56:59]
    v_mfma_f32_16x16x32_bf16 v[64:67], v[48:51], a[156:159], v[64:67]
    v_mfma_f32_16x16x32_bf16 v[72:75], v[48:51], a[172:175], v[72:75]
    s_add_u32 m0, s88, 18816
    s_nop 0
    buffer_load_dwordx4 v2, s[52:55], s79 offen offset:3072 lds
    ds_read_b64_tr_b16 v[48:49], v8 offset:0
    ds_read_b64_tr_b16 v[50:51], v8 offset:4608
    s_cmp_lg_u32 s84, 0
    s_cbranch_scc1 L_exact0B
L_exret0B:
    v_add_f32 v76, v76, v24
    v_add_f32 v77, v77, v24
    v_add_f32 v78, v78, v24
    v_add_f32 v79, v79, v24
    v_exp_f32 v76, v76
    v_exp_f32 v77, v77
    v_exp_f32 v78, v78
    v_exp_f32 v79, v79
    v_add_f32 v32, v76, v77
    v_add_f32 v32, v32, v78
    v_add_f32 v32, v32, v79
    v_cvt_pk_bf16_f32 v76, v76, v77
    v_cvt_pk_bf16_f32 v77, v78, v79
    v_exp_f32 v52, v52
    v_exp_f32 v53, v53
    v_exp_f32 v54, v54
    v_exp_f32 v55, v55
    v_exp_f32 v56, v56
    v_exp_f32 v57, v57
    v_exp_f32 v58, v58
    v_exp_f32 v59, v59
    v_add_f32 v29, v52, v53
    v_add_f32 v29, v29, v54
    v_add_f32 v29, v29, v55
    v_add_f32 v29, v29, v56
    v_add_f32 v29, v29, v57
    v_add_f32 v29, v29, v58
    v_add_f32 v29, v29, v59
    v_cvt_pk_bf16_f32 v52, v52, v53
    v_cvt_pk_bf16_f32 v53, v54, v55
    v_cvt_pk_bf16_f32 v54, v56, v57
    v_cvt_pk_bf16_f32 v55, v58, v59
    v_exp_f32 v60, v60
    v_exp_f32 v61, v61
    v_exp_f32 v62, v62
    v_exp_f32 v63, v63
    v_exp_f32 v64, v64
    v_exp_f32 v65, v65
    v_exp_f32 v66, v66
    v_exp_f32 v67, v67
    v_add_f32 v30, v60, v61
    v_add_f32 v30, v30, v62
    v_add_f32 v30, v30, v63
    v_add_f32 v30, v30, v64
    v_add_f32 v30, v30, v65
    v_add_f32 v30, v30, v66
    v_add_f32 v30, v30, v67
    v_cvt_pk_bf16_f32 v60, v60, v61
    v_cvt_pk_bf16_f32 v61, v62, v63
    v_cvt_pk_bf16_f32 v62, v64, v65
    v_cvt_pk_bf16_f32 v63, v66, v67
    v_exp_f32 v68, v68
    v_exp_f32 v69, v69
    v_exp_f32 v70, v70
    v_exp_f32 v71, v71
    v_exp_f32 v72, v72
    v_exp_f32 v73, v73
    v_exp_f32 v74, v74
    v_exp_f32 v75, v75
    v_add_f32 v31, v68, v69
    v_add_f32 v31, v31, v70
    v_add_f32 v31, v31, v71
    v_add_f32 v31, v31, v72
    v_add_f32 v31, v31, v73
    v_add_f32 v31, v31, v74
    v_add_f32 v31, v31, v75
    v_cvt_pk_bf16_f32 v68, v68, v69
    v_cvt_pk_bf16_f32 v69, v70, v71
    v_cvt_pk_bf16_f32 v70, v72, v73
    v_cvt_pk_bf16_f32 v71, v74, v75
    v_max3_f32 v33, v29, v30, v31
    v_max_f32 v33, v33, v32
    v_cmp_lt_f32 vcc, s83, v33
    s_cbranch_vccnz L_fix0B
L_fixret0B:
    s_mov_b32 s84, 0
    v_add_f32 v28, v28, v32
    v_add_f32 v25, v25, v29
    v_add_f32 v26, v26, v30
    v_add_f32 v27, v27, v31
    s_waitcnt lgkmcnt(6)
    v_mfma_f32_16x16x32_bf16 a[0:3], v[36:39], v[52:55], a[0:3]
    v_mfma_f32_16x16x32_bf16 a[32:35], v[36:39], v[60:63], a[32:35]
    v_mfma_f32_16x16x32_bf16 a[64:67], v[36:39], v[68:71], a[64:67]
    ds_read_b64_tr_b16 v[36:37], v9 offset:0
    ds_read_b64_tr_b16 v[38:39], v9 offset:4608
    s_waitcnt lgkmcnt(6)
    v_mfma_f32_16x16x32_bf16 a[4:7], v[40:43], v[52:55], a[4:7]
    v_mfma_f32_16x16x32_bf16 a[36:39], v[40:43], v[60:63], a[36:39]
    v_mfma_f32_16x16x32_bf16 a[68:71], v[40:43], v[68:71], a[68:71]
    v_add_u32 v10, s78, v8
    ds_read_b64_tr_b16 v[40:41], v10 offset:0
    v_add_u32 v11, s78, v9
    ds_read_b64_tr_b16 v[42:43], v11 offset:0
    s_waitcnt lgkmcnt(6)
    v_mfma_f32_16x16x16_bf16 a[96:99], v[44:45], v[76:77], a[96:99]
    v_mfma_f32_16x16x16_bf16 a[100:103], v[46:47], v[76:77], a[100:103]
    ds_read_b64_tr_b16 v[44:45], v6 offset:128
    ds_read_b64_tr_b16 v[46:47], v6 offset:4736
    s_waitcnt lgkmcnt(6)
    v_mfma_f32_16x16x32_bf16 a[8:11], v[48:51], v[52:55], a[8:11]
    v_mfma_f32_16x16x32_bf16 a[40:43], v[48:51], v[60:63], a[40:43]
    v_mfma_f32_16x16x32_bf16 a[72:75], v[48:51], v[68:71], a[72:75]
    ds_read_b64_tr_b16 v[48:49], v7 offset:128
    ds_read_b64_tr_b16 v[50:51], v7 offset:4736
    s_waitcnt lgkmcnt(6)
    v_mfma_f32_16x16x32_bf16 a[12:15], v[36:39], v[52:55], a[12:15]
    v_mfma_f32_16x16x32_bf16 a[44:47], v[36:39], v[60:63], a[44:47]
    v_mfma_f32_16x16x32_bf16 a[76:79], v[36:39], v[68:71], a[76:79]
    v_add_u32 v10, s78, v6
    ds_read_b64_tr_b16 v[36:37], v10 offset:128
    v_add_u32 v11, s78, v7
    ds_read_b64_tr_b16 v[38:39], v11 offset:128
    s_waitcnt lgkmcnt(6)
    v_mfma_f32_16x16x16_bf16 a[104:107], v[40:41], v[76:77], a[104:107]
    v_mfma_f32_16x16x16_bf16 a[108:111], v[42:43], v[76:77], a[108:111]
    ds_read_b64_tr_b16 v[40:41], v8 offset:128
    ds_read_b64_tr_b16 v[42:43], v8 offset:4736
    s_waitcnt lgkmcnt(6)
    v_mfma_f32_16x16x32_bf16 a[16:19], v[44:47], v[52:55], a[16:19]
    v_mfma_f32_16x16x32_bf16 a[48:51], v[44:47], v[60:63], a[48:51]
    v_mfma_f32_16x16x32_bf16 a[80:83], v[44:47], v[68:71], a[80:83]
    ds_read_b64_tr_b16 v[44:45], v9 offset:128
    ds_read_b64_tr_b16 v[46:47], v9 offset:4736
    s_waitcnt lgkmcnt(6)
    v_mfma_f32_16x16x32_bf16 a[20:23], v[48:51], v[52:55], a[20:23]
    v_mfma_f32_16x16x32_bf16 a[52:55], v[48:51], v[60:63], a[52:55]
    v_mfma_f32_16x16x32_bf16 a[84:87], v[48:51], v[68:71], a[84:87]
    v_add_u32 v10, s78, v8
    ds_read_b64_tr_b16 v[48:49], v10 offset:128
    v_add_u32 v11, s78, v9
    ds_read_b64_tr_b16 v[50:51], v11 offset:128
    s_waitcnt lgkmcnt(6)
    v_mfma_f32_16x16x16_bf16 a[112:115], v[36:37], v[76:77], a[112:115]
    v_mfma_f32_16x16x16_bf16 a[116:119], v[38:39], v[76:77], a[116:119]
    ds_read_b128 v[36:39], v4 offset:9216
    s_waitcnt lgkmcnt(5)
    v_mfma_f32_16x16x32_bf16 a[24:27], v[40:43], v[52:55], a[24:27]
    v_mfma_f32_16x16x32_bf16 a[56:59], v[40:43], v[60:63], a[56:59]
    v_mfma_f32_16x16x32_bf16 a[88:91], v[40:43], v[68:71], a[88:91]
    ds_read_b128 v[40:43], v5 offset:9216
    s_waitcnt lgkmcnt(4)
    v_mfma_f32_16x16x32_bf16 a[28:31], v[44:47], v[52:55], a[28:31]
    v_mfma_f32_16x16x32_bf16 a[60:63], v[44:47], v[60:63], a[60:63]
    v_mfma_f32_16x16x32_bf16 a[92:95], v[44:47], v[68:71], a[92:95]
    ds_read_b128 v[44:47], v4 offset:9344
    s_waitcnt lgkmcnt(3)
    v_mfma_f32_16x16x16_bf16 a[120:123], v[48:49], v[76:77], a[120:123]
    v_mfma_f32_16x16x16_bf16 a[124:127], v[50:51], v[76:77], a[124:127]
    ds_read_b128 v[48:51], v5 offset:9344
L_redo1B:
    s_waitcnt lgkmcnt(3)
    v_mfma_f32_16x16x32_bf16 v[52:55], v[36:39], a[128:131], v[12:15]
    v_mfma_f32_16x16x32_bf16 v[60:63], v[36:39], a[144:147], v[16:19]
    v_mfma_f32_16x16x32_bf16 v[68:71], v[36:39], a[160:163], v[20:23]
    ds_read_b128 v[36:39], v4 offset:13824
    s_waitcnt lgkmcnt(3)
    v_mfma_f32_16x16x32_bf16 v[52:55], v[40:43], a[132:135], v[52:55]
    v_mfma_f32_16x16x32_bf16 v[60:63], v[40:43], a[148:151], v[60:63]
    v_mfma_f32_16x16x32_bf16 v[68:71], v[40:43], a[164:167], v[68:71]
    ds_read_b128 v[40:43], v5 offset:13824
    s_waitcnt lgkmcnt(3)
    v_mfma_f32_16x16x32_bf16 v[52:55], v[44:47], a[136:139], v[52:55]
    v_mfma_f32_16x16x32_bf16 v[60:63], v[44:47], a[152:155], v[60:63]
    v_mfma_f32_16x16x32_bf16 v[68:71], v[44:47], a[168:171], v[68:71]
    ds_read_b128 v[44:47], v4 offset:13952
    s_waitcnt lgkmcnt(3)
    v_mfma_f32_16x16x32_bf16 v[52:55], v[48:51], a[140:143], v[52:55]
    v_mfma_f32_16x16x32_bf16 v[60:63], v[48:51], a[156:159], v[60:63]
    v_mfma_f32_16x16x32_bf16 v[68:71], v[48:51], a[172:175], v[68:71]
    ds_read_b128 v[48:51], v5 offset:13952
    s_waitcnt lgkmcnt(3)
    v_mfma_f32_16x16x32_bf16 v[56:59], v[36:39], a[128:131], v[12:15]
    v_mfma_f32_16x16x32_bf16 v[64:67], v[36:39], a[144:147], v[16:19]
    v_mfma_f32_16x16x32_bf16 v[72:75], v[36:39], a[160:163], v[20:23]
    ds_read_b64_tr_b16 v[36:37], v6 offset:9216
    ds_read_b64_tr_b16 v[38:39], v6 offset:13824
    s_waitcnt lgkmcnt(4)
    v_mfma_f32_16x16x32_bf16 v[56:59], v[40:43], a[132:135], v[56:59]
    v_mfma_f32_16x16x32_bf16 v[64:67], v[40:43], a[148:151], v[64:67]
    v_mfma_f32_16x16x32_bf16 v[72:75], v[40:43], a[164:167], v[72:75]
    ds_read_b64_tr_b16 v[40:41], v7 offset:9216
    ds_read_b64_tr_b16 v[42:43], v7 offset:13824
    s_waitcnt lgkmcnt(5)
    v_mfma_f32_16x16x32_bf16 v[56:59], v[44:47], a[136:139], v[56:59]
    v_mfma_f32_16x16x32_bf16 v[64:67], v[44:47], a[152:155], v[64:67]
    v_mfma_f32_16x16x32_bf16 v[72:75], v[44:47], a[168:171], v[72:75]
    ds_read_b64_tr_b16 v[44:45], v8 offset:9216
    ds_read_b64_tr_b16 v[46:47], v8 offset:13824
    s_waitcnt lgkmcnt(6)
    v_mfma_f32_16x16x32_bf16 v[56:59], v[48:51], a[140:143], v[56:59]
    v_mfma_f32_16x16x32_bf16 v[64:67], v[48:51], a[156:159], v[64:67]
    v_mfma_f32_16x16x32_bf16 v[72:75], v[48:51], a[172:175], v[72:75]
    ds_read_b64_tr_b16 v[48:49], v9 offset:9216
    ds_read_b64_tr_b16 v[50:51], v9 offset:13824
    s_cmp_lg_u32 s84, 0
    s_cbranch_scc1 L_exact1B
L_exret1B:
    s_nop 1
    v_exp_f32 v52, v52
    v_exp_f32 v53, v53
    v_exp_f32 v54, v54
    v_exp_f32 v55, v55
    v_exp_f32 v56, v56
    v_exp_f32 v57, v57
    v_exp_f32 v58, v58
    v_exp_f32 v59, v59
    v_add_f32 v29, v52, v53
    v_add_f32 v29, v29, v54
    v_add_f32 v29, v29, v55
    v_add_f32 v29, v29, v56
    v_add_f32 v29, v29, v57
    v_add_f32 v29, v29, v58
    v_add_f32 v29, v29, v59
    v_cvt_pk_bf16_f32 v52, v52, v53
    v_cvt_pk_bf16_f32 v53, v54, v55
    v_cvt_pk_bf16_f32 v54, v56, v57
    v_cvt_pk_bf16_f32 v55, v58, v59
    v_exp_f32 v60, v60
    v_exp_f32 v61, v61
    v_exp_f32 v62, v62
    v_exp_f32 v63, v63
    v_exp_f32 v64, v64
    v_exp_f32 v65, v65
    v_exp_f32 v66, v66
    v_exp_f32 v67, v67
    v_add_f32 v30, v60, v61
    v_add_f32 v30, v30, v62
    v_add_f32 v30, v30, v63
    v_add_f32 v30, v30, v64
    v_add_f32 v30, v30, v65
    v_add_f32 v30, v30, v66
    v_add_f32 v30, v30, v67
    v_cvt_pk_bf16_f32 v60, v60, v61
    v_cvt_pk_bf16_f32 v61, v62, v63
    v_cvt_pk_bf16_f32 v62, v64, v65
    v_cvt_pk_bf16_f32 v63, v66, v67
    v_exp_f32 v68, v68
    v_exp_f32 v69, v69
    v_exp_f32 v70, v70
    v_exp_f32 v71, v71
    v_exp_f32 v72, v72
    v_exp_f32 v73, v73
    v_exp_f32 v74, v74
    v_exp_f32 v75, v75
    v_add_f32 v31, v68, v69
    v_add_f32 v31, v31, v70
    v_add_f32 v31, v31, v71
    v_add_f32 v31, v31, v72
    v_add_f32 v31, v31, v73
    v_add_f32 v31, v31, v74
    v_add_f32 v31, v31, v75
    v_cvt_pk_bf16_f32 v68, v68, v69
    v_cvt_pk_bf16_f32 v69, v70, v71
    v_cvt_pk_bf16_f32 v70, v72, v73
    v_cvt_pk_bf16_f32 v71, v74, v75
    v_max3_f32 v33, v29, v30, v31
    v_cmp_lt_f32 vcc, s83, v33
    s_cbranch_vccnz L_fix1B
L_fixret1B:
    s_mov_b32 s84, 0
    v_add_f32 v25, v25, v29
    v_add_f32 v26, v26, v30
    v_add_f32 v27, v27, v31
    s_waitcnt lgkmcnt(6)
    v_mfma_f32_16x16x32_bf16 a[0:3], v[36:39], v[52:55], a[0:3]
    v_mfma_f32_16x16x32_bf16 a[32:35], v[36:39], v[60:63], a[32:35]
    v_mfma_f32_16x16x32_bf16 a[64:67], v[36:39], v[68:71], a[64:67]
    ds_read_b64_tr_b16 v[36:37], v6 offset:9344
    ds_read_b64_tr_b16 v[38:39], v6 offset:13952
    s_waitcnt lgkmcnt(6)
    v_mfma_f32_16x16x32_bf16 a[4:7], v[40:43], v[52:55], a[4:7]
    v_mfma_f32_16x16x32_bf16 a[36:39], v[40:43], v[60:63], a[36:39]
    v_mfma_f32_16x16x32_bf16 a[68:71], v[40:43], v[68:71], a[68:71]
    ds_read_b64_tr_b16 v[40:41], v7 offset:9344
    ds_read_b64_tr_b16 v[42:43], v7 offset:13952
    s_waitcnt lgkmcnt(6)
    v_mfma_f32_16x16x32_bf16 a[8:11], v[44:47], v[52:55], a[8:11]
    v_mfma_f32_16x16x32_bf16 a[40:43], v[44:47], v[60:63], a[40:43]
    v_mfma_f32_16x16x32_bf16 a[72:75], v[44:47], v[68:71], a[72:75]
    ds_read_b64_tr_b16 v[44:45], v8 offset:9344
    ds_read_b64_tr_b16 v[46:47], v8 offset:13952
    s_waitcnt lgkmcnt(6)
    v_mfma_f32_16x16x32_bf16 a[12:15], v[48:51], v[52:55], a[12:15]
    v_mfma_f32_16x16x32_bf16 a[44:47], v[48:51], v[60:63], a[44:47]
    v_mfma_f32_16x16x32_bf16 a[76:79], v[48:51], v[68:71], a[76:79]
    ds_read_b64_tr_b16 v[48:49], v9 offset:9344
    ds_read_b64_tr_b16 v[50:51], v9 offset:13952
    s_waitcnt lgkmcnt(6)
    v_mfma_f32_16x16x32_bf16 a[16:19], v[36:39], v[52:55], a[16:19]
    v_mfma_f32_16x16x32_bf16 a[48:51], v[36:39], v[60:63], a[48:51]
    v_mfma_f32_16x16x32_bf16 a[80:83], v[36:39], v[68:71], a[80:83]
    s_waitcnt lgkmcnt(4)
    v_mfma_f32_16x16x32_bf16 a[20:23], v[40:43], v[52:55], a[20:23]
    v_mfma_f32_16x16x32_bf16 a[52:55], v[40:43], v[60:63], a[52:55]
    v_mfma_f32_16x16x32_bf16 a[84:87], v[40:43], v[68:71], a[84:87]
    s_waitcnt lgkmcnt(2)
    v_mfma_f32_16x16x32_bf16 a[24:27], v[44:47], v[52:55], a[24:27]
    v_mfma_f32_16x16x32_bf16 a[56:59], v[44:47], v[60:63], a[56:59]
    v_mfma_f32_16x16x32_bf16 a[88:91], v[44:47], v[68:71], a[88:91]
    s_waitcnt lgkmcnt(0)
    v_mfma_f32_16x16x32_bf16 a[28:31], v[48:51], v[52:55], a[28:31]
    v_mfma_f32_16x16x32_bf16 a[60:63], v[48:51], v[60:63], a[60:63]
    v_mfma_f32_16x16x32_bf16 a[92:95], v[48:51], v[68:71], a[92:95]
    v_add_u32 v4, s81, v4
    v_add_u32 v5, s81, v5
    v_add_u32 v6, s81, v6
    v_add_u32 v7, s81, v7
    v_add_u32 v8, s81, v8
    v_add_u32 v9, s81, v9
    s_add_u32 s79, s79, 16384
    s_sub_u32 s80, 36864, s80
    s_sub_u32 s81, 0, s81
    s_add_u32 s86, s86, 1
    s_cmp_lt_u32 s86, 6
    s_cbranch_scc1 L_blk
    s_waitcnt vmcnt(0) lgkmcnt(0)
    s_barrier
    ds_read_b128 v[36:39], v4 offset:0
    v_add_u32 v10, s78, v4
    ds_read_b128 v[40:43], v10 offset:0
    ds_read_b128 v[44:47], v3 offset:0
    ds_read_b128 v[48:51], v5 offset:0
L_redo0C:
    s_waitcnt lgkmcnt(3)
    v_mfma_f32_16x16x32_bf16 v[52:55], v[36:39], a[128:131], v[12:15]
    v_mfma_f32_16x16x32_bf16 v[60:63], v[36:39], a[144:147], v[16:19]
    v_mfma_f32_16x16x32_bf16 v[68:71], v[36:39], a[160:163], v[20:23]
    ds_read_b128 v[36:39], v4 offset:128
    s_waitcnt lgkmcnt(2)
    v_mfma_f32_16x16x32_bf16 v[76:79], v[40:43], v[44:47], 0
    v_add_u32 v11, s78, v5
    ds_read_b128 v[40:43], v11 offset:0
    ds_read_b128 v[44:47], v3 offset:1024
    s_waitcnt lgkmcnt(3)
    v_mfma_f32_16x16x32_bf16 v[52:55], v[48:51], a[132:135], v[52:55]
    v_mfma_f32_16x16x32_bf16 v[60:63], v[48:51], a[148:151], v[60:63]
    v_mfma_f32_16x16x32_bf16 v[68:71], v[48:51], a[164:167], v[68:71]
    ds_read_b128 v[48:51], v5 offset:128
    s_waitcnt lgkmcnt(3)
    v_mfma_f32_16x16x32_bf16 v[52:55], v[36:39], a[136:139], v[52:55]
    v_mfma_f32_16x16x32_bf16 v[60:63], v[36:39], a[152:155], v[60:63]
    v_mfma_f32_16x16x32_bf16 v[68:71], v[36:39], a[168:171], v[68:71]
    ds_read_b128 v[36:39], v4 offset:4608
    s_waitcnt lgkmcnt(2)
    v_mfma_f32_16x16x32_bf16 v[76:79], v[40:43], v[44:47], v[76:79]
    v_add_u32 v10, s78, v4
    ds_read_b128 v[40:43], v10 offset:128
    ds_read_b128 v[44:47], v3 offset:2048
    s_waitcnt lgkmcnt(3)
    v_mfma_f32_16x16x32_bf16 v[52:55], v[48:51], a[140:143], v[52:55]
    v_mfma_f32_16x16x32_bf16 v[60:63], v[48:51], a[156:159], v[60:63]
    v_mfma_f32_16x16x32_bf16 v[68:71], v[48:51], a[172:175], v[68:71]
    ds_read_b128 v[48:51], v5 offset:4608
    s_waitcnt lgkmcnt(3)
    v_mfma_f32_16x16x32_bf16 v[56:59], v[36:39], a[128:131], v[12:15]
    v_mfma_f32_16x16x32_bf16 v[64:67], v[36:39], a[144:147], v[16:19]
    v_mfma_f32_16x16x32_bf16 v[72:75], v[36:39], a[160:163], v[20:23]
    ds_read_b128 v[36:39], v4 offset:4736
    s_waitcnt lgkmcnt(2)
    v_mfma_f32_16x16x32_bf16 v[76:79], v[40:43], v[44:47], v[76:79]
    v_add_u32 v11, s78, v5
    ds_read_b128 v[40:43], v11 offset:128
    ds_read_b128 v[44:47], v3 offset:3072
    s_waitcnt lgkmcnt(3)
    v_mfma_f32_16x16x32_bf16 v[56:59], v[48:51], a[132:135], v[56:59]
    v_mfma_f32_16x16x32_bf16 v[64:67], v[48:51], a[148:151], v[64:67]
    v_mfma_f32_16x16x32_bf16 v[72:75], v[48:51], a[164:167], v[72:75]
    ds_read_b128 v[48:51], v5 offset:4736
    s_waitcnt lgkmcnt(3)
    v_mfma_f32_16x16x32_bf16 v[56:59], v[36:39], a[136:139], v[56:59]
    v_mfma_f32_16x16x32_bf16 v[64:67], v[36:39], a[152:155], v[64:67]
    v_mfma_f32_16x16x32_bf16 v[72:75], v[36:39], a[168:171], v[72:75]
    ds_read_b64_tr_b16 v[36:37], v6 offset:0
    ds_read_b64_tr_b16 v[38:39], v6 offset:4608
    s_waitcnt lgkmcnt(3)
    v_mfma_f32_16x16x32_bf16 v[76:79], v[40:43], v[44:47], v[76:79]
    ds_read_b64_tr_b16 v[40:41], v7 offset:0
    ds_read_b64_tr_b16 v[42:43], v7 offset:4608
    v_add_u32 v10, s78, v6
    ds_read_b64_tr_b16 v[44:45], v10 offset:0
    v_add_u32 v11, s78, v7
    ds_read_b64_tr_b16 v[46:47], v11 offset:0
    s_waitcnt lgkmcnt(6)
    v_mfma_f32_16x16x32_bf16 v[56:59], v[48:51], a[140:143], v[56:59]
    v_mfma_f32_16x16x32_bf16 v[64:67], v[48:51], a[156:159], v[64:67]
    v_mfma_f32_16x16x32_bf16 v[72:75], v[48:51], a[172:175], v[72:75]
    ds_read_b64_tr_b16 v[48:49], v8 offset:0
    ds_read_b64_tr_b16 v[50:51], v8 offset:4608
    s_cmp_lg_u32 s84, 0
    s_cbranch_scc1 L_exact0C
L_exret0C:
    v_add_f32 v76, v76, v24
    v_add_f32 v77, v77, v24
    v_add_f32 v78, v78, v24
    v_add_f32 v79, v79, v24
    v_exp_f32 v76, v76
    v_exp_f32 v77, v77
    v_exp_f32 v78, v78
    v_exp_f32 v79, v79
    v_add_f32 v32, v76, v77
    v_add_f32 v32, v32, v78
    v_add_f32 v32, v32, v79
    v_cvt_pk_bf16_f32 v76, v76, v77
    v_cvt_pk_bf16_f32 v77, v78, v79
    v_exp_f32 v52, v52
    v_exp_f32 v53, v53
    v_exp_f32 v54, v54
    v_exp_f32 v55, v55
    v_exp_f32 v56, v56
    v_exp_f32 v57, v57
    v_exp_f32 v58, v58
    v_exp_f32 v59, v59
    v_add_f32 v29, v52, v53
    v_add_f32 v29, v29, v54
    v_add_f32 v29, v29, v55
    v_add_f32 v29, v29, v56
    v_add_f32 v29, v29, v57
    v_add_f32 v29, v29, v58
    v_add_f32 v29, v29, v59
    v_cvt_pk_bf16_f32 v52, v52, v53
    v_cvt_pk_bf16_f32 v53, v54, v55
    v_cvt_pk_bf16_f32 v54, v56, v57
    v_cvt_pk_bf16_f32 v55, v58, v59
    v_exp_f32 v60, v60
    v_exp_f32 v61, v61
    v_exp_f32 v62, v62
    v_exp_f32 v63, v63
    v_exp_f32 v64, v64
    v_exp_f32 v65, v65
    v_exp_f32 v66, v66
    v_exp_f32 v67, v67
    v_add_f32 v30, v60, v61
    v_add_f32 v30, v30, v62
    v_add_f32 v30, v30, v63
    v_add_f32 v30, v30, v64
    v_add_f32 v30, v30, v65
    v_add_f32 v30, v30, v66
    v_add_f32 v30, v30, v67
    v_cvt_pk_bf16_f32 v60, v60, v61
    v_cvt_pk_bf16_f32 v61, v62, v63
    v_cvt_pk_bf16_f32 v62, v64, v65
    v_cvt_pk_bf16_f32 v63, v66, v67
    v_exp_f32 v68, v68
    v_exp_f32 v69, v69
    v_exp_f32 v70, v70
    v_exp_f32 v71, v71
    v_exp_f32 v72, v72
    v_exp_f32 v73, v73
    v_exp_f32 v74, v74
    v_exp_f32 v75, v75
    v_add_f32 v31, v68, v69
    v_add_f32 v31, v31, v70
    v_add_f32 v31, v31, v71
    v_add_f32 v31, v31, v72
    v_add_f32 v31, v31, v73
    v_add_f32 v31, v31, v74
    v_add_f32 v31, v31, v75
    v_cvt_pk_bf16_f32 v68, v68, v69
    v_cvt_pk_bf16_f32 v69, v70, v71
    v_cvt_pk_bf16_f32 v70, v72, v73
    v_cvt_pk_bf16_f32 v71, v74, v75
    v_max3_f32 v33, v29, v30, v31
    v_max_f32 v33, v33, v32
    v_cmp_lt_f32 vcc, s83, v33
    s_cbranch_vccnz L_fix0C
L_fixret0C:
    s_mov_b32 s84, 0
    v_add_f32 v28, v28, v32
    v_add_f32 v25, v25, v29
    v_add_f32 v26, v26, v30
    v_add_f32 v27, v27, v31
    s_waitcnt lgkmcnt(6)
    v_mfma_f32_16x16x32_bf16 a[0:3], v[36:39], v[52:55], a[0:3]
    v_mfma_f32_16x16x32_bf16 a[32:35], v[36:39], v[60:63], a[32:35]
    v_mfma_f32_16x16x32_bf16 a[64:67], v[36:39], v[68:71], a[64:67]
    ds_read_b64_tr_b16 v[36:37], v9 offset:0
    ds_read_b64_tr_b16 v[38:39], v9 offset:4608
    s_waitcnt lgkmcnt(6)
    v_mfma_f32_16x16x32_bf16 a[4:7], v[40:43], v[52:55], a[4:7]
    v_mfma_f32_16x16x32_bf16 a[36:39], v[40:43], v[60:63], a[36:39]
    v_mfma_f32_16x16x32_bf16 a[68:71], v[40:43], v[68:71], a[68:71]
    v_add_u32 v10, s78, v8
    ds_read_b64_tr_b16 v[40:41], v10 offset:0
    v_add_u32 v11, s78, v9
    ds_read_b64_tr_b16 v[42:43], v11 offset:0
    s_waitcnt lgkmcnt(6)
    v_mfma_f32_16x16x16_bf16 a[96:99], v[44:45], v[76:77], a[96:99]
    v_mfma_f32_16x16x16_bf16 a[100:103], v[46:47], v[76:77], a[100:103]
    ds_read_b64_tr_b16 v[44:45], v6 offset:128
    ds_read_b64_tr_b16 v[46:47], v6 offset:4736
    s_waitcnt lgkmcnt(6)
    v_mfma_f32_16x16x32_bf16 a[8:11], v[48:51], v[52:55], a[8:11]
    v_mfma_f32_16x16x32_bf16 a[40:43], v[48:51], v[60:63], a[40:43]
    v_mfma_f32_16x16x32_bf16 a[72:75], v[48:51], v[68:71], a[72:75]
    ds_read_b64_tr_b16 v[48:49], v7 offset:128
    ds_read_b64_tr_b16 v[50:51], v7 offset:4736
    s_waitcnt lgkmcnt(6)
    v_mfma_f32_16x16x32_bf16 a[12:15], v[36:39], v[52:55], a[12:15]
    v_mfma_f32_16x16x32_bf16 a[44:47], v[36:39], v[60:63], a[44:47]
    v_mfma_f32_16x16x32_bf16 a[76:79], v[36:39], v[68:71], a[76:79]
    v_add_u32 v10, s78, v6
    ds_read_b64_tr_b16 v[36:37], v10 offset:128
    v_add_u32 v11, s78, v7
    ds_read_b64_tr_b16 v[38:39], v11 offset:128
    s_waitcnt lgkmcnt(6)
    v_mfma_f32_16x16x16_bf16 a[104:107], v[40:41], v[76:77], a[104:107]
    v_mfma_f32_16x16x16_bf16 a[108:111], v[42:43], v[76:77], a[108:111]
    ds_read_b64_tr_b16 v[40:41], v8 offset:128
    ds_read_b64_tr_b16 v[42:43], v8 offset:4736
    s_waitcnt lgkmcnt(6)
    v_mfma_f32_16x16x32_bf16 a[16:19], v[44:47], v[52:55], a[16:19]
    v_mfma_f32_16x16x32_bf16 a[48:51], v[44:47], v[60:63], a[48:51]
    v_mfma_f32_16x16x32_bf16 a[80:83], v[44:47], v[68:71], a[80:83]
    ds_read_b64_tr_b16 v[44:45], v9 offset:128
    ds_read_b64_tr_b16 v[46:47], v9 offset:4736
    s_waitcnt lgkmcnt(6)
    v_mfma_f32_16x16x32_bf16 a[20:23], v[48:51], v[52:55], a[20:23]
    v_mfma_f32_16x16x32_bf16 a[52:55], v[48:51], v[60:63], a[52:55]
    v_mfma_f32_16x16x32_bf16 a[84:87], v[48:51], v[68:71], a[84:87]
    v_add_u32 v10, s78, v8
    ds_read_b64_tr_b16 v[48:49], v10 offset:128
    v_add_u32 v11, s78, v9
    ds_read_b64_tr_b16 v[50:51], v11 offset:128
    s_waitcnt lgkmcnt(6)
    v_mfma_f32_16x16x16_bf16 a[112:115], v[36:37], v[76:77], a[112:115]
    v_mfma_f32_16x16x16_bf16 a[116:119], v[38:39], v[76:77], a[116:119]
    ds_read_b128 v[36:39], v4 offset:9216
    s_waitcnt lgkmcnt(5)
    v_mfma_f32_16x16x32_bf16 a[24:27], v[40:43], v[52:55], a[24:27]
    v_mfma_f32_16x16x32_bf16 a[56:59], v[40:43], v[60:63], a[56:59]
    v_mfma_f32_16x16x32_bf16 a[88:91], v[40:43], v[68:71], a[88:91]
    ds_read_b128 v[40:43], v5 offset:9216
    s_waitcnt lgkmcnt(4)
    v_mfma_f32_16x16x32_bf16 a[28:31], v[44:47], v[52:55], a[28:31]
    v_mfma_f32_16x16x32_bf16 a[60:63], v[44:47], v[60:63], a[60:63]
    v_mfma_f32_16x16x32_bf16 a[92:95], v[44:47], v[68:71], a[92:95]
    ds_read_b128 v[44:47], v4 offset:9344
    s_waitcnt lgkmcnt(3)
    v_mfma_f32_16x16x16_bf16 a[120:123], v[48:49], v[76:77], a[120:123]
    v_mfma_f32_16x16x16_bf16 a[124:127], v[50:51], v[76:77], a[124:127]
    ds_read_b128 v[48:51], v5 offset:9344
L_redo1C:
    s_waitcnt lgkmcnt(3)
    v_mfma_f32_16x16x32_bf16 v[52:55], v[36:39], a[128:131], v[12:15]
    v_mfma_f32_16x16x32_bf16 v[60:63], v[36:39], a[144:147], v[16:19]
    v_mfma_f32_16x16x32_bf16 v[68:71], v[36:39], a[160:163], v[20:23]
    ds_read_b128 v[36:39], v4 offset:13824
    s_waitcnt lgkmcnt(3)
    v_mfma_f32_16x16x32_bf16 v[52:55], v[40:43], a[132:135], v[52:55]
    v_mfma_f32_16x16x32_bf16 v[60:63], v[40:43], a[148:151], v[60:63]
    v_mfma_f32_16x16x32_bf16 v[68:71], v[40:43], a[164:167], v[68:71]
    ds_read_b128 v[40:43], v5 offset:13824
    s_waitcnt lgkmcnt(3)
    v_mfma_f32_16x16x32_bf16 v[52:55], v[44:47], a[136:139], v[52:55]
    v_mfma_f32_16x16x32_bf16 v[60:63], v[44:47], a[152:155], v[60:63]
    v_mfma_f32_16x16x32_bf16 v[68:71], v[44:47], a[168:171], v[68:71]
    ds_read_b128 v[44:47], v4 offset:13952
    s_waitcnt lgkmcnt(3)
    v_mfma_f32_16x16x32_bf16 v[52:55], v[48:51], a[140:143], v[52:55]
    v_mfma_f32_16x16x32_bf16 v[60:63], v[48:51], a[156:159], v[60:63]
    v_mfma_f32_16x16x32_bf16 v[68:71], v[48:51], a[172:175], v[68:71]
    ds_read_b128 v[48:51], v5 offset:13952
    s_waitcnt lgkmcnt(3)
    v_mfma_f32_16x16x32_bf16 v[56:59], v[36:39], a[128:131], v[12:15]
    v_mfma_f32_16x16x32_bf16 v[64:67], v[36:39], a[144:147], v[16:19]
    v_mfma_f32_16x16x32_bf16 v[72:75], v[36:39], a[160:163], v[20:23]
    ds_read_b64_tr_b16 v[36:37], v6 offset:9216
    ds_read_b64_tr_b16 v[38:39], v6 offset:13824
    s_waitcnt lgkmcnt(4)
    v_mfma_f32_16x16x32_bf16 v[56:59], v[40:43], a[132:135], v[56:59]
    v_mfma_f32_16x16x32_bf16 v[64:67], v[40:43], a[148:151], v[64:67]
    v_mfma_f32_16x16x32_bf16 v[72:75], v[40:43], a[164:167], v[72:75]
    ds_read_b64_tr_b16 v[40:41], v7 offset:9216
    ds_read_b64_tr_b16 v[42:43], v7 offset:13824
    s_waitcnt lgkmcnt(5)
    v_mfma_f32_16x16x32_bf16 v[56:59], v[44:47], a[136:139], v[56:59]
    v_mfma_f32_16x16x32_bf16 v[64:67], v[44:47], a[152:155], v[64:67]
    v_mfma_f32_16x16x32_bf16 v[72:75], v[44:47], a[168:171], v[72:75]
    ds_read_b64_tr_b16 v[44:45], v8 offset:9216
    ds_read_b64_tr_b16 v[46:47], v8 offset:13824
    s_waitcnt lgkmcnt(6)
    v_mfma_f32_16x16x32_bf16 v[56:59], v[48:51], a[140:143], v[56:59]
    v_mfma_f32_16x16x32_bf16 v[64:67], v[48:51], a[156:159], v[64:67]
    v_mfma_f32_16x16x32_bf16 v[72:75], v[48:51], a[172:175], v[72:75]
    ds_read_b64_tr_b16 v[48:49], v9 offset:9216
    ds_read_b64_tr_b16 v[50:51], v9 offset:13824
    s_cmp_lg_u32 s84, 0
    s_cbranch_scc1 L_exact1C
L_exret1C:
    s_nop 1
    v_exp_f32 v52, v52
    v_exp_f32 v53, v53
    v_exp_f32 v54, v54
    v_exp_f32 v55, v55
    v_exp_f32 v56, v56
    v_exp_f32 v57, v57
    v_exp_f32 v58, v58
    v_exp_f32 v59, v59
    v_add_f32 v29, v52, v53
    v_add_f32 v29, v29, v54
    v_add_f32 v29, v29, v55
    v_add_f32 v29, v29, v56
    v_add_f32 v29, v29, v57
    v_add_f32 v29, v29, v58
    v_add_f32 v29, v29, v59
    v_cvt_pk_bf16_f32 v52, v52, v53
    v_cvt_pk_bf16_f32 v53, v54, v55
    v_cvt_pk_bf16_f32 v54, v56, v57
    v_cvt_pk_bf16_f32 v55, v58, v59
    v_exp_f32 v60, v60
    v_exp_f32 v61, v61
    v_exp_f32 v62, v62
    v_exp_f32 v63, v63
    v_exp_f32 v64, v64
    v_exp_f32 v65, v65
    v_exp_f32 v66, v66
    v_exp_f32 v67, v67
    v_add_f32 v30, v60, v61
    v_add_f32 v30, v30, v62
    v_add_f32 v30, v30, v63
    v_add_f32 v30, v30, v64
    v_add_f32 v30, v30, v65
    v_add_f32 v30, v30, v66
    v_add_f32 v30, v30, v67
    v_cvt_pk_bf16_f32 v60, v60, v61
    v_cvt_pk_bf16_f32 v61, v62, v63
    v_cvt_pk_bf16_f32 v62, v64, v65
    v_cvt_pk_bf16_f32 v63, v66, v67
    v_exp_f32 v68, v68
    v_exp_f32 v69, v69
    v_exp_f32 v70, v70
    v_exp_f32 v71, v71
    v_exp_f32 v72, v72
    v_exp_f32 v73, v73
    v_exp_f32 v74, v74
    v_exp_f32 v75, v75
    v_add_f32 v31, v68, v69
    v_add_f32 v31, v31, v70
    v_add_f32 v31, v31, v71
    v_add_f32 v31, v31, v72
    v_add_f32 v31, v31, v73
    v_add_f32 v31, v31, v74
    v_add_f32 v31, v31, v75
    v_cvt_pk_bf16_f32 v68, v68, v69
    v_cvt_pk_bf16_f32 v69, v70, v71
    v_cvt_pk_bf16_f32 v70, v72, v73
    v_cvt_pk_bf16_f32 v71, v74, v75
    v_max3_f32 v33, v29, v30, v31
    v_cmp_lt_f32 vcc, s83, v33
    s_cbranch_vccnz L_fix1C
L_fixret1C:
    s_mov_b32 s84, 0
    v_add_f32 v25, v25, v29
    v_add_f32 v26, v26, v30
    v_add_f32 v27, v27, v31
    s_waitcnt lgkmcnt(6)
    v_mfma_f32_16x16x32_bf16 a[0:3], v[36:39], v[52:55], a[0:3]
    v_mfma_f32_16x16x32_bf16 a[32:35], v[36:39], v[60:63], a[32:35]
    v_mfma_f32_16x16x32_bf16 a[64:67], v[36:39], v[68:71], a[64:67]
    ds_read_b64_tr_b16 v[36:37], v6 offset:9344
    ds_read_b64_tr_b16 v[38:39], v6 offset:13952
    s_waitcnt lgkmcnt(6)
    v_mfma_f32_16x16x32_bf16 a[4:7], v[40:43], v[52:55], a[4:7]
    v_mfma_f32_16x16x32_bf16 a[36:39], v[40:43], v[60:63], a[36:39]
    v_mfma_f32_16x16x32_bf16 a[68:71], v[40:43], v[68:71], a[68:71]
    ds_read_b64_tr_b16 v[40:41], v7 offset:9344
    ds_read_b64_tr_b16 v[42:43], v7 offset:13952
    s_waitcnt lgkmcnt(6)
    v_mfma_f32_16x16x32_bf16 a[8:11], v[44:47], v[52:55], a[8:11]
    v_mfma_f32_16x16x32_bf16 a[40:43], v[44:47], v[60:63], a[40:43]
    v_mfma_f32_16x16x32_bf16 a[72:75], v[44:47], v[68:71], a[72:75]
    ds_read_b64_tr_b16 v[44:45], v8 offset:9344
    ds_read_b64_tr_b16 v[46:47], v8 offset:13952
    s_waitcnt lgkmcnt(6)
    v_mfma_f32_16x16x32_bf16 a[12:15], v[48:51], v[52:55], a[12:15]
    v_mfma_f32_16x16x32_bf16 a[44:47], v[48:51], v[60:63], a[44:47]
    v_mfma_f32_16x16x32_bf16 a[76:79], v[48:51], v[68:71], a[76:79]
    ds_read_b64_tr_b16 v[48:49], v9 offset:9344
    ds_read_b64_tr_b16 v[50:51], v9 offset:13952
    s_waitcnt lgkmcnt(6)
    v_mfma_f32_16x16x32_bf16 a[16:19], v[36:39], v[52:55], a[16:19]
    v_mfma_f32_16x16x32_bf16 a[48:51], v[36:39], v[60:63], a[48:51]
    v_mfma_f32_16x16x32_bf16 a[80:83], v[36:39], v[68:71], a[80:83]
    s_waitcnt lgkmcnt(4)
    v_mfma_f32_16x16x32_bf16 a[20:23], v[40:43], v[52:55], a[20:23]
    v_mfma_f32_16x16x32_bf16 a[52:55], v[40:43], v[60:63], a[52:55]
    v_mfma_f32_16x16x32_bf16 a[84:87], v[40:43], v[68:71], a[84:87]
    s_waitcnt lgkmcnt(2)
    v_mfma_f32_16x16x32_bf16 a[24:27], v[44:47], v[52:55], a[24:27]
    v_mfma_f32_16x16x32_bf16 a[56:59], v[44:47], v[60:63], a[56:59]
    v_mfma_f32_16x16x32_bf16 a[88:91], v[44:47], v[68:71], a[88:91]
    s_waitcnt lgkmcnt(0)
    v_mfma_f32_16x16x32_bf16 a[28:31], v[48:51], v[52:55], a[28:31]
    v_mfma_f32_16x16x32_bf16 a[60:63], v[48:51], v[60:63], a[60:63]
    v_mfma_f32_16x16x32_bf16 a[92:95], v[48:51], v[68:71], a[92:95]
    v_mov_b32 v33, v28
    s_nop 1
    v_permlane32_swap_b32 v33, v28
    v_add_f32 v28, v28, v33
    v_mov_b32 v33, v28
    s_nop 1
    v_permlane16_swap_b32 v33, v28
    v_add_f32 v28, v28, v33
    v_mov_b32 v33, v25
    s_nop 1
    v_permlane32_swap_b32 v33, v25
    v_add_f32 v25, v25, v33
    v_mov_b32 v33, v25
    s_nop 1
    v_permlane16_swap_b32 v33, v25
    v_add_f32 v25, v25, v33
    v_mov_b32 v33, v26
    s_nop 1
    v_permlane32_swap_b32 v33, v26
    v_add_f32 v26, v26, v33
    v_mov_b32 v33, v26
    s_nop 1
    v_permlane16_swap_b32 v33, v26
    v_add_f32 v26, v26, v33
    v_mov_b32 v33, v27
    s_nop 1
    v_permlane32_swap_b32 v33, v27
    v_add_f32 v27, v27, v33
    v_mov_b32 v33, v27
    s_nop 1
    v_permlane16_swap_b32 v33, v27
    v_add_f32 v27, v27, v33
    s_lshl_b32 s87, s71, 13
    s_add_u32 s87, s87, 36864
    v_add_u32 v34, s87, v1
    ds_write_b128 v34, a[96:99] offset:0
    ds_write_b128 v34, a[100:103] offset:1024
    ds_write_b128 v34, a[104:107] offset:2048
    ds_write_b128 v34, a[108:111] offset:3072
    ds_write_b128 v34, a[112:115] offset:4096
    ds_write_b128 v34, a[116:119] offset:5120
    ds_write_b128 v34, a[120:123] offset:6144
    ds_write_b128 v34, a[124:127] offset:7168
    v_lshrrev_b32 v10, 1, v1
    v_add_u32 v10, 36864, v10
    s_lshl_b32 s87, s71, 9
    v_add_u32 v11, s87, v10
    v_mov_b32 v30, v24
    v_mov_b32 v31, v28
    ds_write_b64 v11, v[30:31] offset:32768
    v_rcp_f32 v12, v25
    v_rcp_f32 v16, v26
    v_rcp_f32 v20, v27
    s_waitcnt lgkmcnt(0)
    s_barrier
    ds_read_b64 v[64:65], v10 offset:32768
    ds_read_b64 v[66:67], v10 offset:33280
    ds_read_b64 v[68:69], v10 offset:33792
    ds_read_b64 v[70:71], v10 offset:34304
    s_lshl_b32 s87, s71, 11
    s_add_u32 s87, s87, 36864
    v_add_u32 v34, s87, v1
    ds_read_b128 a[96:99], v34 offset:0
    ds_read_b128 a[100:103], v34 offset:1024
    ds_read_b128 a[104:107], v34 offset:8192
    ds_read_b128 a[108:111], v34 offset:9216
    ds_read_b128 a[112:115], v34 offset:16384
    ds_read_b128 a[116:119], v34 offset:17408
    ds_read_b128 a[120:123], v34 offset:24576
    ds_read_b128 a[124:127], v34 offset:25600
    s_mul_i32 s88, s71, 3072
    s_add_u32 s88, s88, s91
    v_accvgpr_read_b32 v36, a0
    v_accvgpr_read_b32 v37, a1
    v_accvgpr_read_b32 v38, a2
    v_accvgpr_read_b32 v39, a3
    v_accvgpr_read_b32 v40, a4
    v_accvgpr_read_b32 v41, a5
    v_accvgpr_read_b32 v42, a6
    v_accvgpr_read_b32 v43, a7
    v_mul_f32 v36, v12, v36
    v_mul_f32 v37, v12, v37
    v_mul_f32 v38, v12, v38
    v_mul_f32 v39, v12, v39
    v_mul_f32 v40, v12, v40
    v_mul_f32 v41, v12, v41
    v_mul_f32 v42, v12, v42
    v_mul_f32 v43, v12, v43
    v_cvt_pk_bf16_f32 v52, v36, v37
    v_cvt_pk_bf16_f32 v53, v38, v39
    v_cvt_pk_bf16_f32 v54, v40, v41
    v_cvt_pk_bf16_f32 v55, v42, v43
    s_add_u32 s87, s88, 0
    buffer_store_dwordx4 v[52:55], v1, s[64:67], s87 offen
    v_accvgpr_read_b32 v44, a8
    v_accvgpr_read_b32 v45, a9
    v_accvgpr_read_b32 v46, a10
    v_accvgpr_read_b32 v47, a11
    v_accvgpr_read_b32 v48, a12
    v_accvgpr_read_b32 v49, a13
    v_accvgpr_read_b32 v50, a14
    v_accvgpr_read_b32 v51, a15
    v_mul_f32 v44, v12, v44
    v_mul_f32 v45, v12, v45
    v_mul_f32 v46, v12, v46
    v_mul_f32 v47, v12, v47
    v_mul_f32 v48, v12, v48
    v_mul_f32 v49, v12, v49
    v_mul_f32 v50, v12, v50
    v_mul_f32 v51, v12, v51
    v_cvt_pk_bf16_f32 v56, v44, v45
    v_cvt_pk_bf16_f32 v57, v46, v47
    v_cvt_pk_bf16_f32 v58, v48, v49
    v_cvt_pk_bf16_f32 v59, v50, v51
    s_add_u32 s87, s88, 106496
    buffer_store_dwordx4 v[56:59], v1, s[64:67], s87 offen
    v_accvgpr_read_b32 v36, a16
    v_accvgpr_read_b32 v37, a17
    v_accvgpr_read_b32 v38, a18
    v_accvgpr_read_b32 v39, a19
    v_accvgpr_read_b32 v40, a20
    v_accvgpr_read_b32 v41, a21
    v_accvgpr_read_b32 v42, a22
    v_accvgpr_read_b32 v43, a23
    v_mul_f32 v36, v12, v36
    v_mul_f32 v37, v12, v37
    v_mul_f32 v38, v12, v38
    v_mul_f32 v39, v12, v39
    v_mul_f32 v40, v12, v40
    v_mul_f32 v41, v12, v41
    v_mul_f32 v42, v12, v42
    v_mul_f32 v43, v12, v43
    v_cvt_pk_bf16_f32 v60, v36, v37
    v_cvt_pk_bf16_f32 v61, v38, v39
    v_cvt_pk_bf16_f32 v62, v40, v41
    v_cvt_pk_bf16_f32 v63, v42, v43
    s_add_u32 s87, s88, 212992
    buffer_store_dwordx4 v[60:63], v1, s[64:67], s87 offen
    v_accvgpr_read_b32 v44, a24
    v_accvgpr_read_b32 v45, a25
    v_accvgpr_read_b32 v46, a26
    v_accvgpr_read_b32 v47, a27
    v_accvgpr_read_b32 v48, a28
    v_accvgpr_read_b32 v49, a29
    v_accvgpr_read_b32 v50, a30
    v_accvgpr_read_b32 v51, a31
    v_mul_f32 v44, v12, v44
    v_mul_f32 v45, v12, v45
    v_mul_f32 v46, v12, v46
    v_mul_f32 v47, v12, v47
    v_mul_f32 v48, v12, v48
    v_mul_f32 v49, v12, v49
    v_mul_f32 v50, v12, v50
    v_mul_f32 v51, v12, v51
    v_cvt_pk_bf16_f32 v52, v44, v45
    v_cvt_pk_bf16_f32 v53, v46, v47
    v_cvt_pk_bf16_f32 v54, v48, v49
    v_cvt_pk_bf16_f32 v55, v50, v51
    s_add_u32 s87, s88, 319488
    buffer_store_dwordx4 v[52:55], v1, s[64:67], s87 offen
    v_accvgpr_read_b32 v36, a32
    v_accvgpr_read_b32 v37, a33
    v_accvgpr_read_b32 v38, a34
    v_accvgpr_read_b32 v39, a35
    v_accvgpr_read_b32 v40, a36
    v_accvgpr_read_b32 v41, a37
    v_accvgpr_read_b32 v42, a38
    v_accvgpr_read_b32 v43, a39
    v_mul_f32 v36, v16, v36
    v_mul_f32 v37, v16, v37
    v_mul_f32 v38, v16, v38
    v_mul_f32 v39, v16, v39
    v_mul_f32 v40, v16, v40
    v_mul_f32 v41, v16, v41
    v_mul_f32 v42, v16, v42
    v_mul_f32 v43, v16, v43
    v_cvt_pk_bf16_f32 v56, v36, v37
    v_cvt_pk_bf16_f32 v57, v38, v39
    v_cvt_pk_bf16_f32 v58, v40, v41
    v_cvt_pk_bf16_f32 v59, v42, v43
    s_add_u32 s87, s88, 1024
    buffer_store_dwordx4 v[56:59], v1, s[64:67], s87 offen
    v_accvgpr_read_b32 v44, a40
    v_accvgpr_read_b32 v45, a41
    v_accvgpr_read_b32 v46, a42
    v_accvgpr_read_b32 v47, a43
    v_accvgpr_read_b32 v48, a44
    v_accvgpr_read_b32 v49, a45
    v_accvgpr_read_b32 v50, a46
    v_accvgpr_read_b32 v51, a47
    v_mul_f32 v44, v16, v44
    v_mul_f32 v45, v16, v45
    v_mul_f32 v46, v16, v46
    v_mul_f32 v47, v16, v47
    v_mul_f32 v48, v16, v48
    v_mul_f32 v49, v16, v49
    v_mul_f32 v50, v16, v50
    v_mul_f32 v51, v16, v51
    v_cvt_pk_bf16_f32 v60, v44, v45
    v_cvt_pk_bf16_f32 v61, v46, v47
    v_cvt_pk_bf16_f32 v62, v48, v49
    v_cvt_pk_bf16_f32 v63, v50, v51
    s_add_u32 s87, s88, 107520
    buffer_store_dwordx4 v[60:63], v1, s[64:67], s87 offen
    v_accvgpr_read_b32 v36, a48
    v_accvgpr_read_b32 v37, a49
    v_accvgpr_read_b32 v38, a50
    v_accvgpr_read_b32 v39, a51
    v_accvgpr_read_b32 v40, a52
    v_accvgpr_read_b32 v41, a53
    v_accvgpr_read_b32 v42, a54
    v_accvgpr_read_b32 v43, a55
    v_mul_f32 v36, v16, v36
    v_mul_f32 v37, v16, v37
    v_mul_f32 v38, v16, v38
    v_mul_f32 v39, v16, v39
    v_mul_f32 v40, v16, v40
    v_mul_f32 v41, v16, v41
    v_mul_f32 v42, v16, v42
    v_mul_f32 v43, v16, v43
    v_cvt_pk_bf16_f32 v52, v36, v37
    v_cvt_pk_bf16_f32 v53, v38, v39
    v_cvt_pk_bf16_f32 v54, v40, v41
    v_cvt_pk_bf16_f32 v55, v42, v43
    s_add_u32 s87, s88, 214016
    buffer_store_dwordx4 v[52:55], v1, s[64:67], s87 offen
    v_accvgpr_read_b32 v44, a56
    v_accvgpr_read_b32 v45, a57
    v_accvgpr_read_b32 v46, a58
    v_accvgpr_read_b32 v47, a59
    v_accvgpr_read_b32 v48, a60
    v_accvgpr_read_b32 v49, a61
    v_accvgpr_read_b32 v50, a62
    v_accvgpr_read_b32 v51, a63
    v_mul_f32 v44, v16, v44
    v_mul_f32 v45, v16, v45
    v_mul_f32 v46, v16, v46
    v_mul_f32 v47, v16, v47
    v_mul_f32 v48, v16, v48
    v_mul_f32 v49, v16, v49
    v_mul_f32 v50, v16, v50
    v_mul_f32 v51, v16, v51
    v_cvt_pk_bf16_f32 v56, v44, v45
    v_cvt_pk_bf16_f32 v57, v46, v47
    v_cvt_pk_bf16_f32 v58, v48, v49
    v_cvt_pk_bf16_f32 v59, v50, v51
    s_add_u32 s87, s88, 320512
    buffer_store_dwordx4 v[56:59], v1, s[64:67], s87 offen
    v_accvgpr_read_b32 v36, a64
    v_accvgpr_read_b32 v37, a65
    v_accvgpr_read_b32 v38, a66
    v_accvgpr_read_b32 v39, a67
    v_accvgpr_read_b32 v40, a68
    v_accvgpr_read_b32 v41, a69
    v_accvgpr_read_b32 v42, a70
    v_accvgpr_read_b32 v43, a71
    v_mul_f32 v36, v20, v36
    v_mul_f32 v37, v20, v37
    v_mul_f32 v38, v20, v38
    v_mul_f32 v39, v20, v39
    v_mul_f32 v40, v20, v40
    v_mul_f32 v41, v20, v41
    v_mul_f32 v42, v20, v42
    v_mul_f32 v43, v20, v43
    v_cvt_pk_bf16_f32 v60, v36, v37
    v_cvt_pk_bf16_f32 v61, v38, v39
    v_cvt_pk_bf16_f32 v62, v40, v41
    v_cvt_pk_bf16_f32 v63, v42, v43
    s_add_u32 s87, s88, 2048
    buffer_store_dwordx4 v[60:63], v1, s[64:67], s87 offen
    v_accvgpr_read_b32 v44, a72
    v_accvgpr_read_b32 v45, a73
    v_accvgpr_read_b32 v46, a74
    v_accvgpr_read_b32 v47, a75
    v_accvgpr_read_b32 v48, a76
    v_accvgpr_read_b32 v49, a77
    v_accvgpr_read_b32 v50, a78
    v_accvgpr_read_b32 v51, a79
    v_mul_f32 v44, v20, v44
    v_mul_f32 v45, v20, v45
    v_mul_f32 v46, v20, v46
    v_mul_f32 v47, v20, v47
    v_mul_f32 v48, v20, v48
    v_mul_f32 v49, v20, v49
    v_mul_f32 v50, v20, v50
    v_mul_f32 v51, v20, v51
    v_cvt_pk_bf16_f32 v52, v44, v45
    v_cvt_pk_bf16_f32 v53, v46, v47
    v_cvt_pk_bf16_f32 v54, v48, v49
    v_cvt_pk_bf16_f32 v55, v50, v51
    s_add_u32 s87, s88, 108544
    buffer_store_dwordx4 v[52:55], v1, s[64:67], s87 offen
    v_accvgpr_read_b32 v36, a80
    v_accvgpr_read_b32 v37, a81
    v_accvgpr_read_b32 v38, a82
    v_accvgpr_read_b32 v39, a83
    v_accvgpr_read_b32 v40, a84
    v_accvgpr_read_b32 v41, a85
    v_accvgpr_read_b32 v42, a86
    v_accvgpr_read_b32 v43, a87
    v_mul_f32 v36, v20, v36
    v_mul_f32 v37, v20, v37
    v_mul_f32 v38, v20, v38
    v_mul_f32 v39, v20, v39
    v_mul_f32 v40, v20, v40
    v_mul_f32 v41, v20, v41
    v_mul_f32 v42, v20, v42
    v_mul_f32 v43, v20, v43
    v_cvt_pk_bf16_f32 v56, v36, v37
    v_cvt_pk_bf16_f32 v57, v38, v39
    v_cvt_pk_bf16_f32 v58, v40, v41
    v_cvt_pk_bf16_f32 v59, v42, v43
    s_add_u32 s87, s88, 215040
    buffer_store_dwordx4 v[56:59], v1, s[64:67], s87 offen
    v_accvgpr_read_b32 v44, a88
    v_accvgpr_read_b32 v45, a89
    v_accvgpr_read_b32 v46, a90
    v_accvgpr_read_b32 v47, a91
    v_accvgpr_read_b32 v48, a92
    v_accvgpr_read_b32 v49, a93
    v_accvgpr_read_b32 v50, a94
    v_accvgpr_read_b32 v51, a95
    v_mul_f32 v44, v20, v44
    v_mul_f32 v45, v20, v45
    v_mul_f32 v46, v20, v46
    v_mul_f32 v47, v20, v47
    v_mul_f32 v48, v20, v48
    v_mul_f32 v49, v20, v49
    v_mul_f32 v50, v20, v50
    v_mul_f32 v51, v20, v51
    v_cvt_pk_bf16_f32 v60, v44, v45
    v_cvt_pk_bf16_f32 v61, v46, v47
    v_cvt_pk_bf16_f32 v62, v48, v49
    v_cvt_pk_bf16_f32 v63, v50, v51
    s_add_u32 s87, s88, 321536
    buffer_store_dwordx4 v[60:63], v1, s[64:67], s87 offen
    s_waitcnt lgkmcnt(0)
    v_min_f32 v33, v64, v66
    v_min3_f32 v33, v33, v68, v70
    v_sub_f32 v64, v33, v64
    v_sub_f32 v66, v33, v66
    v_sub_f32 v68, v33, v68
    v_sub_f32 v70, v33, v70
    v_exp_f32 v64, v64
    v_exp_f32 v66, v66
    v_exp_f32 v68, v68
    v_exp_f32 v70, v70
    s_nop 0
    v_mul_f32 v33, v64, v65
    v_fmac_f32 v33, v66, v67
    v_fmac_f32 v33, v68, v69
    v_fmac_f32 v33, v70, v71
    v_rcp_f32 v33, v33
    s_nop 0
    v_mul_f32 v64, v64, v33
    v_mul_f32 v66, v66, v33
    v_mul_f32 v68, v68, v33
    v_mul_f32 v70, v70, v33
    v_accvgpr_read_b32 v34, a96
    v_mul_f32 v36, v34, v64
    v_accvgpr_read_b32 v10, a104
    v_fmac_f32 v36, v10, v66
    v_accvgpr_read_b32 v34, a112
    v_fmac_f32 v36, v34, v68
    v_accvgpr_read_b32 v10, a120
    v_fmac_f32 v36, v10, v70
    v_accvgpr_read_b32 v34, a97
    v_mul_f32 v37, v34, v64
    v_accvgpr_read_b32 v10, a105
    v_fmac_f32 v37, v10, v66
    v_accvgpr_read_b32 v34, a113
    v_fmac_f32 v37, v34, v68
    v_accvgpr_read_b32 v10, a121
    v_fmac_f32 v37, v10, v70
    v_accvgpr_read_b32 v34, a98
    v_mul_f32 v38, v34, v64
    v_accvgpr_read_b32 v10, a106
    v_fmac_f32 v38, v10, v66
    v_accvgpr_read_b32 v34, a114
    v_fmac_f32 v38, v34, v68
    v_accvgpr_read_b32 v10, a122
    v_fmac_f32 v38, v10, v70
    v_accvgpr_read_b32 v34, a99
    v_mul_f32 v39, v34, v64
    v_accvgpr_read_b32 v10, a107
    v_fmac_f32 v39, v10, v66
    v_accvgpr_read_b32 v34, a115
    v_fmac_f32 v39, v34, v68
    v_accvgpr_read_b32 v10, a123
    v_fmac_f32 v39, v10, v70
    v_accvgpr_read_b32 v34, a100
    v_mul_f32 v40, v34, v64
    v_accvgpr_read_b32 v10, a108
    v_fmac_f32 v40, v10, v66
    v_accvgpr_read_b32 v34, a116
    v_fmac_f32 v40, v34, v68
    v_accvgpr_read_b32 v10, a124
    v_fmac_f32 v40, v10, v70
    v_accvgpr_read_b32 v34, a101
    v_mul_f32 v41, v34, v64
    v_accvgpr_read_b32 v10, a109
    v_fmac_f32 v41, v10, v66
    v_accvgpr_read_b32 v34, a117
    v_fmac_f32 v41, v34, v68
    v_accvgpr_read_b32 v10, a125
    v_fmac_f32 v41, v10, v70
    v_accvgpr_read_b32 v34, a102
    v_mul_f32 v42, v34, v64
    v_accvgpr_read_b32 v10, a110
    v_fmac_f32 v42, v10, v66
    v_accvgpr_read_b32 v34, a118
    v_fmac_f32 v42, v34, v68
    v_accvgpr_read_b32 v10, a126
    v_fmac_f32 v42, v10, v70
    v_accvgpr_read_b32 v34, a103
    v_mul_f32 v43, v34, v64
    v_accvgpr_read_b32 v10, a111
    v_fmac_f32 v43, v10, v66
    v_accvgpr_read_b32 v34, a119
    v_fmac_f32 v43, v34, v68
    v_accvgpr_read_b32 v10, a127
    v_fmac_f32 v43, v10, v70
    v_cvt_pk_bf16_f32 v44, v36, v37
    v_cvt_pk_bf16_f32 v45, v38, v39
    v_cvt_pk_bf16_f32 v46, v40, v41
    v_cvt_pk_bf16_f32 v47, v42, v43
    s_mul_i32 s87, s71, 106496
    s_add_u32 s87, s87, s91
    s_add_u32 s87, s87, 12288
    buffer_store_dwordx4 v[44:47], v1, s[64:67], s87 offen
L_attn_end:
    s_endpgm
L_fix0A:
    s_cmp_lg_u32 s84, 0
    s_cbranch_scc1 L_fixret0A
    s_mov_b32 s84, 1
    s_waitcnt lgkmcnt(0)
    ds_read_b128 v[36:39], v4 offset:0
    v_add_u32 v10, s78, v4
    ds_read_b128 v[40:43], v10 offset:0
    ds_read_b128 v[44:47], v3 offset:0
    ds_read_b128 v[48:51], v5 offset:0
    s_waitcnt lgkmcnt(0)
    s_branch L_redo0A
L_exact0A:
    s_nop 15
    v_max3_f32 v34, v52, v53, v54
    v_max3_f32 v34, v34, v55, v56
    v_max3_f32 v34, v34, v57, v58
    v_max_f32 v34, v34, v59
    v_mov_b32 v33, v34
    s_nop 1
    v_permlane32_swap_b32 v33, v34
    v_max_f32 v34, v34, v33
    v_mov_b32 v33, v34
    s_nop 1
    v_permlane16_swap_b32 v33, v34
    v_max_f32 v34, v34, v33
    v_sub_f32 v34, 0, v34
    v_min_f32 v34, s90, v34
    v_add_f32 v12, v12, v34
    v_add_f32 v13, v13, v34
    v_add_f32 v14, v14, v34
    v_add_f32 v15, v15, v34
    v_add_f32 v52, v52, v34
    v_add_f32 v53, v53, v34
    v_add_f32 v54, v54, v34
    v_add_f32 v55, v55, v34
    v_add_f32 v56, v56, v34
    v_add_f32 v57, v57, v34
    v_add_f32 v58, v58, v34
    v_add_f32 v59, v59, v34
    v_exp_f32 v29, v34
    v_max3_f32 v34, v60, v61, v62
    v_max3_f32 v34, v34, v63, v64
    v_max3_f32 v34, v34, v65, v66
    v_max_f32 v34, v34, v67
    v_mov_b32 v33, v34
    s_nop 1
    v_permlane32_swap_b32 v33, v34
    v_max_f32 v34, v34, v33
    v_mov_b32 v33, v34
    s_nop 1
    v_permlane16_swap_b32 v33, v34
    v_max_f32 v34, v34, v33
    v_sub_f32 v34, 0, v34
    v_min_f32 v34, s90, v34
    v_add_f32 v16, v16, v34
    v_add_f32 v17, v17, v34
    v_add_f32 v18, v18, v34
    v_add_f32 v19, v19, v34
    v_add_f32 v60, v60, v34
    v_add_f32 v61, v61, v34
    v_add_f32 v62, v62, v34
    v_add_f32 v63, v63, v34
    v_add_f32 v64, v64, v34
    v_add_f32 v65, v65, v34
    v_add_f32 v66, v66, v34
    v_add_f32 v67, v67, v34
    v_exp_f32 v30, v34
    v_max3_f32 v34, v68, v69, v70
    v_max3_f32 v34, v34, v71, v72
    v_max3_f32 v34, v34, v73, v74
    v_max_f32 v34, v34, v75
    v_mov_b32 v33, v34
    s_nop 1
    v_permlane32_swap_b32 v33, v34
    v_max_f32 v34, v34, v33
    v_mov_b32 v33, v34
    s_nop 1
    v_permlane16_swap_b32 v33, v34
    v_max_f32 v34, v34, v33
    v_sub_f32 v34, 0, v34
    v_min_f32 v34, s90, v34
    v_add_f32 v20, v20, v34
    v_add_f32 v21, v21, v34
    v_add_f32 v22, v22, v34
    v_add_f32 v23, v23, v34
    v_add_f32 v68, v68, v34
    v_add_f32 v69, v69, v34
    v_add_f32 v70, v70, v34
    v_add_f32 v71, v71, v34
    v_add_f32 v72, v72, v34
    v_add_f32 v73, v73, v34
    v_add_f32 v74, v74, v34
    v_add_f32 v75, v75, v34
    v_exp_f32 v31, v34
    v_max3_f32 v34, v76, v77, v78
    v_max_f32 v34, v34, v79
    v_mov_b32 v33, v34
    s_nop 1
    v_permlane32_swap_b32 v33, v34
    v_max_f32 v34, v34, v33
    v_mov_b32 v33, v34
    s_nop 1
    v_permlane16_swap_b32 v33, v34
    v_max_f32 v34, v34, v33
    v_add_f32 v34, v34, v24
    v_sub_f32 v34, 0, v34
    v_min_f32 v34, s90, v34
    v_add_f32 v24, v24, v34
    v_exp_f32 v32, v34
    s_mov_b32 s90, 0
    s_cmp_lg_u32 s85, 0
    s_mov_b32 s85, 0
    s_cbranch_scc1 L_exret0A
    v_mul_f32 v25, v25, v29
    v_accvgpr_read_b32 v33, a0
    v_accvgpr_read_b32 v34, a1
    v_mul_f32 v33, v33, v29
    v_mul_f32 v34, v34, v29
    v_accvgpr_write_b32 a0, v33
    v_accvgpr_write_b32 a1, v34
    v_accvgpr_read_b32 v33, a2
    v_accvgpr_read_b32 v34, a3
    v_mul_f32 v33, v33, v29
    v_mul_f32 v34, v34, v29
    v_accvgpr_write_b32 a2, v33
    v_accvgpr_write_b32 a3, v34
    v_accvgpr_read_b32 v33, a4
    v_accvgpr_read_b32 v34, a5
    v_mul_f32 v33, v33, v29
    v_mul_f32 v34, v34, v29
    v_accvgpr_write_b32 a4, v33
    v_accvgpr_write_b32 a5, v34
    v_accvgpr_read_b32 v33, a6
    v_accvgpr_read_b32 v34, a7
    v_mul_f32 v33, v33, v29
    v_mul_f32 v34, v34, v29
    v_accvgpr_write_b32 a6, v33
    v_accvgpr_write_b32 a7, v34
    v_accvgpr_read_b32 v33, a8
    v_accvgpr_read_b32 v34, a9
    v_mul_f32 v33, v33, v29
    v_mul_f32 v34, v34, v29
    v_accvgpr_write_b32 a8, v33
    v_accvgpr_write_b32 a9, v34
    v_accvgpr_read_b32 v33, a10
    v_accvgpr_read_b32 v34, a11
    v_mul_f32 v33, v33, v29
    v_mul_f32 v34, v34, v29
    v_accvgpr_write_b32 a10, v33
    v_accvgpr_write_b32 a11, v34
    v_accvgpr_read_b32 v33, a12
    v_accvgpr_read_b32 v34, a13
    v_mul_f32 v33, v33, v29
    v_mul_f32 v34, v34, v29
    v_accvgpr_write_b32 a12, v33
    v_accvgpr_write_b32 a13, v34
    v_accvgpr_read_b32 v33, a14
    v_accvgpr_read_b32 v34, a15
    v_mul_f32 v33, v33, v29
    v_mul_f32 v34, v34, v29
    v_accvgpr_write_b32 a14, v33
    v_accvgpr_write_b32 a15, v34
    v_accvgpr_read_b32 v33, a16
    v_accvgpr_read_b32 v34, a17
    v_mul_f32 v33, v33, v29
    v_mul_f32 v34, v34, v29
    v_accvgpr_write_b32 a16, v33
    v_accvgpr_write_b32 a17, v34
    v_accvgpr_read_b32 v33, a18
    v_accvgpr_read_b32 v34, a19
    v_mul_f32 v33, v33, v29
    v_mul_f32 v34, v34, v29
    v_accvgpr_write_b32 a18, v33
    v_accvgpr_write_b32 a19, v34
    v_accvgpr_read_b32 v33, a20
    v_accvgpr_read_b32 v34, a21
    v_mul_f32 v33, v33, v29
    v_mul_f32 v34, v34, v29
    v_accvgpr_write_b32 a20, v33
    v_accvgpr_write_b32 a21, v34
    v_accvgpr_read_b32 v33, a22
    v_accvgpr_read_b32 v34, a23
    v_mul_f32 v33, v33, v29
    v_mul_f32 v34, v34, v29
    v_accvgpr_write_b32 a22, v33
    v_accvgpr_write_b32 a23, v34
    v_accvgpr_read_b32 v33, a24
    v_accvgpr_read_b32 v34, a25
    v_mul_f32 v33, v33, v29
    v_mul_f32 v34, v34, v29
    v_accvgpr_write_b32 a24, v33
    v_accvgpr_write_b32 a25, v34
    v_accvgpr_read_b32 v33, a26
    v_accvgpr_read_b32 v34, a27
    v_mul_f32 v33, v33, v29
    v_mul_f32 v34, v34, v29
    v_accvgpr_write_b32 a26, v33
    v_accvgpr_write_b32 a27, v34
    v_accvgpr_read_b32 v33, a28
    v_accvgpr_read_b32 v34, a29
    v_mul_f32 v33, v33, v29
    v_mul_f32 v34, v34, v29
    v_accvgpr_write_b32 a28, v33
    v_accvgpr_write_b32 a29, v34
    v_accvgpr_read_b32 v33, a30
    v_accvgpr_read_b32 v34, a31
    v_mul_f32 v33, v33, v29
    v_mul_f32 v34, v34, v29
    v_accvgpr_write_b32 a30, v33
    v_accvgpr_write_b32 a31, v34
    v_mul_f32 v26, v26, v30
    v_accvgpr_read_b32 v33, a32
    v_accvgpr_read_b32 v34, a33
    v_mul_f32 v33, v33, v30
    v_mul_f32 v34, v34, v30
    v_accvgpr_write_b32 a32, v33
    v_accvgpr_write_b32 a33, v34
    v_accvgpr_read_b32 v33, a34
    v_accvgpr_read_b32 v34, a35
    v_mul_f32 v33, v33, v30
    v_mul_f32 v34, v34, v30
    v_accvgpr_write_b32 a34, v33
    v_accvgpr_write_b32 a35, v34
    v_accvgpr_read_b32 v33, a36
    v_accvgpr_read_b32 v34, a37
    v_mul_f32 v33, v33, v30
    v_mul_f32 v34, v34, v30
    v_accvgpr_write_b32 a36, v33
    v_accvgpr_write_b32 a37, v34
    v_accvgpr_read_b32 v33, a38
    v_accvgpr_read_b32 v34, a39
    v_mul_f32 v33, v33, v30
    v_mul_f32 v34, v34, v30
    v_accvgpr_write_b32 a38, v33
    v_accvgpr_write_b32 a39, v34
    v_accvgpr_read_b32 v33, a40
    v_accvgpr_read_b32 v34, a41
    v_mul_f32 v33, v33, v30
    v_mul_f32 v34, v34, v30
    v_accvgpr_write_b32 a40, v33
    v_accvgpr_write_b32 a41, v34
    v_accvgpr_read_b32 v33, a42
    v_accvgpr_read_b32 v34, a43
    v_mul_f32 v33, v33, v30
    v_mul_f32 v34, v34, v30
    v_accvgpr_write_b32 a42, v33
    v_accvgpr_write_b32 a43, v34
    v_accvgpr_read_b32 v33, a44
    v_accvgpr_read_b32 v34, a45
    v_mul_f32 v33, v33, v30
    v_mul_f32 v34, v34, v30
    v_accvgpr_write_b32 a44, v33
    v_accvgpr_write_b32 a45, v34
    v_accvgpr_read_b32 v33, a46
    v_accvgpr_read_b32 v34, a47
    v_mul_f32 v33, v33, v30
    v_mul_f32 v34, v34, v30
    v_accvgpr_write_b32 a46, v33
    v_accvgpr_write_b32 a47, v34
    v_accvgpr_read_b32 v33, a48
    v_accvgpr_read_b32 v34, a49
    v_mul_f32 v33, v33, v30
    v_mul_f32 v34, v34, v30
    v_accvgpr_write_b32 a48, v33
    v_accvgpr_write_b32 a49, v34
    v_accvgpr_read_b32 v33, a50
    v_accvgpr_read_b32 v34, a51
    v_mul_f32 v33, v33, v30
    v_mul_f32 v34, v34, v30
    v_accvgpr_write_b32 a50, v33
    v_accvgpr_write_b32 a51, v34
    v_accvgpr_read_b32 v33, a52
    v_accvgpr_read_b32 v34, a53
    v_mul_f32 v33, v33, v30
    v_mul_f32 v34, v34, v30
    v_accvgpr_write_b32 a52, v33
    v_accvgpr_write_b32 a53, v34
    v_accvgpr_read_b32 v33, a54
    v_accvgpr_read_b32 v34, a55
    v_mul_f32 v33, v33, v30
    v_mul_f32 v34, v34, v30
    v_accvgpr_write_b32 a54, v33
    v_accvgpr_write_b32 a55, v34
    v_accvgpr_read_b32 v33, a56
    v_accvgpr_read_b32 v34, a57
    v_mul_f32 v33, v33, v30
    v_mul_f32 v34, v34, v30
    v_accvgpr_write_b32 a56, v33
    v_accvgpr_write_b32 a57, v34
    v_accvgpr_read_b32 v33, a58
    v_accvgpr_read_b32 v34, a59
    v_mul_f32 v33, v33, v30
    v_mul_f32 v34, v34, v30
    v_accvgpr_write_b32 a58, v33
    v_accvgpr_write_b32 a59, v34
    v_accvgpr_read_b32 v33, a60
    v_accvgpr_read_b32 v34, a61
    v_mul_f32 v33, v33, v30
    v_mul_f32 v34, v34, v30
    v_accvgpr_write_b32 a60, v33
    v_accvgpr_write_b32 a61, v34
    v_accvgpr_read_b32 v33, a62
    v_accvgpr_read_b32 v34, a63
    v_mul_f32 v33, v33, v30
    v_mul_f32 v34, v34, v30
    v_accvgpr_write_b32 a62, v33
    v_accvgpr_write_b32 a63, v34
    v_mul_f32 v27, v27, v31
    v_accvgpr_read_b32 v33, a64
    v_accvgpr_read_b32 v34, a65
    v_mul_f32 v33, v33, v31
    v_mul_f32 v34, v34, v31
    v_accvgpr_write_b32 a64, v33
    v_accvgpr_write_b32 a65, v34
    v_accvgpr_read_b32 v33, a66
    v_accvgpr_read_b32 v34, a67
    v_mul_f32 v33, v33, v31
    v_mul_f32 v34, v34, v31
    v_accvgpr_write_b32 a66, v33
    v_accvgpr_write_b32 a67, v34
    v_accvgpr_read_b32 v33, a68
    v_accvgpr_read_b32 v34, a69
    v_mul_f32 v33, v33, v31
    v_mul_f32 v34, v34, v31
    v_accvgpr_write_b32 a68, v33
    v_accvgpr_write_b32 a69, v34
    v_accvgpr_read_b32 v33, a70
    v_accvgpr_read_b32 v34, a71
    v_mul_f32 v33, v33, v31
    v_mul_f32 v34, v34, v31
    v_accvgpr_write_b32 a70, v33
    v_accvgpr_write_b32 a71, v34
    v_accvgpr_read_b32 v33, a72
    v_accvgpr_read_b32 v34, a73
    v_mul_f32 v33, v33, v31
    v_mul_f32 v34, v34, v31
    v_accvgpr_write_b32 a72, v33
    v_accvgpr_write_b32 a73, v34
    v_accvgpr_read_b32 v33, a74
    v_accvgpr_read_b32 v34, a75
    v_mul_f32 v33, v33, v31
    v_mul_f32 v34, v34, v31
    v_accvgpr_write_b32 a74, v33
    v_accvgpr_write_b32 a75, v34
    v_accvgpr_read_b32 v33, a76
    v_accvgpr_read_b32 v34, a77
    v_mul_f32 v33, v33, v31
    v_mul_f32 v34, v34, v31
    v_accvgpr_write_b32 a76, v33
    v_accvgpr_write_b32 a77, v34
    v_accvgpr_read_b32 v33, a78
    v_accvgpr_read_b32 v34, a79
    v_mul_f32 v33, v33, v31
    v_mul_f32 v34, v34, v31
    v_accvgpr_write_b32 a78, v33
    v_accvgpr_write_b32 a79, v34
    v_accvgpr_read_b32 v33, a80
    v_accvgpr_read_b32 v34, a81
    v_mul_f32 v33, v33, v31
    v_mul_f32 v34, v34, v31
    v_accvgpr_write_b32 a80, v33
    v_accvgpr_write_b32 a81, v34
    v_accvgpr_read_b32 v33, a82
    v_accvgpr_read_b32 v34, a83
    v_mul_f32 v33, v33, v31
    v_mul_f32 v34, v34, v31
    v_accvgpr_write_b32 a82, v33
    v_accvgpr_write_b32 a83, v34
    v_accvgpr_read_b32 v33, a84
    v_accvgpr_read_b32 v34, a85
    v_mul_f32 v33, v33, v31
    v_mul_f32 v34, v34, v31
    v_accvgpr_write_b32 a84, v33
    v_accvgpr_write_b32 a85, v34
    v_accvgpr_read_b32 v33, a86
    v_accvgpr_read_b32 v34, a87
    v_mul_f32 v33, v33, v31
    v_mul_f32 v34, v34, v31
    v_accvgpr_write_b32 a86, v33
    v_accvgpr_write_b32 a87, v34
    v_accvgpr_read_b32 v33, a88
    v_accvgpr_read_b32 v34, a89
    v_mul_f32 v33, v33, v31
    v_mul_f32 v34, v34, v31
    v_accvgpr_write_b32 a88, v33
    v_accvgpr_write_b32 a89, v34
    v_accvgpr_read_b32 v33, a90
    v_accvgpr_read_b32 v34, a91
    v_mul_f32 v33, v33, v31
    v_mul_f32 v34, v34, v31
    v_accvgpr_write_b32 a90, v33
    v_accvgpr_write_b32 a91, v34
    v_accvgpr_read_b32 v33, a92
    v_accvgpr_read_b32 v34, a93
    v_mul_f32 v33, v33, v31
    v_mul_f32 v34, v34, v31
    v_accvgpr_write_b32 a92, v33
    v_accvgpr_write_b32 a93, v34
    v_accvgpr_read_b32 v33, a94
    v_accvgpr_read_b32 v34, a95
    v_mul_f32 v33, v33, v31
    v_mul_f32 v34, v34, v31
    v_accvgpr_write_b32 a94, v33
    v_accvgpr_write_b32 a95, v34
    v_mul_f32 v28, v28, v32
    v_accvgpr_read_b32 v33, a96
    v_accvgpr_read_b32 v34, a97
    v_mul_f32 v33, v33, v32
    v_mul_f32 v34, v34, v32
    v_accvgpr_write_b32 a96, v33
    v_accvgpr_write_b32 a97, v34
    v_accvgpr_read_b32 v33, a98
    v_accvgpr_read_b32 v34, a99
    v_mul_f32 v33, v33, v32
    v_mul_f32 v34, v34, v32
    v_accvgpr_write_b32 a98, v33
    v_accvgpr_write_b32 a99, v34
    v_accvgpr_read_b32 v33, a100
    v_accvgpr_read_b32 v34, a101
    v_mul_f32 v33, v33, v32
    v_mul_f32 v34, v34, v32
    v_accvgpr_write_b32 a100, v33
    v_accvgpr_write_b32 a101, v34
    v_accvgpr_read_b32 v33, a102
    v_accvgpr_read_b32 v34, a103
    v_mul_f32 v33, v33, v32
    v_mul_f32 v34, v34, v32
    v_accvgpr_write_b32 a102, v33
    v_accvgpr_write_b32 a103, v34
    v_accvgpr_read_b32 v33, a104
    v_accvgpr_read_b32 v34, a105
    v_mul_f32 v33, v33, v32
    v_mul_f32 v34, v34, v32
    v_accvgpr_write_b32 a104, v33
    v_accvgpr_write_b32 a105, v34
    v_accvgpr_read_b32 v33, a106
    v_accvgpr_read_b32 v34, a107
    v_mul_f32 v33, v33, v32
    v_mul_f32 v34, v34, v32
    v_accvgpr_write_b32 a106, v33
    v_accvgpr_write_b32 a107, v34
    v_accvgpr_read_b32 v33, a108
    v_accvgpr_read_b32 v34, a109
    v_mul_f32 v33, v33, v32
    v_mul_f32 v34, v34, v32
    v_accvgpr_write_b32 a108, v33
    v_accvgpr_write_b32 a109, v34
    v_accvgpr_read_b32 v33, a110
    v_accvgpr_read_b32 v34, a111
    v_mul_f32 v33, v33, v32
    v_mul_f32 v34, v34, v32
    v_accvgpr_write_b32 a110, v33
    v_accvgpr_write_b32 a111, v34
    v_accvgpr_read_b32 v33, a112
    v_accvgpr_read_b32 v34, a113
    v_mul_f32 v33, v33, v32
    v_mul_f32 v34, v34, v32
    v_accvgpr_write_b32 a112, v33
    v_accvgpr_write_b32 a113, v34
    v_accvgpr_read_b32 v33, a114
    v_accvgpr_read_b32 v34, a115
    v_mul_f32 v33, v33, v32
    v_mul_f32 v34, v34, v32
    v_accvgpr_write_b32 a114, v33
    v_accvgpr_write_b32 a115, v34
    v_accvgpr_read_b32 v33, a116
    v_accvgpr_read_b32 v34, a117
    v_mul_f32 v33, v33, v32
    v_mul_f32 v34, v34, v32
    v_accvgpr_write_b32 a116, v33
    v_accvgpr_write_b32 a117, v34
    v_accvgpr_read_b32 v33, a118
    v_accvgpr_read_b32 v34, a119
    v_mul_f32 v33, v33, v32
    v_mul_f32 v34, v34, v32
    v_accvgpr_write_b32 a118, v33
    v_accvgpr_write_b32 a119, v34
    v_accvgpr_read_b32 v33, a120
    v_accvgpr_read_b32 v34, a121
    v_mul_f32 v33, v33, v32
    v_mul_f32 v34, v34, v32
    v_accvgpr_write_b32 a120, v33
    v_accvgpr_write_b32 a121, v34
    v_accvgpr_read_b32 v33, a122
    v_accvgpr_read_b32 v34, a123
    v_mul_f32 v33, v33, v32
    v_mul_f32 v34, v34, v32
    v_accvgpr_write_b32 a122, v33
    v_accvgpr_write_b32 a123, v34
    v_accvgpr_read_b32 v33, a124
    v_accvgpr_read_b32 v34, a125
    v_mul_f32 v33, v33, v32
    v_mul_f32 v34, v34, v32
    v_accvgpr_write_b32 a124, v33
    v_accvgpr_write_b32 a125, v34
    v_accvgpr_read_b32 v33, a126
    v_accvgpr_read_b32 v34, a127
    v_mul_f32 v33, v33, v32
    v_mul_f32 v34, v34, v32
    v_accvgpr_write_b32 a126, v33
    v_accvgpr_write_b32 a127, v34
    s_nop 3
    s_branch L_exret0A
L_fix1A:
    s_cmp_lg_u32 s84, 0
    s_cbranch_scc1 L_fixret1A
    s_mov_b32 s84, 1
    s_waitcnt lgkmcnt(0)
    ds_read_b128 v[36:39], v4 offset:9216
    ds_read_b128 v[40:43], v5 offset:9216
    ds_read_b128 v[44:47], v4 offset:9344
    ds_read_b128 v[48:51], v5 offset:9344
    s_waitcnt lgkmcnt(0)
    s_branch L_redo1A
L_exact1A:
    s_nop 15
    v_max3_f32 v34, v52, v53, v54
    v_max3_f32 v34, v34, v55, v56
    v_max3_f32 v34, v34, v57, v58
    v_max_f32 v34, v34, v59
    v_mov_b32 v33, v34
    s_nop 1
    v_permlane32_swap_b32 v33, v34
    v_max_f32 v34, v34, v33
    v_mov_b32 v33, v34
    s_nop 1
    v_permlane16_swap_b32 v33, v34
    v_max_f32 v34, v34, v33
    v_sub_f32 v34, 0, v34
    v_min_f32 v34, s90, v34
    v_add_f32 v12, v12, v34
    v_add_f32 v13, v13, v34
    v_add_f32 v14, v14, v34
    v_add_f32 v15, v15, v34
    v_add_f32 v52, v52, v34
    v_add_f32 v53, v53, v34
    v_add_f32 v54, v54, v34
    v_add_f32 v55, v55, v34
    v_add_f32 v56, v56, v34
    v_add_f32 v57, v57, v34
    v_add_f32 v58, v58, v34
    v_add_f32 v59, v59, v34
    v_exp_f32 v29, v34
    v_max3_f32 v34, v60, v61, v62
    v_max3_f32 v34, v34, v63, v64
    v_max3_f32 v34, v34, v65, v66
    v_max_f32 v34, v34, v67
    v_mov_b32 v33, v34
    s_nop 1
    v_permlane32_swap_b32 v33, v34
    v_max_f32 v34, v34, v33
    v_mov_b32 v33, v34
    s_nop 1
    v_permlane16_swap_b32 v33, v34
    v_max_f32 v34, v34, v33
    v_sub_f32 v34, 0, v34
    v_min_f32 v34, s90, v34
    v_add_f32 v16, v16, v34
    v_add_f32 v17, v17, v34
    v_add_f32 v18, v18, v34
    v_add_f32 v19, v19, v34
    v_add_f32 v60, v60, v34
    v_add_f32 v61, v61, v34
    v_add_f32 v62, v62, v34
    v_add_f32 v63, v63, v34
    v_add_f32 v64, v64, v34
    v_add_f32 v65, v65, v34
    v_add_f32 v66, v66, v34
    v_add_f32 v67, v67, v34
    v_exp_f32 v30, v34
    v_max3_f32 v34, v68, v69, v70
    v_max3_f32 v34, v34, v71, v72
    v_max3_f32 v34, v34, v73, v74
    v_max_f32 v34, v34, v75
    v_mov_b32 v33, v34
    s_nop 1
    v_permlane32_swap_b32 v33, v34
    v_max_f32 v34, v34, v33
    v_mov_b32 v33, v34
    s_nop 1
    v_permlane16_swap_b32 v33, v34
    v_max_f32 v34, v34, v33
    v_sub_f32 v34, 0, v34
    v_min_f32 v34, s90, v34
    v_add_f32 v20, v20, v34
    v_add_f32 v21, v21, v34
    v_add_f32 v22, v22, v34
    v_add_f32 v23, v23, v34
    v_add_f32 v68, v68, v34
    v_add_f32 v69, v69, v34
    v_add_f32 v70, v70, v34
    v_add_f32 v71, v71, v34
    v_add_f32 v72, v72, v34
    v_add_f32 v73, v73, v34
    v_add_f32 v74, v74, v34
    v_add_f32 v75, v75, v34
    v_exp_f32 v31, v34
    s_mov_b32 s90, 0
    s_cmp_lg_u32 s85, 0
    s_mov_b32 s85, 0
    s_cbranch_scc1 L_exret1A
    v_mul_f32 v25, v25, v29
    v_accvgpr_read_b32 v33, a0
    v_accvgpr_read_b32 v34, a1
    v_mul_f32 v33, v33, v29
    v_mul_f32 v34, v34, v29
    v_accvgpr_write_b32 a0, v33
    v_accvgpr_write_b32 a1, v34
    v_accvgpr_read_b32 v33, a2
    v_accvgpr_read_b32 v34, a3
    v_mul_f32 v33, v33, v29
    v_mul_f32 v34, v34, v29
    v_accvgpr_write_b32 a2, v33
    v_accvgpr_write_b32 a3, v34
    v_accvgpr_read_b32 v33, a4
    v_accvgpr_read_b32 v34, a5
    v_mul_f32 v33, v33, v29
    v_mul_f32 v34, v34, v29
    v_accvgpr_write_b32 a4, v33
    v_accvgpr_write_b32 a5, v34
    v_accvgpr_read_b32 v33, a6
    v_accvgpr_read_b32 v34, a7
    v_mul_f32 v33, v33, v29
    v_mul_f32 v34, v34, v29
    v_accvgpr_write_b32 a6, v33
    v_accvgpr_write_b32 a7, v34
    v_accvgpr_read_b32 v33, a8
    v_accvgpr_read_b32 v34, a9
    v_mul_f32 v33, v33, v29
    v_mul_f32 v34, v34, v29
    v_accvgpr_write_b32 a8, v33
    v_accvgpr_write_b32 a9, v34
    v_accvgpr_read_b32 v33, a10
    v_accvgpr_read_b32 v34, a11
    v_mul_f32 v33, v33, v29
    v_mul_f32 v34, v34, v29
    v_accvgpr_write_b32 a10, v33
    v_accvgpr_write_b32 a11, v34
    v_accvgpr_read_b32 v33, a12
    v_accvgpr_read_b32 v34, a13
    v_mul_f32 v33, v33, v29
    v_mul_f32 v34, v34, v29
    v_accvgpr_write_b32 a12, v33
    v_accvgpr_write_b32 a13, v34
    v_accvgpr_read_b32 v33, a14
    v_accvgpr_read_b32 v34, a15
    v_mul_f32 v33, v33, v29
    v_mul_f32 v34, v34, v29
    v_accvgpr_write_b32 a14, v33
    v_accvgpr_write_b32 a15, v34
    v_accvgpr_read_b32 v33, a16
    v_accvgpr_read_b32 v34, a17
    v_mul_f32 v33, v33, v29
    v_mul_f32 v34, v34, v29
    v_accvgpr_write_b32 a16, v33
    v_accvgpr_write_b32 a17, v34
    v_accvgpr_read_b32 v33, a18
    v_accvgpr_read_b32 v34, a19
    v_mul_f32 v33, v33, v29
    v_mul_f32 v34, v34, v29
    v_accvgpr_write_b32 a18, v33
    v_accvgpr_write_b32 a19, v34
    v_accvgpr_read_b32 v33, a20
    v_accvgpr_read_b32 v34, a21
    v_mul_f32 v33, v33, v29
    v_mul_f32 v34, v34, v29
    v_accvgpr_write_b32 a20, v33
    v_accvgpr_write_b32 a21, v34
    v_accvgpr_read_b32 v33, a22
    v_accvgpr_read_b32 v34, a23
    v_mul_f32 v33, v33, v29
    v_mul_f32 v34, v34, v29
    v_accvgpr_write_b32 a22, v33
    v_accvgpr_write_b32 a23, v34
    v_accvgpr_read_b32 v33, a24
    v_accvgpr_read_b32 v34, a25
    v_mul_f32 v33, v33, v29
    v_mul_f32 v34, v34, v29
    v_accvgpr_write_b32 a24, v33
    v_accvgpr_write_b32 a25, v34
    v_accvgpr_read_b32 v33, a26
    v_accvgpr_read_b32 v34, a27
    v_mul_f32 v33, v33, v29
    v_mul_f32 v34, v34, v29
    v_accvgpr_write_b32 a26, v33
    v_accvgpr_write_b32 a27, v34
    v_accvgpr_read_b32 v33, a28
    v_accvgpr_read_b32 v34, a29
    v_mul_f32 v33, v33, v29
    v_mul_f32 v34, v34, v29
    v_accvgpr_write_b32 a28, v33
    v_accvgpr_write_b32 a29, v34
    v_accvgpr_read_b32 v33, a30
    v_accvgpr_read_b32 v34, a31
    v_mul_f32 v33, v33, v29
    v_mul_f32 v34, v34, v29
    v_accvgpr_write_b32 a30, v33
    v_accvgpr_write_b32 a31, v34
    v_mul_f32 v26, v26, v30
    v_accvgpr_read_b32 v33, a32
    v_accvgpr_read_b32 v34, a33
    v_mul_f32 v33, v33, v30
    v_mul_f32 v34, v34, v30
    v_accvgpr_write_b32 a32, v33
    v_accvgpr_write_b32 a33, v34
    v_accvgpr_read_b32 v33, a34
    v_accvgpr_read_b32 v34, a35
    v_mul_f32 v33, v33, v30
    v_mul_f32 v34, v34, v30
    v_accvgpr_write_b32 a34, v33
    v_accvgpr_write_b32 a35, v34
    v_accvgpr_read_b32 v33, a36
    v_accvgpr_read_b32 v34, a37
    v_mul_f32 v33, v33, v30
    v_mul_f32 v34, v34, v30
    v_accvgpr_write_b32 a36, v33
    v_accvgpr_write_b32 a37, v34
    v_accvgpr_read_b32 v33, a38
    v_accvgpr_read_b32 v34, a39
    v_mul_f32 v33, v33, v30
    v_mul_f32 v34, v34, v30
    v_accvgpr_write_b32 a38, v33
    v_accvgpr_write_b32 a39, v34
    v_accvgpr_read_b32 v33, a40
    v_accvgpr_read_b32 v34, a41
    v_mul_f32 v33, v33, v30
    v_mul_f32 v34, v34, v30
    v_accvgpr_write_b32 a40, v33
    v_accvgpr_write_b32 a41, v34
    v_accvgpr_read_b32 v33, a42
    v_accvgpr_read_b32 v34, a43
    v_mul_f32 v33, v33, v30
    v_mul_f32 v34, v34, v30
    v_accvgpr_write_b32 a42, v33
    v_accvgpr_write_b32 a43, v34
    v_accvgpr_read_b32 v33, a44
    v_accvgpr_read_b32 v34, a45
    v_mul_f32 v33, v33, v30
    v_mul_f32 v34, v34, v30
    v_accvgpr_write_b32 a44, v33
    v_accvgpr_write_b32 a45, v34
    v_accvgpr_read_b32 v33, a46
    v_accvgpr_read_b32 v34, a47
    v_mul_f32 v33, v33, v30
    v_mul_f32 v34, v34, v30
    v_accvgpr_write_b32 a46, v33
    v_accvgpr_write_b32 a47, v34
    v_accvgpr_read_b32 v33, a48
    v_accvgpr_read_b32 v34, a49
    v_mul_f32 v33, v33, v30
    v_mul_f32 v34, v34, v30
    v_accvgpr_write_b32 a48, v33
    v_accvgpr_write_b32 a49, v34
    v_accvgpr_read_b32 v33, a50
    v_accvgpr_read_b32 v34, a51
    v_mul_f32 v33, v33, v30
    v_mul_f32 v34, v34, v30
    v_accvgpr_write_b32 a50, v33
    v_accvgpr_write_b32 a51, v34
    v_accvgpr_read_b32 v33, a52
    v_accvgpr_read_b32 v34, a53
    v_mul_f32 v33, v33, v30
    v_mul_f32 v34, v34, v30
    v_accvgpr_write_b32 a52, v33
    v_accvgpr_write_b32 a53, v34
    v_accvgpr_read_b32 v33, a54
    v_accvgpr_read_b32 v34, a55
    v_mul_f32 v33, v33, v30
    v_mul_f32 v34, v34, v30
    v_accvgpr_write_b32 a54, v33
    v_accvgpr_write_b32 a55, v34
    v_accvgpr_read_b32 v33, a56
    v_accvgpr_read_b32 v34, a57
    v_mul_f32 v33, v33, v30
    v_mul_f32 v34, v34, v30
    v_accvgpr_write_b32 a56, v33
    v_accvgpr_write_b32 a57, v34
    v_accvgpr_read_b32 v33, a58
    v_accvgpr_read_b32 v34, a59
    v_mul_f32 v33, v33, v30
    v_mul_f32 v34, v34, v30
    v_accvgpr_write_b32 a58, v33
    v_accvgpr_write_b32 a59, v34
    v_accvgpr_read_b32 v33, a60
    v_accvgpr_read_b32 v34, a61
    v_mul_f32 v33, v33, v30
    v_mul_f32 v34, v34, v30
    v_accvgpr_write_b32 a60, v33
    v_accvgpr_write_b32 a61, v34
    v_accvgpr_read_b32 v33, a62
    v_accvgpr_read_b32 v34, a63
    v_mul_f32 v33, v33, v30
    v_mul_f32 v34, v34, v30
    v_accvgpr_write_b32 a62, v33
    v_accvgpr_write_b32 a63, v34
    v_mul_f32 v27, v27, v31
    v_accvgpr_read_b32 v33, a64
    v_accvgpr_read_b32 v34, a65
    v_mul_f32 v33, v33, v31
    v_mul_f32 v34, v34, v31
    v_accvgpr_write_b32 a64, v33
    v_accvgpr_write_b32 a65, v34
    v_accvgpr_read_b32 v33, a66
    v_accvgpr_read_b32 v34, a67
    v_mul_f32 v33, v33, v31
    v_mul_f32 v34, v34, v31
    v_accvgpr_write_b32 a66, v33
    v_accvgpr_write_b32 a67, v34
    v_accvgpr_read_b32 v33, a68
    v_accvgpr_read_b32 v34, a69
    v_mul_f32 v33, v33, v31
    v_mul_f32 v34, v34, v31
    v_accvgpr_write_b32 a68, v33
    v_accvgpr_write_b32 a69, v34
    v_accvgpr_read_b32 v33, a70
    v_accvgpr_read_b32 v34, a71
    v_mul_f32 v33, v33, v31
    v_mul_f32 v34, v34, v31
    v_accvgpr_write_b32 a70, v33
    v_accvgpr_write_b32 a71, v34
    v_accvgpr_read_b32 v33, a72
    v_accvgpr_read_b32 v34, a73
    v_mul_f32 v33, v33, v31
    v_mul_f32 v34, v34, v31
    v_accvgpr_write_b32 a72, v33
    v_accvgpr_write_b32 a73, v34
    v_accvgpr_read_b32 v33, a74
    v_accvgpr_read_b32 v34, a75
    v_mul_f32 v33, v33, v31
    v_mul_f32 v34, v34, v31
    v_accvgpr_write_b32 a74, v33
    v_accvgpr_write_b32 a75, v34
    v_accvgpr_read_b32 v33, a76
    v_accvgpr_read_b32 v34, a77
    v_mul_f32 v33, v33, v31
    v_mul_f32 v34, v34, v31
    v_accvgpr_write_b32 a76, v33
    v_accvgpr_write_b32 a77, v34
    v_accvgpr_read_b32 v33, a78
    v_accvgpr_read_b32 v34, a79
    v_mul_f32 v33, v33, v31
    v_mul_f32 v34, v34, v31
    v_accvgpr_write_b32 a78, v33
    v_accvgpr_write_b32 a79, v34
    v_accvgpr_read_b32 v33, a80
    v_accvgpr_read_b32 v34, a81
    v_mul_f32 v33, v33, v31
    v_mul_f32 v34, v34, v31
    v_accvgpr_write_b32 a80, v33
    v_accvgpr_write_b32 a81, v34
    v_accvgpr_read_b32 v33, a82
    v_accvgpr_read_b32 v34, a83
    v_mul_f32 v33, v33, v31
    v_mul_f32 v34, v34, v31
    v_accvgpr_write_b32 a82, v33
    v_accvgpr_write_b32 a83, v34
    v_accvgpr_read_b32 v33, a84
    v_accvgpr_read_b32 v34, a85
    v_mul_f32 v33, v33, v31
    v_mul_f32 v34, v34, v31
    v_accvgpr_write_b32 a84, v33
    v_accvgpr_write_b32 a85, v34
    v_accvgpr_read_b32 v33, a86
    v_accvgpr_read_b32 v34, a87
    v_mul_f32 v33, v33, v31
    v_mul_f32 v34, v34, v31
    v_accvgpr_write_b32 a86, v33
    v_accvgpr_write_b32 a87, v34
    v_accvgpr_read_b32 v33, a88
    v_accvgpr_read_b32 v34, a89
    v_mul_f32 v33, v33, v31
    v_mul_f32 v34, v34, v31
    v_accvgpr_write_b32 a88, v33
    v_accvgpr_write_b32 a89, v34
    v_accvgpr_read_b32 v33, a90
    v_accvgpr_read_b32 v34, a91
    v_mul_f32 v33, v33, v31
    v_mul_f32 v34, v34, v31
    v_accvgpr_write_b32 a90, v33
    v_accvgpr_write_b32 a91, v34
    v_accvgpr_read_b32 v33, a92
    v_accvgpr_read_b32 v34, a93
    v_mul_f32 v33, v33, v31
    v_mul_f32 v34, v34, v31
    v_accvgpr_write_b32 a92, v33
    v_accvgpr_write_b32 a93, v34
    v_accvgpr_read_b32 v33, a94
    v_accvgpr_read_b32 v34, a95
    v_mul_f32 v33, v33, v31
    v_mul_f32 v34, v34, v31
    v_accvgpr_write_b32 a94, v33
    v_accvgpr_write_b32 a95, v34
    s_nop 3
    s_branch L_exret1A
L_fix0B:
    s_cmp_lg_u32 s84, 0
    s_cbranch_scc1 L_fixret0B
    s_mov_b32 s84, 1
    s_waitcnt lgkmcnt(0)
    ds_read_b128 v[36:39], v4 offset:0
    v_add_u32 v10, s78, v4
    ds_read_b128 v[40:43], v10 offset:0
    ds_read_b128 v[44:47], v3 offset:0
    ds_read_b128 v[48:51], v5 offset:0
    s_waitcnt lgkmcnt(0)
    s_branch L_redo0B
L_exact0B:
    s_nop 15
    v_max3_f32 v34, v52, v53, v54
    v_max3_f32 v34, v34, v55, v56
    v_max3_f32 v34, v34, v57, v58
    v_max_f32 v34, v34, v59
    v_mov_b32 v33, v34
    s_nop 1
    v_permlane32_swap_b32 v33, v34
    v_max_f32 v34, v34, v33
    v_mov_b32 v33, v34
    s_nop 1
    v_permlane16_swap_b32 v33, v34
    v_max_f32 v34, v34, v33
    v_sub_f32 v34, 0, v34
    v_min_f32 v34, s90, v34
    v_add_f32 v12, v12, v34
    v_add_f32 v13, v13, v34
    v_add_f32 v14, v14, v34
    v_add_f32 v15, v15, v34
    v_add_f32 v52, v52, v34
    v_add_f32 v53, v53, v34
    v_add_f32 v54, v54, v34
    v_add_f32 v55, v55, v34
    v_add_f32 v56, v56, v34
    v_add_f32 v57, v57, v34
    v_add_f32 v58, v58, v34
    v_add_f32 v59, v59, v34
    v_exp_f32 v29, v34
    v_max3_f32 v34, v60, v61, v62
    v_max3_f32 v34, v34, v63, v64
    v_max3_f32 v34, v34, v65, v66
    v_max_f32 v34, v34, v67
    v_mov_b32 v33, v34
    s_nop 1
    v_permlane32_swap_b32 v33, v34
    v_max_f32 v34, v34, v33
    v_mov_b32 v33, v34
    s_nop 1
    v_permlane16_swap_b32 v33, v34
    v_max_f32 v34, v34, v33
    v_sub_f32 v34, 0, v34
    v_min_f32 v34, s90, v34
    v_add_f32 v16, v16, v34
    v_add_f32 v17, v17, v34
    v_add_f32 v18, v18, v34
    v_add_f32 v19, v19, v34
    v_add_f32 v60, v60, v34
    v_add_f32 v61, v61, v34
    v_add_f32 v62, v62, v34
    v_add_f32 v63, v63, v34
    v_add_f32 v64, v64, v34
    v_add_f32 v65, v65, v34
    v_add_f32 v66, v66, v34
    v_add_f32 v67, v67, v34
    v_exp_f32 v30, v34
    v_max3_f32 v34, v68, v69, v70
    v_max3_f32 v34, v34, v71, v72
    v_max3_f32 v34, v34, v73, v74
    v_max_f32 v34, v34, v75
    v_mov_b32 v33, v34
    s_nop 1
    v_permlane32_swap_b32 v33, v34
    v_max_f32 v34, v34, v33
    v_mov_b32 v33, v34
    s_nop 1
    v_permlane16_swap_b32 v33, v34
    v_max_f32 v34, v34, v33
    v_sub_f32 v34, 0, v34
    v_min_f32 v34, s90, v34
    v_add_f32 v20, v20, v34
    v_add_f32 v21, v21, v34
    v_add_f32 v22, v22, v34
    v_add_f32 v23, v23, v34
    v_add_f32 v68, v68, v34
    v_add_f32 v69, v69, v34
    v_add_f32 v70, v70, v34
    v_add_f32 v71, v71, v34
    v_add_f32 v72, v72, v34
    v_add_f32 v73, v73, v34
    v_add_f32 v74, v74, v34
    v_add_f32 v75, v75, v34
    v_exp_f32 v31, v34
    v_max3_f32 v34, v76, v77, v78
    v_max_f32 v34, v34, v79
    v_mov_b32 v33, v34
    s_nop 1
    v_permlane32_swap_b32 v33, v34
    v_max_f32 v34, v34, v33
    v_mov_b32 v33, v34
    s_nop 1
    v_permlane16_swap_b32 v33, v34
    v_max_f32 v34, v34, v33
    v_add_f32 v34, v34, v24
    v_sub_f32 v34, 0, v34
    v_min_f32 v34, s90, v34
    v_add_f32 v24, v24, v34
    v_exp_f32 v32, v34
    s_mov_b32 s90, 0
    s_cmp_lg_u32 s85, 0
    s_mov_b32 s85, 0
    s_cbranch_scc1 L_exret0B
    v_mul_f32 v25, v25, v29
    v_accvgpr_read_b32 v33, a0
    v_accvgpr_read_b32 v34, a1
    v_mul_f32 v33, v33, v29
    v_mul_f32 v34, v34, v29
    v_accvgpr_write_b32 a0, v33
    v_accvgpr_write_b32 a1, v34
    v_accvgpr_read_b32 v33, a2
    v_accvgpr_read_b32 v34, a3
    v_mul_f32 v33, v33, v29
    v_mul_f32 v34, v34, v29
    v_accvgpr_write_b32 a2, v33
    v_accvgpr_write_b32 a3, v34
    v_accvgpr_read_b32 v33, a4
    v_accvgpr_read_b32 v34, a5
    v_mul_f32 v33, v33, v29
    v_mul_f32 v34, v34, v29
    v_accvgpr_write_b32 a4, v33
    v_accvgpr_write_b32 a5, v34
    v_accvgpr_read_b32 v33, a6
    v_accvgpr_read_b32 v34, a7
    v_mul_f32 v33, v33, v29
    v_mul_f32 v34, v34, v29
    v_accvgpr_write_b32 a6, v33
    v_accvgpr_write_b32 a7, v34
    v_accvgpr_read_b32 v33, a8
    v_accvgpr_read_b32 v34, a9
    v_mul_f32 v33, v33, v29
    v_mul_f32 v34, v34, v29
    v_accvgpr_write_b32 a8, v33
    v_accvgpr_write_b32 a9, v34
    v_accvgpr_read_b32 v33, a10
    v_accvgpr_read_b32 v34, a11
    v_mul_f32 v33, v33, v29
    v_mul_f32 v34, v34, v29
    v_accvgpr_write_b32 a10, v33
    v_accvgpr_write_b32 a11, v34
    v_accvgpr_read_b32 v33, a12
    v_accvgpr_read_b32 v34, a13
    v_mul_f32 v33, v33, v29
    v_mul_f32 v34, v34, v29
    v_accvgpr_write_b32 a12, v33
    v_accvgpr_write_b32 a13, v34
    v_accvgpr_read_b32 v33, a14
    v_accvgpr_read_b32 v34, a15
    v_mul_f32 v33, v33, v29
    v_mul_f32 v34, v34, v29
    v_accvgpr_write_b32 a14, v33
    v_accvgpr_write_b32 a15, v34
    v_accvgpr_read_b32 v33, a16
    v_accvgpr_read_b32 v34, a17
    v_mul_f32 v33, v33, v29
    v_mul_f32 v34, v34, v29
    v_accvgpr_write_b32 a16, v33
    v_accvgpr_write_b32 a17, v34
    v_accvgpr_read_b32 v33, a18
    v_accvgpr_read_b32 v34, a19
    v_mul_f32 v33, v33, v29
    v_mul_f32 v34, v34, v29
    v_accvgpr_write_b32 a18, v33
    v_accvgpr_write_b32 a19, v34
    v_accvgpr_read_b32 v33, a20
    v_accvgpr_read_b32 v34, a21
    v_mul_f32 v33, v33, v29
    v_mul_f32 v34, v34, v29
    v_accvgpr_write_b32 a20, v33
    v_accvgpr_write_b32 a21, v34
    v_accvgpr_read_b32 v33, a22
    v_accvgpr_read_b32 v34, a23
    v_mul_f32 v33, v33, v29
    v_mul_f32 v34, v34, v29
    v_accvgpr_write_b32 a22, v33
    v_accvgpr_write_b32 a23, v34
    v_accvgpr_read_b32 v33, a24
    v_accvgpr_read_b32 v34, a25
    v_mul_f32 v33, v33, v29
    v_mul_f32 v34, v34, v29
    v_accvgpr_write_b32 a24, v33
    v_accvgpr_write_b32 a25, v34
    v_accvgpr_read_b32 v33, a26
    v_accvgpr_read_b32 v34, a27
    v_mul_f32 v33, v33, v29
    v_mul_f32 v34, v34, v29
    v_accvgpr_write_b32 a26, v33
    v_accvgpr_write_b32 a27, v34
    v_accvgpr_read_b32 v33, a28
    v_accvgpr_read_b32 v34, a29
    v_mul_f32 v33, v33, v29
    v_mul_f32 v34, v34, v29
    v_accvgpr_write_b32 a28, v33
    v_accvgpr_write_b32 a29, v34
    v_accvgpr_read_b32 v33, a30
    v_accvgpr_read_b32 v34, a31
    v_mul_f32 v33, v33, v29
    v_mul_f32 v34, v34, v29
    v_accvgpr_write_b32 a30, v33
    v_accvgpr_write_b32 a31, v34
    v_mul_f32 v26, v26, v30
    v_accvgpr_read_b32 v33, a32
    v_accvgpr_read_b32 v34, a33
    v_mul_f32 v33, v33, v30
    v_mul_f32 v34, v34, v30
    v_accvgpr_write_b32 a32, v33
    v_accvgpr_write_b32 a33, v34
    v_accvgpr_read_b32 v33, a34
    v_accvgpr_read_b32 v34, a35
    v_mul_f32 v33, v33, v30
    v_mul_f32 v34, v34, v30
    v_accvgpr_write_b32 a34, v33
    v_accvgpr_write_b32 a35, v34
    v_accvgpr_read_b32 v33, a36
    v_accvgpr_read_b32 v34, a37
    v_mul_f32 v33, v33, v30
    v_mul_f32 v34, v34, v30
    v_accvgpr_write_b32 a36, v33
    v_accvgpr_write_b32 a37, v34
    v_accvgpr_read_b32 v33, a38
    v_accvgpr_read_b32 v34, a39
    v_mul_f32 v33, v33, v30
    v_mul_f32 v34, v34, v30
    v_accvgpr_write_b32 a38, v33
    v_accvgpr_write_b32 a39, v34
    v_accvgpr_read_b32 v33, a40
    v_accvgpr_read_b32 v34, a41
    v_mul_f32 v33, v33, v30
    v_mul_f32 v34, v34, v30
    v_accvgpr_write_b32 a40, v33
    v_accvgpr_write_b32 a41, v34
    v_accvgpr_read_b32 v33, a42
    v_accvgpr_read_b32 v34, a43
    v_mul_f32 v33, v33, v30
    v_mul_f32 v34, v34, v30
    v_accvgpr_write_b32 a42, v33
    v_accvgpr_write_b32 a43, v34
    v_accvgpr_read_b32 v33, a44
    v_accvgpr_read_b32 v34, a45
    v_mul_f32 v33, v33, v30
    v_mul_f32 v34, v34, v30
    v_accvgpr_write_b32 a44, v33
    v_accvgpr_write_b32 a45, v34
    v_accvgpr_read_b32 v33, a46
    v_accvgpr_read_b32 v34, a47
    v_mul_f32 v33, v33, v30
    v_mul_f32 v34, v34, v30
    v_accvgpr_write_b32 a46, v33
    v_accvgpr_write_b32 a47, v34
    v_accvgpr_read_b32 v33, a48
    v_accvgpr_read_b32 v34, a49
    v_mul_f32 v33, v33, v30
    v_mul_f32 v34, v34, v30
    v_accvgpr_write_b32 a48, v33
    v_accvgpr_write_b32 a49, v34
    v_accvgpr_read_b32 v33, a50
    v_accvgpr_read_b32 v34, a51
    v_mul_f32 v33, v33, v30
    v_mul_f32 v34, v34, v30
    v_accvgpr_write_b32 a50, v33
    v_accvgpr_write_b32 a51, v34
    v_accvgpr_read_b32 v33, a52
    v_accvgpr_read_b32 v34, a53
    v_mul_f32 v33, v33, v30
    v_mul_f32 v34, v34, v30
    v_accvgpr_write_b32 a52, v33
    v_accvgpr_write_b32 a53, v34
    v_accvgpr_read_b32 v33, a54
    v_accvgpr_read_b32 v34, a55
    v_mul_f32 v33, v33, v30
    v_mul_f32 v34, v34, v30
    v_accvgpr_write_b32 a54, v33
    v_accvgpr_write_b32 a55, v34
    v_accvgpr_read_b32 v33, a56
    v_accvgpr_read_b32 v34, a57
    v_mul_f32 v33, v33, v30
    v_mul_f32 v34, v34, v30
    v_accvgpr_write_b32 a56, v33
    v_accvgpr_write_b32 a57, v34
    v_accvgpr_read_b32 v33, a58
    v_accvgpr_read_b32 v34, a59
    v_mul_f32 v33, v33, v30
    v_mul_f32 v34, v34, v30
    v_accvgpr_write_b32 a58, v33
    v_accvgpr_write_b32 a59, v34
    v_accvgpr_read_b32 v33, a60
    v_accvgpr_read_b32 v34, a61
    v_mul_f32 v33, v33, v30
    v_mul_f32 v34, v34, v30
    v_accvgpr_write_b32 a60, v33
    v_accvgpr_write_b32 a61, v34
    v_accvgpr_read_b32 v33, a62
    v_accvgpr_read_b32 v34, a63
    v_mul_f32 v33, v33, v30
    v_mul_f32 v34, v34, v30
    v_accvgpr_write_b32 a62, v33
    v_accvgpr_write_b32 a63, v34
    v_mul_f32 v27, v27, v31
    v_accvgpr_read_b32 v33, a64
    v_accvgpr_read_b32 v34, a65
    v_mul_f32 v33, v33, v31
    v_mul_f32 v34, v34, v31
    v_accvgpr_write_b32 a64, v33
    v_accvgpr_write_b32 a65, v34
    v_accvgpr_read_b32 v33, a66
    v_accvgpr_read_b32 v34, a67
    v_mul_f32 v33, v33, v31
    v_mul_f32 v34, v34, v31
    v_accvgpr_write_b32 a66, v33
    v_accvgpr_write_b32 a67, v34
    v_accvgpr_read_b32 v33, a68
    v_accvgpr_read_b32 v34, a69
    v_mul_f32 v33, v33, v31
    v_mul_f32 v34, v34, v31
    v_accvgpr_write_b32 a68, v33
    v_accvgpr_write_b32 a69, v34
    v_accvgpr_read_b32 v33, a70
    v_accvgpr_read_b32 v34, a71
    v_mul_f32 v33, v33, v31
    v_mul_f32 v34, v34, v31
    v_accvgpr_write_b32 a70, v33
    v_accvgpr_write_b32 a71, v34
    v_accvgpr_read_b32 v33, a72
    v_accvgpr_read_b32 v34, a73
    v_mul_f32 v33, v33, v31
    v_mul_f32 v34, v34, v31
    v_accvgpr_write_b32 a72, v33
    v_accvgpr_write_b32 a73, v34
    v_accvgpr_read_b32 v33, a74
    v_accvgpr_read_b32 v34, a75
    v_mul_f32 v33, v33, v31
    v_mul_f32 v34, v34, v31
    v_accvgpr_write_b32 a74, v33
    v_accvgpr_write_b32 a75, v34
    v_accvgpr_read_b32 v33, a76
    v_accvgpr_read_b32 v34, a77
    v_mul_f32 v33, v33, v31
    v_mul_f32 v34, v34, v31
    v_accvgpr_write_b32 a76, v33
    v_accvgpr_write_b32 a77, v34
    v_accvgpr_read_b32 v33, a78
    v_accvgpr_read_b32 v34, a79
    v_mul_f32 v33, v33, v31
    v_mul_f32 v34, v34, v31
    v_accvgpr_write_b32 a78, v33
    v_accvgpr_write_b32 a79, v34
    v_accvgpr_read_b32 v33, a80
    v_accvgpr_read_b32 v34, a81
    v_mul_f32 v33, v33, v31
    v_mul_f32 v34, v34, v31
    v_accvgpr_write_b32 a80, v33
    v_accvgpr_write_b32 a81, v34
    v_accvgpr_read_b32 v33, a82
    v_accvgpr_read_b32 v34, a83
    v_mul_f32 v33, v33, v31
    v_mul_f32 v34, v34, v31
    v_accvgpr_write_b32 a82, v33
    v_accvgpr_write_b32 a83, v34
    v_accvgpr_read_b32 v33, a84
    v_accvgpr_read_b32 v34, a85
    v_mul_f32 v33, v33, v31
    v_mul_f32 v34, v34, v31
    v_accvgpr_write_b32 a84, v33
    v_accvgpr_write_b32 a85, v34
    v_accvgpr_read_b32 v33, a86
    v_accvgpr_read_b32 v34, a87
    v_mul_f32 v33, v33, v31
    v_mul_f32 v34, v34, v31
    v_accvgpr_write_b32 a86, v33
    v_accvgpr_write_b32 a87, v34
    v_accvgpr_read_b32 v33, a88
    v_accvgpr_read_b32 v34, a89
    v_mul_f32 v33, v33, v31
    v_mul_f32 v34, v34, v31
    v_accvgpr_write_b32 a88, v33
    v_accvgpr_write_b32 a89, v34
    v_accvgpr_read_b32 v33, a90
    v_accvgpr_read_b32 v34, a91
    v_mul_f32 v33, v33, v31
    v_mul_f32 v34, v34, v31
    v_accvgpr_write_b32 a90, v33
    v_accvgpr_write_b32 a91, v34
    v_accvgpr_read_b32 v33, a92
    v_accvgpr_read_b32 v34, a93
    v_mul_f32 v33, v33, v31
    v_mul_f32 v34, v34, v31
    v_accvgpr_write_b32 a92, v33
    v_accvgpr_write_b32 a93, v34
    v_accvgpr_read_b32 v33, a94
    v_accvgpr_read_b32 v34, a95
    v_mul_f32 v33, v33, v31
    v_mul_f32 v34, v34, v31
    v_accvgpr_write_b32 a94, v33
    v_accvgpr_write_b32 a95, v34
    v_mul_f32 v28, v28, v32
    v_accvgpr_read_b32 v33, a96
    v_accvgpr_read_b32 v34, a97
    v_mul_f32 v33, v33, v32
    v_mul_f32 v34, v34, v32
    v_accvgpr_write_b32 a96, v33
    v_accvgpr_write_b32 a97, v34
    v_accvgpr_read_b32 v33, a98
    v_accvgpr_read_b32 v34, a99
    v_mul_f32 v33, v33, v32
    v_mul_f32 v34, v34, v32
    v_accvgpr_write_b32 a98, v33
    v_accvgpr_write_b32 a99, v34
    v_accvgpr_read_b32 v33, a100
    v_accvgpr_read_b32 v34, a101
    v_mul_f32 v33, v33, v32
    v_mul_f32 v34, v34, v32
    v_accvgpr_write_b32 a100, v33
    v_accvgpr_write_b32 a101, v34
    v_accvgpr_read_b32 v33, a102
    v_accvgpr_read_b32 v34, a103
    v_mul_f32 v33, v33, v32
    v_mul_f32 v34, v34, v32
    v_accvgpr_write_b32 a102, v33
    v_accvgpr_write_b32 a103, v34
    v_accvgpr_read_b32 v33, a104
    v_accvgpr_read_b32 v34, a105
    v_mul_f32 v33, v33, v32
    v_mul_f32 v34, v34, v32
    v_accvgpr_write_b32 a104, v33
    v_accvgpr_write_b32 a105, v34
    v_accvgpr_read_b32 v33, a106
    v_accvgpr_read_b32 v34, a107
    v_mul_f32 v33, v33, v32
    v_mul_f32 v34, v34, v32
    v_accvgpr_write_b32 a106, v33
    v_accvgpr_write_b32 a107, v34
    v_accvgpr_read_b32 v33, a108
    v_accvgpr_read_b32 v34, a109
    v_mul_f32 v33, v33, v32
    v_mul_f32 v34, v34, v32
    v_accvgpr_write_b32 a108, v33
    v_accvgpr_write_b32 a109, v34
    v_accvgpr_read_b32 v33, a110
    v_accvgpr_read_b32 v34, a111
    v_mul_f32 v33, v33, v32
    v_mul_f32 v34, v34, v32
    v_accvgpr_write_b32 a110, v33
    v_accvgpr_write_b32 a111, v34
    v_accvgpr_read_b32 v33, a112
    v_accvgpr_read_b32 v34, a113
    v_mul_f32 v33, v33, v32
    v_mul_f32 v34, v34, v32
    v_accvgpr_write_b32 a112, v33
    v_accvgpr_write_b32 a113, v34
    v_accvgpr_read_b32 v33, a114
    v_accvgpr_read_b32 v34, a115
    v_mul_f32 v33, v33, v32
    v_mul_f32 v34, v34, v32
    v_accvgpr_write_b32 a114, v33
    v_accvgpr_write_b32 a115, v34
    v_accvgpr_read_b32 v33, a116
    v_accvgpr_read_b32 v34, a117
    v_mul_f32 v33, v33, v32
    v_mul_f32 v34, v34, v32
    v_accvgpr_write_b32 a116, v33
    v_accvgpr_write_b32 a117, v34
    v_accvgpr_read_b32 v33, a118
    v_accvgpr_read_b32 v34, a119
    v_mul_f32 v33, v33, v32
    v_mul_f32 v34, v34, v32
    v_accvgpr_write_b32 a118, v33
    v_accvgpr_write_b32 a119, v34
    v_accvgpr_read_b32 v33, a120
    v_accvgpr_read_b32 v34, a121
    v_mul_f32 v33, v33, v32
    v_mul_f32 v34, v34, v32
    v_accvgpr_write_b32 a120, v33
    v_accvgpr_write_b32 a121, v34
    v_accvgpr_read_b32 v33, a122
    v_accvgpr_read_b32 v34, a123
    v_mul_f32 v33, v33, v32
    v_mul_f32 v34, v34, v32
    v_accvgpr_write_b32 a122, v33
    v_accvgpr_write_b32 a123, v34
    v_accvgpr_read_b32 v33, a124
    v_accvgpr_read_b32 v34, a125
    v_mul_f32 v33, v33, v32
    v_mul_f32 v34, v34, v32
    v_accvgpr_write_b32 a124, v33
    v_accvgpr_write_b32 a125, v34
    v_accvgpr_read_b32 v33, a126
    v_accvgpr_read_b32 v34, a127
    v_mul_f32 v33, v33, v32
    v_mul_f32 v34, v34, v32
    v_accvgpr_write_b32 a126, v33
    v_accvgpr_write_b32 a127, v34
    s_nop 3
    s_branch L_exret0B
L_fix1B:
    s_cmp_lg_u32 s84, 0
    s_cbranch_scc1 L_fixret1B
    s_mov_b32 s84, 1
    s_waitcnt lgkmcnt(0)
    ds_read_b128 v[36:39], v4 offset:9216
    ds_read_b128 v[40:43], v5 offset:9216
    ds_read_b128 v[44:47], v4 offset:9344
    ds_read_b128 v[48:51], v5 offset:9344
    s_waitcnt lgkmcnt(0)
    s_branch L_redo1B
L_exact1B:
    s_nop 15
    v_max3_f32 v34, v52, v53, v54
    v_max3_f32 v34, v34, v55, v56
    v_max3_f32 v34, v34, v57, v58
    v_max_f32 v34, v34, v59
    v_mov_b32 v33, v34
    s_nop 1
    v_permlane32_swap_b32 v33, v34
    v_max_f32 v34, v34, v33
    v_mov_b32 v33, v34
    s_nop 1
    v_permlane16_swap_b32 v33, v34
    v_max_f32 v34, v34, v33
    v_sub_f32 v34, 0, v34
    v_min_f32 v34, s90, v34
    v_add_f32 v12, v12, v34
    v_add_f32 v13, v13, v34
    v_add_f32 v14, v14, v34
    v_add_f32 v15, v15, v34
    v_add_f32 v52, v52, v34
    v_add_f32 v53, v53, v34
    v_add_f32 v54, v54, v34
    v_add_f32 v55, v55, v34
    v_add_f32 v56, v56, v34
    v_add_f32 v57, v57, v34
    v_add_f32 v58, v58, v34
    v_add_f32 v59, v59, v34
    v_exp_f32 v29, v34
    v_max3_f32 v34, v60, v61, v62
    v_max3_f32 v34, v34, v63, v64
    v_max3_f32 v34, v34, v65, v66
    v_max_f32 v34, v34, v67
    v_mov_b32 v33, v34
    s_nop 1
    v_permlane32_swap_b32 v33, v34
    v_max_f32 v34, v34, v33
    v_mov_b32 v33, v34
    s_nop 1
    v_permlane16_swap_b32 v33, v34
    v_max_f32 v34, v34, v33
    v_sub_f32 v34, 0, v34
    v_min_f32 v34, s90, v34
    v_add_f32 v16, v16, v34
    v_add_f32 v17, v17, v34
    v_add_f32 v18, v18, v34
    v_add_f32 v19, v19, v34
    v_add_f32 v60, v60, v34
    v_add_f32 v61, v61, v34
    v_add_f32 v62, v62, v34
    v_add_f32 v63, v63, v34
    v_add_f32 v64, v64, v34
    v_add_f32 v65, v65, v34
    v_add_f32 v66, v66, v34
    v_add_f32 v67, v67, v34
    v_exp_f32 v30, v34
    v_max3_f32 v34, v68, v69, v70
    v_max3_f32 v34, v34, v71, v72
    v_max3_f32 v34, v34, v73, v74
    v_max_f32 v34, v34, v75
    v_mov_b32 v33, v34
    s_nop 1
    v_permlane32_swap_b32 v33, v34
    v_max_f32 v34, v34, v33
    v_mov_b32 v33, v34
    s_nop 1
    v_permlane16_swap_b32 v33, v34
    v_max_f32 v34, v34, v33
    v_sub_f32 v34, 0, v34
    v_min_f32 v34, s90, v34
    v_add_f32 v20, v20, v34
    v_add_f32 v21, v21, v34
    v_add_f32 v22, v22, v34
    v_add_f32 v23, v23, v34
    v_add_f32 v68, v68, v34
    v_add_f32 v69, v69, v34
    v_add_f32 v70, v70, v34
    v_add_f32 v71, v71, v34
    v_add_f32 v72, v72, v34
    v_add_f32 v73, v73, v34
    v_add_f32 v74, v74, v34
    v_add_f32 v75, v75, v34
    v_exp_f32 v31, v34
    s_mov_b32 s90, 0
    s_cmp_lg_u32 s85, 0
    s_mov_b32 s85, 0
    s_cbranch_scc1 L_exret1B
    v_mul_f32 v25, v25, v29
    v_accvgpr_read_b32 v33, a0
    v_accvgpr_read_b32 v34, a1
    v_mul_f32 v33, v33, v29
    v_mul_f32 v34, v34, v29
    v_accvgpr_write_b32 a0, v33
    v_accvgpr_write_b32 a1, v34
    v_accvgpr_read_b32 v33, a2
    v_accvgpr_read_b32 v34, a3
    v_mul_f32 v33, v33, v29
    v_mul_f32 v34, v34, v29
    v_accvgpr_write_b32 a2, v33
    v_accvgpr_write_b32 a3, v34
    v_accvgpr_read_b32 v33, a4
    v_accvgpr_read_b32 v34, a5
    v_mul_f32 v33, v33, v29
    v_mul_f32 v34, v34, v29
    v_accvgpr_write_b32 a4, v33
    v_accvgpr_write_b32 a5, v34
    v_accvgpr_read_b32 v33, a6
    v_accvgpr_read_b32 v34, a7
    v_mul_f32 v33, v33, v29
    v_mul_f32 v34, v34, v29
    v_accvgpr_write_b32 a6, v33
    v_accvgpr_write_b32 a7, v34
    v_accvgpr_read_b32 v33, a8
    v_accvgpr_read_b32 v34, a9
    v_mul_f32 v33, v33, v29
    v_mul_f32 v34, v34, v29
    v_accvgpr_write_b32 a8, v33
    v_accvgpr_write_b32 a9, v34
    v_accvgpr_read_b32 v33, a10
    v_accvgpr_read_b32 v34, a11
    v_mul_f32 v33, v33, v29
    v_mul_f32 v34, v34, v29
    v_accvgpr_write_b32 a10, v33
    v_accvgpr_write_b32 a11, v34
    v_accvgpr_read_b32 v33, a12
    v_accvgpr_read_b32 v34, a13
    v_mul_f32 v33, v33, v29
    v_mul_f32 v34, v34, v29
    v_accvgpr_write_b32 a12, v33
    v_accvgpr_write_b32 a13, v34
    v_accvgpr_read_b32 v33, a14
    v_accvgpr_read_b32 v34, a15
    v_mul_f32 v33, v33, v29
    v_mul_f32 v34, v34, v29
    v_accvgpr_write_b32 a14, v33
    v_accvgpr_write_b32 a15, v34
    v_accvgpr_read_b32 v33, a16
    v_accvgpr_read_b32 v34, a17
    v_mul_f32 v33, v33, v29
    v_mul_f32 v34, v34, v29
    v_accvgpr_write_b32 a16, v33
    v_accvgpr_write_b32 a17, v34
    v_accvgpr_read_b32 v33, a18
    v_accvgpr_read_b32 v34, a19
    v_mul_f32 v33, v33, v29
    v_mul_f32 v34, v34, v29
    v_accvgpr_write_b32 a18, v33
    v_accvgpr_write_b32 a19, v34
    v_accvgpr_read_b32 v33, a20
    v_accvgpr_read_b32 v34, a21
    v_mul_f32 v33, v33, v29
    v_mul_f32 v34, v34, v29
    v_accvgpr_write_b32 a20, v33
    v_accvgpr_write_b32 a21, v34
    v_accvgpr_read_b32 v33, a22
    v_accvgpr_read_b32 v34, a23
    v_mul_f32 v33, v33, v29
    v_mul_f32 v34, v34, v29
    v_accvgpr_write_b32 a22, v33
    v_accvgpr_write_b32 a23, v34
    v_accvgpr_read_b32 v33, a24
    v_accvgpr_read_b32 v34, a25
    v_mul_f32 v33, v33, v29
    v_mul_f32 v34, v34, v29
    v_accvgpr_write_b32 a24, v33
    v_accvgpr_write_b32 a25, v34
    v_accvgpr_read_b32 v33, a26
    v_accvgpr_read_b32 v34, a27
    v_mul_f32 v33, v33, v29
    v_mul_f32 v34, v34, v29
    v_accvgpr_write_b32 a26, v33
    v_accvgpr_write_b32 a27, v34
    v_accvgpr_read_b32 v33, a28
    v_accvgpr_read_b32 v34, a29
    v_mul_f32 v33, v33, v29
    v_mul_f32 v34, v34, v29
    v_accvgpr_write_b32 a28, v33
    v_accvgpr_write_b32 a29, v34
    v_accvgpr_read_b32 v33, a30
    v_accvgpr_read_b32 v34, a31
    v_mul_f32 v33, v33, v29
    v_mul_f32 v34, v34, v29
    v_accvgpr_write_b32 a30, v33
    v_accvgpr_write_b32 a31, v34
    v_mul_f32 v26, v26, v30
    v_accvgpr_read_b32 v33, a32
    v_accvgpr_read_b32 v34, a33
    v_mul_f32 v33, v33, v30
    v_mul_f32 v34, v34, v30
    v_accvgpr_write_b32 a32, v33
    v_accvgpr_write_b32 a33, v34
    v_accvgpr_read_b32 v33, a34
    v_accvgpr_read_b32 v34, a35
    v_mul_f32 v33, v33, v30
    v_mul_f32 v34, v34, v30
    v_accvgpr_write_b32 a34, v33
    v_accvgpr_write_b32 a35, v34
    v_accvgpr_read_b32 v33, a36
    v_accvgpr_read_b32 v34, a37
    v_mul_f32 v33, v33, v30
    v_mul_f32 v34, v34, v30
    v_accvgpr_write_b32 a36, v33
    v_accvgpr_write_b32 a37, v34
    v_accvgpr_read_b32 v33, a38
    v_accvgpr_read_b32 v34, a39
    v_mul_f32 v33, v33, v30
    v_mul_f32 v34, v34, v30
    v_accvgpr_write_b32 a38, v33
    v_accvgpr_write_b32 a39, v34
    v_accvgpr_read_b32 v33, a40
    v_accvgpr_read_b32 v34, a41
    v_mul_f32 v33, v33, v30
    v_mul_f32 v34, v34, v30
    v_accvgpr_write_b32 a40, v33
    v_accvgpr_write_b32 a41, v34
    v_accvgpr_read_b32 v33, a42
    v_accvgpr_read_b32 v34, a43
    v_mul_f32 v33, v33, v30
    v_mul_f32 v34, v34, v30
    v_accvgpr_write_b32 a42, v33
    v_accvgpr_write_b32 a43, v34
    v_accvgpr_read_b32 v33, a44
    v_accvgpr_read_b32 v34, a45
    v_mul_f32 v33, v33, v30
    v_mul_f32 v34, v34, v30
    v_accvgpr_write_b32 a44, v33
    v_accvgpr_write_b32 a45, v34
    v_accvgpr_read_b32 v33, a46
    v_accvgpr_read_b32 v34, a47
    v_mul_f32 v33, v33, v30
    v_mul_f32 v34, v34, v30
    v_accvgpr_write_b32 a46, v33
    v_accvgpr_write_b32 a47, v34
    v_accvgpr_read_b32 v33, a48
    v_accvgpr_read_b32 v34, a49
    v_mul_f32 v33, v33, v30
    v_mul_f32 v34, v34, v30
    v_accvgpr_write_b32 a48, v33
    v_accvgpr_write_b32 a49, v34
    v_accvgpr_read_b32 v33, a50
    v_accvgpr_read_b32 v34, a51
    v_mul_f32 v33, v33, v30
    v_mul_f32 v34, v34, v30
    v_accvgpr_write_b32 a50, v33
    v_accvgpr_write_b32 a51, v34
    v_accvgpr_read_b32 v33, a52
    v_accvgpr_read_b32 v34, a53
    v_mul_f32 v33, v33, v30
    v_mul_f32 v34, v34, v30
    v_accvgpr_write_b32 a52, v33
    v_accvgpr_write_b32 a53, v34
    v_accvgpr_read_b32 v33, a54
    v_accvgpr_read_b32 v34, a55
    v_mul_f32 v33, v33, v30
    v_mul_f32 v34, v34, v30
    v_accvgpr_write_b32 a54, v33
    v_accvgpr_write_b32 a55, v34
    v_accvgpr_read_b32 v33, a56
    v_accvgpr_read_b32 v34, a57
    v_mul_f32 v33, v33, v30
    v_mul_f32 v34, v34, v30
    v_accvgpr_write_b32 a56, v33
    v_accvgpr_write_b32 a57, v34
    v_accvgpr_read_b32 v33, a58
    v_accvgpr_read_b32 v34, a59
    v_mul_f32 v33, v33, v30
    v_mul_f32 v34, v34, v30
    v_accvgpr_write_b32 a58, v33
    v_accvgpr_write_b32 a59, v34
    v_accvgpr_read_b32 v33, a60
    v_accvgpr_read_b32 v34, a61
    v_mul_f32 v33, v33, v30
    v_mul_f32 v34, v34, v30
    v_accvgpr_write_b32 a60, v33
    v_accvgpr_write_b32 a61, v34
    v_accvgpr_read_b32 v33, a62
    v_accvgpr_read_b32 v34, a63
    v_mul_f32 v33, v33, v30
    v_mul_f32 v34, v34, v30
    v_accvgpr_write_b32 a62, v33
    v_accvgpr_write_b32 a63, v34
    v_mul_f32 v27, v27, v31
    v_accvgpr_read_b32 v33, a64
    v_accvgpr_read_b32 v34, a65
    v_mul_f32 v33, v33, v31
    v_mul_f32 v34, v34, v31
    v_accvgpr_write_b32 a64, v33
    v_accvgpr_write_b32 a65, v34
    v_accvgpr_read_b32 v33, a66
    v_accvgpr_read_b32 v34, a67
    v_mul_f32 v33, v33, v31
    v_mul_f32 v34, v34, v31
    v_accvgpr_write_b32 a66, v33
    v_accvgpr_write_b32 a67, v34
    v_accvgpr_read_b32 v33, a68
    v_accvgpr_read_b32 v34, a69
    v_mul_f32 v33, v33, v31
    v_mul_f32 v34, v34, v31
    v_accvgpr_write_b32 a68, v33
    v_accvgpr_write_b32 a69, v34
    v_accvgpr_read_b32 v33, a70
    v_accvgpr_read_b32 v34, a71
    v_mul_f32 v33, v33, v31
    v_mul_f32 v34, v34, v31
    v_accvgpr_write_b32 a70, v33
    v_accvgpr_write_b32 a71, v34
    v_accvgpr_read_b32 v33, a72
    v_accvgpr_read_b32 v34, a73
    v_mul_f32 v33, v33, v31
    v_mul_f32 v34, v34, v31
    v_accvgpr_write_b32 a72, v33
    v_accvgpr_write_b32 a73, v34
    v_accvgpr_read_b32 v33, a74
    v_accvgpr_read_b32 v34, a75
    v_mul_f32 v33, v33, v31
    v_mul_f32 v34, v34, v31
    v_accvgpr_write_b32 a74, v33
    v_accvgpr_write_b32 a75, v34
    v_accvgpr_read_b32 v33, a76
    v_accvgpr_read_b32 v34, a77
    v_mul_f32 v33, v33, v31
    v_mul_f32 v34, v34, v31
    v_accvgpr_write_b32 a76, v33
    v_accvgpr_write_b32 a77, v34
    v_accvgpr_read_b32 v33, a78
    v_accvgpr_read_b32 v34, a79
    v_mul_f32 v33, v33, v31
    v_mul_f32 v34, v34, v31
    v_accvgpr_write_b32 a78, v33
    v_accvgpr_write_b32 a79, v34
    v_accvgpr_read_b32 v33, a80
    v_accvgpr_read_b32 v34, a81
    v_mul_f32 v33, v33, v31
    v_mul_f32 v34, v34, v31
    v_accvgpr_write_b32 a80, v33
    v_accvgpr_write_b32 a81, v34
    v_accvgpr_read_b32 v33, a82
    v_accvgpr_read_b32 v34, a83
    v_mul_f32 v33, v33, v31
    v_mul_f32 v34, v34, v31
    v_accvgpr_write_b32 a82, v33
    v_accvgpr_write_b32 a83, v34
    v_accvgpr_read_b32 v33, a84
    v_accvgpr_read_b32 v34, a85
    v_mul_f32 v33, v33, v31
    v_mul_f32 v34, v34, v31
    v_accvgpr_write_b32 a84, v33
    v_accvgpr_write_b32 a85, v34
    v_accvgpr_read_b32 v33, a86
    v_accvgpr_read_b32 v34, a87
    v_mul_f32 v33, v33, v31
    v_mul_f32 v34, v34, v31
    v_accvgpr_write_b32 a86, v33
    v_accvgpr_write_b32 a87, v34
    v_accvgpr_read_b32 v33, a88
    v_accvgpr_read_b32 v34, a89
    v_mul_f32 v33, v33, v31
    v_mul_f32 v34, v34, v31
    v_accvgpr_write_b32 a88, v33
    v_accvgpr_write_b32 a89, v34
    v_accvgpr_read_b32 v33, a90
    v_accvgpr_read_b32 v34, a91
    v_mul_f32 v33, v33, v31
    v_mul_f32 v34, v34, v31
    v_accvgpr_write_b32 a90, v33
    v_accvgpr_write_b32 a91, v34
    v_accvgpr_read_b32 v33, a92
    v_accvgpr_read_b32 v34, a93
    v_mul_f32 v33, v33, v31
    v_mul_f32 v34, v34, v31
    v_accvgpr_write_b32 a92, v33
    v_accvgpr_write_b32 a93, v34
    v_accvgpr_read_b32 v33, a94
    v_accvgpr_read_b32 v34, a95
    v_mul_f32 v33, v33, v31
    v_mul_f32 v34, v34, v31
    v_accvgpr_write_b32 a94, v33
    v_accvgpr_write_b32 a95, v34
    s_nop 3
    s_branch L_exret1B
L_fix0C:
    s_cmp_lg_u32 s84, 0
    s_cbranch_scc1 L_fixret0C
    s_mov_b32 s84, 1
    s_waitcnt lgkmcnt(0)
    ds_read_b128 v[36:39], v4 offset:0
    v_add_u32 v10, s78, v4
    ds_read_b128 v[40:43], v10 offset:0
    ds_read_b128 v[44:47], v3 offset:0
    ds_read_b128 v[48:51], v5 offset:0
    s_waitcnt lgkmcnt(0)
    s_branch L_redo0C
L_exact0C:
    s_nop 15
    v_max3_f32 v34, v52, v53, v54
    v_max3_f32 v34, v34, v55, v56
    v_max3_f32 v34, v34, v57, v58
    v_max_f32 v34, v34, v59
    v_mov_b32 v33, v34
    s_nop 1
    v_permlane32_swap_b32 v33, v34
    v_max_f32 v34, v34, v33
    v_mov_b32 v33, v34
    s_nop 1
    v_permlane16_swap_b32 v33, v34
    v_max_f32 v34, v34, v33
    v_sub_f32 v34, 0, v34
    v_min_f32 v34, s90, v34
    v_add_f32 v12, v12, v34
    v_add_f32 v13, v13, v34
    v_add_f32 v14, v14, v34
    v_add_f32 v15, v15, v34
    v_add_f32 v52, v52, v34
    v_add_f32 v53, v53, v34
    v_add_f32 v54, v54, v34
    v_add_f32 v55, v55, v34
    v_add_f32 v56, v56, v34
    v_add_f32 v57, v57, v34
    v_add_f32 v58, v58, v34
    v_add_f32 v59, v59, v34
    v_exp_f32 v29, v34
    v_max3_f32 v34, v60, v61, v62
    v_max3_f32 v34, v34, v63, v64
    v_max3_f32 v34, v34, v65, v66
    v_max_f32 v34, v34, v67
    v_mov_b32 v33, v34
    s_nop 1
    v_permlane32_swap_b32 v33, v34
    v_max_f32 v34, v34, v33
    v_mov_b32 v33, v34
    s_nop 1
    v_permlane16_swap_b32 v33, v34
    v_max_f32 v34, v34, v33
    v_sub_f32 v34, 0, v34
    v_min_f32 v34, s90, v34
    v_add_f32 v16, v16, v34
    v_add_f32 v17, v17, v34
    v_add_f32 v18, v18, v34
    v_add_f32 v19, v19, v34
    v_add_f32 v60, v60, v34
    v_add_f32 v61, v61, v34
    v_add_f32 v62, v62, v34
    v_add_f32 v63, v63, v34
    v_add_f32 v64, v64, v34
    v_add_f32 v65, v65, v34
    v_add_f32 v66, v66, v34
    v_add_f32 v67, v67, v34
    v_exp_f32 v30, v34
    v_max3_f32 v34, v68, v69, v70
    v_max3_f32 v34, v34, v71, v72
    v_max3_f32 v34, v34, v73, v74
    v_max_f32 v34, v34, v75
    v_mov_b32 v33, v34
    s_nop 1
    v_permlane32_swap_b32 v33, v34
    v_max_f32 v34, v34, v33
    v_mov_b32 v33, v34
    s_nop 1
    v_permlane16_swap_b32 v33, v34
    v_max_f32 v34, v34, v33
    v_sub_f32 v34, 0, v34
    v_min_f32 v34, s90, v34
    v_add_f32 v20, v20, v34
    v_add_f32 v21, v21, v34
    v_add_f32 v22, v22, v34
    v_add_f32 v23, v23, v34
    v_add_f32 v68, v68, v34
    v_add_f32 v69, v69, v34
    v_add_f32 v70, v70, v34
    v_add_f32 v71, v71, v34
    v_add_f32 v72, v72, v34
    v_add_f32 v73, v73, v34
    v_add_f32 v74, v74, v34
    v_add_f32 v75, v75, v34
    v_exp_f32 v31, v34
    v_max3_f32 v34, v76, v77, v78
    v_max_f32 v34, v34, v79
    v_mov_b32 v33, v34
    s_nop 1
    v_permlane32_swap_b32 v33, v34
    v_max_f32 v34, v34, v33
    v_mov_b32 v33, v34
    s_nop 1
    v_permlane16_swap_b32 v33, v34
    v_max_f32 v34, v34, v33
    v_add_f32 v34, v34, v24
    v_sub_f32 v34, 0, v34
    v_min_f32 v34, s90, v34
    v_add_f32 v24, v24, v34
    v_exp_f32 v32, v34
    s_mov_b32 s90, 0
    s_cmp_lg_u32 s85, 0
    s_mov_b32 s85, 0
    s_cbranch_scc1 L_exret0C
    v_mul_f32 v25, v25, v29
    v_accvgpr_read_b32 v33, a0
    v_accvgpr_read_b32 v34, a1
    v_mul_f32 v33, v33, v29
    v_mul_f32 v34, v34, v29
    v_accvgpr_write_b32 a0, v33
    v_accvgpr_write_b32 a1, v34
    v_accvgpr_read_b32 v33, a2
    v_accvgpr_read_b32 v34, a3
    v_mul_f32 v33, v33, v29
    v_mul_f32 v34, v34, v29
    v_accvgpr_write_b32 a2, v33
    v_accvgpr_write_b32 a3, v34
    v_accvgpr_read_b32 v33, a4
    v_accvgpr_read_b32 v34, a5
    v_mul_f32 v33, v33, v29
    v_mul_f32 v34, v34, v29
    v_accvgpr_write_b32 a4, v33
    v_accvgpr_write_b32 a5, v34
    v_accvgpr_read_b32 v33, a6
    v_accvgpr_read_b32 v34, a7
    v_mul_f32 v33, v33, v29
    v_mul_f32 v34, v34, v29
    v_accvgpr_write_b32 a6, v33
    v_accvgpr_write_b32 a7, v34
    v_accvgpr_read_b32 v33, a8
    v_accvgpr_read_b32 v34, a9
    v_mul_f32 v33, v33, v29
    v_mul_f32 v34, v34, v29
    v_accvgpr_write_b32 a8, v33
    v_accvgpr_write_b32 a9, v34
    v_accvgpr_read_b32 v33, a10
    v_accvgpr_read_b32 v34, a11
    v_mul_f32 v33, v33, v29
    v_mul_f32 v34, v34, v29
    v_accvgpr_write_b32 a10, v33
    v_accvgpr_write_b32 a11, v34
    v_accvgpr_read_b32 v33, a12
    v_accvgpr_read_b32 v34, a13
    v_mul_f32 v33, v33, v29
    v_mul_f32 v34, v34, v29
    v_accvgpr_write_b32 a12, v33
    v_accvgpr_write_b32 a13, v34
    v_accvgpr_read_b32 v33, a14
    v_accvgpr_read_b32 v34, a15
    v_mul_f32 v33, v33, v29
    v_mul_f32 v34, v34, v29
    v_accvgpr_write_b32 a14, v33
    v_accvgpr_write_b32 a15, v34
    v_accvgpr_read_b32 v33, a16
    v_accvgpr_read_b32 v34, a17
    v_mul_f32 v33, v33, v29
    v_mul_f32 v34, v34, v29
    v_accvgpr_write_b32 a16, v33
    v_accvgpr_write_b32 a17, v34
    v_accvgpr_read_b32 v33, a18
    v_accvgpr_read_b32 v34, a19
    v_mul_f32 v33, v33, v29
    v_mul_f32 v34, v34, v29
    v_accvgpr_write_b32 a18, v33
    v_accvgpr_write_b32 a19, v34
    v_accvgpr_read_b32 v33, a20
    v_accvgpr_read_b32 v34, a21
    v_mul_f32 v33, v33, v29
    v_mul_f32 v34, v34, v29
    v_accvgpr_write_b32 a20, v33
    v_accvgpr_write_b32 a21, v34
    v_accvgpr_read_b32 v33, a22
    v_accvgpr_read_b32 v34, a23
    v_mul_f32 v33, v33, v29
    v_mul_f32 v34, v34, v29
    v_accvgpr_write_b32 a22, v33
    v_accvgpr_write_b32 a23, v34
    v_accvgpr_read_b32 v33, a24
    v_accvgpr_read_b32 v34, a25
    v_mul_f32 v33, v33, v29
    v_mul_f32 v34, v34, v29
    v_accvgpr_write_b32 a24, v33
    v_accvgpr_write_b32 a25, v34
    v_accvgpr_read_b32 v33, a26
    v_accvgpr_read_b32 v34, a27
    v_mul_f32 v33, v33, v29
    v_mul_f32 v34, v34, v29
    v_accvgpr_write_b32 a26, v33
    v_accvgpr_write_b32 a27, v34
    v_accvgpr_read_b32 v33, a28
    v_accvgpr_read_b32 v34, a29
    v_mul_f32 v33, v33, v29
    v_mul_f32 v34, v34, v29
    v_accvgpr_write_b32 a28, v33
    v_accvgpr_write_b32 a29, v34
    v_accvgpr_read_b32 v33, a30
    v_accvgpr_read_b32 v34, a31
    v_mul_f32 v33, v33, v29
    v_mul_f32 v34, v34, v29
    v_accvgpr_write_b32 a30, v33
    v_accvgpr_write_b32 a31, v34
    v_mul_f32 v26, v26, v30
    v_accvgpr_read_b32 v33, a32
    v_accvgpr_read_b32 v34, a33
    v_mul_f32 v33, v33, v30
    v_mul_f32 v34, v34, v30
    v_accvgpr_write_b32 a32, v33
    v_accvgpr_write_b32 a33, v34
    v_accvgpr_read_b32 v33, a34
    v_accvgpr_read_b32 v34, a35
    v_mul_f32 v33, v33, v30
    v_mul_f32 v34, v34, v30
    v_accvgpr_write_b32 a34, v33
    v_accvgpr_write_b32 a35, v34
    v_accvgpr_read_b32 v33, a36
    v_accvgpr_read_b32 v34, a37
    v_mul_f32 v33, v33, v30
    v_mul_f32 v34, v34, v30
    v_accvgpr_write_b32 a36, v33
    v_accvgpr_write_b32 a37, v34
    v_accvgpr_read_b32 v33, a38
    v_accvgpr_read_b32 v34, a39
    v_mul_f32 v33, v33, v30
    v_mul_f32 v34, v34, v30
    v_accvgpr_write_b32 a38, v33
    v_accvgpr_write_b32 a39, v34
    v_accvgpr_read_b32 v33, a40
    v_accvgpr_read_b32 v34, a41
    v_mul_f32 v33, v33, v30
    v_mul_f32 v34, v34, v30
    v_accvgpr_write_b32 a40, v33
    v_accvgpr_write_b32 a41, v34
    v_accvgpr_read_b32 v33, a42
    v_accvgpr_read_b32 v34, a43
    v_mul_f32 v33, v33, v30
    v_mul_f32 v34, v34, v30
    v_accvgpr_write_b32 a42, v33
    v_accvgpr_write_b32 a43, v34
    v_accvgpr_read_b32 v33, a44
    v_accvgpr_read_b32 v34, a45
    v_mul_f32 v33, v33, v30
    v_mul_f32 v34, v34, v30
    v_accvgpr_write_b32 a44, v33
    v_accvgpr_write_b32 a45, v34
    v_accvgpr_read_b32 v33, a46
    v_accvgpr_read_b32 v34, a47
    v_mul_f32 v33, v33, v30
    v_mul_f32 v34, v34, v30
    v_accvgpr_write_b32 a46, v33
    v_accvgpr_write_b32 a47, v34
    v_accvgpr_read_b32 v33, a48
    v_accvgpr_read_b32 v34, a49
    v_mul_f32 v33, v33, v30
    v_mul_f32 v34, v34, v30
    v_accvgpr_write_b32 a48, v33
    v_accvgpr_write_b32 a49, v34
    v_accvgpr_read_b32 v33, a50
    v_accvgpr_read_b32 v34, a51
    v_mul_f32 v33, v33, v30
    v_mul_f32 v34, v34, v30
    v_accvgpr_write_b32 a50, v33
    v_accvgpr_write_b32 a51, v34
    v_accvgpr_read_b32 v33, a52
    v_accvgpr_read_b32 v34, a53
    v_mul_f32 v33, v33, v30
    v_mul_f32 v34, v34, v30
    v_accvgpr_write_b32 a52, v33
    v_accvgpr_write_b32 a53, v34
    v_accvgpr_read_b32 v33, a54
    v_accvgpr_read_b32 v34, a55
    v_mul_f32 v33, v33, v30
    v_mul_f32 v34, v34, v30
    v_accvgpr_write_b32 a54, v33
    v_accvgpr_write_b32 a55, v34
    v_accvgpr_read_b32 v33, a56
    v_accvgpr_read_b32 v34, a57
    v_mul_f32 v33, v33, v30
    v_mul_f32 v34, v34, v30
    v_accvgpr_write_b32 a56, v33
    v_accvgpr_write_b32 a57, v34
    v_accvgpr_read_b32 v33, a58
    v_accvgpr_read_b32 v34, a59
    v_mul_f32 v33, v33, v30
    v_mul_f32 v34, v34, v30
    v_accvgpr_write_b32 a58, v33
    v_accvgpr_write_b32 a59, v34
    v_accvgpr_read_b32 v33, a60
    v_accvgpr_read_b32 v34, a61
    v_mul_f32 v33, v33, v30
    v_mul_f32 v34, v34, v30
    v_accvgpr_write_b32 a60, v33
    v_accvgpr_write_b32 a61, v34
    v_accvgpr_read_b32 v33, a62
    v_accvgpr_read_b32 v34, a63
    v_mul_f32 v33, v33, v30
    v_mul_f32 v34, v34, v30
    v_accvgpr_write_b32 a62, v33
    v_accvgpr_write_b32 a63, v34
    v_mul_f32 v27, v27, v31
    v_accvgpr_read_b32 v33, a64
    v_accvgpr_read_b32 v34, a65
    v_mul_f32 v33, v33, v31
    v_mul_f32 v34, v34, v31
    v_accvgpr_write_b32 a64, v33
    v_accvgpr_write_b32 a65, v34
    v_accvgpr_read_b32 v33, a66
    v_accvgpr_read_b32 v34, a67
    v_mul_f32 v33, v33, v31
    v_mul_f32 v34, v34, v31
    v_accvgpr_write_b32 a66, v33
    v_accvgpr_write_b32 a67, v34
    v_accvgpr_read_b32 v33, a68
    v_accvgpr_read_b32 v34, a69
    v_mul_f32 v33, v33, v31
    v_mul_f32 v34, v34, v31
    v_accvgpr_write_b32 a68, v33
    v_accvgpr_write_b32 a69, v34
    v_accvgpr_read_b32 v33, a70
    v_accvgpr_read_b32 v34, a71
    v_mul_f32 v33, v33, v31
    v_mul_f32 v34, v34, v31
    v_accvgpr_write_b32 a70, v33
    v_accvgpr_write_b32 a71, v34
    v_accvgpr_read_b32 v33, a72
    v_accvgpr_read_b32 v34, a73
    v_mul_f32 v33, v33, v31
    v_mul_f32 v34, v34, v31
    v_accvgpr_write_b32 a72, v33
    v_accvgpr_write_b32 a73, v34
    v_accvgpr_read_b32 v33, a74
    v_accvgpr_read_b32 v34, a75
    v_mul_f32 v33, v33, v31
    v_mul_f32 v34, v34, v31
    v_accvgpr_write_b32 a74, v33
    v_accvgpr_write_b32 a75, v34
    v_accvgpr_read_b32 v33, a76
    v_accvgpr_read_b32 v34, a77
    v_mul_f32 v33, v33, v31
    v_mul_f32 v34, v34, v31
    v_accvgpr_write_b32 a76, v33
    v_accvgpr_write_b32 a77, v34
    v_accvgpr_read_b32 v33, a78
    v_accvgpr_read_b32 v34, a79
    v_mul_f32 v33, v33, v31
    v_mul_f32 v34, v34, v31
    v_accvgpr_write_b32 a78, v33
    v_accvgpr_write_b32 a79, v34
    v_accvgpr_read_b32 v33, a80
    v_accvgpr_read_b32 v34, a81
    v_mul_f32 v33, v33, v31
    v_mul_f32 v34, v34, v31
    v_accvgpr_write_b32 a80, v33
    v_accvgpr_write_b32 a81, v34
    v_accvgpr_read_b32 v33, a82
    v_accvgpr_read_b32 v34, a83
    v_mul_f32 v33, v33, v31
    v_mul_f32 v34, v34, v31
    v_accvgpr_write_b32 a82, v33
    v_accvgpr_write_b32 a83, v34
    v_accvgpr_read_b32 v33, a84
    v_accvgpr_read_b32 v34, a85
    v_mul_f32 v33, v33, v31
    v_mul_f32 v34, v34, v31
    v_accvgpr_write_b32 a84, v33
    v_accvgpr_write_b32 a85, v34
    v_accvgpr_read_b32 v33, a86
    v_accvgpr_read_b32 v34, a87
    v_mul_f32 v33, v33, v31
    v_mul_f32 v34, v34, v31
    v_accvgpr_write_b32 a86, v33
    v_accvgpr_write_b32 a87, v34
    v_accvgpr_read_b32 v33, a88
    v_accvgpr_read_b32 v34, a89
    v_mul_f32 v33, v33, v31
    v_mul_f32 v34, v34, v31
    v_accvgpr_write_b32 a88, v33
    v_accvgpr_write_b32 a89, v34
    v_accvgpr_read_b32 v33, a90
    v_accvgpr_read_b32 v34, a91
    v_mul_f32 v33, v33, v31
    v_mul_f32 v34, v34, v31
    v_accvgpr_write_b32 a90, v33
    v_accvgpr_write_b32 a91, v34
    v_accvgpr_read_b32 v33, a92
    v_accvgpr_read_b32 v34, a93
    v_mul_f32 v33, v33, v31
    v_mul_f32 v34, v34, v31
    v_accvgpr_write_b32 a92, v33
    v_accvgpr_write_b32 a93, v34
    v_accvgpr_read_b32 v33, a94
    v_accvgpr_read_b32 v34, a95
    v_mul_f32 v33, v33, v31
    v_mul_f32 v34, v34, v31
    v_accvgpr_write_b32 a94, v33
    v_accvgpr_write_b32 a95, v34
    v_mul_f32 v28, v28, v32
    v_accvgpr_read_b32 v33, a96
    v_accvgpr_read_b32 v34, a97
    v_mul_f32 v33, v33, v32
    v_mul_f32 v34, v34, v32
    v_accvgpr_write_b32 a96, v33
    v_accvgpr_write_b32 a97, v34
    v_accvgpr_read_b32 v33, a98
    v_accvgpr_read_b32 v34, a99
    v_mul_f32 v33, v33, v32
    v_mul_f32 v34, v34, v32
    v_accvgpr_write_b32 a98, v33
    v_accvgpr_write_b32 a99, v34
    v_accvgpr_read_b32 v33, a100
    v_accvgpr_read_b32 v34, a101
    v_mul_f32 v33, v33, v32
    v_mul_f32 v34, v34, v32
    v_accvgpr_write_b32 a100, v33
    v_accvgpr_write_b32 a101, v34
    v_accvgpr_read_b32 v33, a102
    v_accvgpr_read_b32 v34, a103
    v_mul_f32 v33, v33, v32
    v_mul_f32 v34, v34, v32
    v_accvgpr_write_b32 a102, v33
    v_accvgpr_write_b32 a103, v34
    v_accvgpr_read_b32 v33, a104
    v_accvgpr_read_b32 v34, a105
    v_mul_f32 v33, v33, v32
    v_mul_f32 v34, v34, v32
    v_accvgpr_write_b32 a104, v33
    v_accvgpr_write_b32 a105, v34
    v_accvgpr_read_b32 v33, a106
    v_accvgpr_read_b32 v34, a107
    v_mul_f32 v33, v33, v32
    v_mul_f32 v34, v34, v32
    v_accvgpr_write_b32 a106, v33
    v_accvgpr_write_b32 a107, v34
    v_accvgpr_read_b32 v33, a108
    v_accvgpr_read_b32 v34, a109
    v_mul_f32 v33, v33, v32
    v_mul_f32 v34, v34, v32
    v_accvgpr_write_b32 a108, v33
    v_accvgpr_write_b32 a109, v34
    v_accvgpr_read_b32 v33, a110
    v_accvgpr_read_b32 v34, a111
    v_mul_f32 v33, v33, v32
    v_mul_f32 v34, v34, v32
    v_accvgpr_write_b32 a110, v33
    v_accvgpr_write_b32 a111, v34
    v_accvgpr_read_b32 v33, a112
    v_accvgpr_read_b32 v34, a113
    v_mul_f32 v33, v33, v32
    v_mul_f32 v34, v34, v32
    v_accvgpr_write_b32 a112, v33
    v_accvgpr_write_b32 a113, v34
    v_accvgpr_read_b32 v33, a114
    v_accvgpr_read_b32 v34, a115
    v_mul_f32 v33, v33, v32
    v_mul_f32 v34, v34, v32
    v_accvgpr_write_b32 a114, v33
    v_accvgpr_write_b32 a115, v34
    v_accvgpr_read_b32 v33, a116
    v_accvgpr_read_b32 v34, a117
    v_mul_f32 v33, v33, v32
    v_mul_f32 v34, v34, v32
    v_accvgpr_write_b32 a116, v33
    v_accvgpr_write_b32 a117, v34
    v_accvgpr_read_b32 v33, a118
    v_accvgpr_read_b32 v34, a119
    v_mul_f32 v33, v33, v32
    v_mul_f32 v34, v34, v32
    v_accvgpr_write_b32 a118, v33
    v_accvgpr_write_b32 a119, v34
    v_accvgpr_read_b32 v33, a120
    v_accvgpr_read_b32 v34, a121
    v_mul_f32 v33, v33, v32
    v_mul_f32 v34, v34, v32
    v_accvgpr_write_b32 a120, v33
    v_accvgpr_write_b32 a121, v34
    v_accvgpr_read_b32 v33, a122
    v_accvgpr_read_b32 v34, a123
    v_mul_f32 v33, v33, v32
    v_mul_f32 v34, v34, v32
    v_accvgpr_write_b32 a122, v33
    v_accvgpr_write_b32 a123, v34
    v_accvgpr_read_b32 v33, a124
    v_accvgpr_read_b32 v34, a125
    v_mul_f32 v33, v33, v32
    v_mul_f32 v34, v34, v32
    v_accvgpr_write_b32 a124, v33
    v_accvgpr_write_b32 a125, v34
    v_accvgpr_read_b32 v33, a126
    v_accvgpr_read_b32 v34, a127
    v_mul_f32 v33, v33, v32
    v_mul_f32 v34, v34, v32
    v_accvgpr_write_b32 a126, v33
    v_accvgpr_write_b32 a127, v34
    s_nop 3
    s_branch L_exret0C
L_fix1C:
    s_cmp_lg_u32 s84, 0
    s_cbranch_scc1 L_fixret1C
    s_mov_b32 s84, 1
    s_waitcnt lgkmcnt(0)
    ds_read_b128 v[36:39], v4 offset:9216
    ds_read_b128 v[40:43], v5 offset:9216
    ds_read_b128 v[44:47], v4 offset:9344
    ds_read_b128 v[48:51], v5 offset:9344
    s_waitcnt lgkmcnt(0)
    s_branch L_redo1C
L_exact1C:
    s_nop 15
    v_max3_f32 v34, v52, v53, v54
    v_max3_f32 v34, v34, v55, v56
    v_max3_f32 v34, v34, v57, v58
    v_max_f32 v34, v34, v59
    v_mov_b32 v33, v34
    s_nop 1
    v_permlane32_swap_b32 v33, v34
    v_max_f32 v34, v34, v33
    v_mov_b32 v33, v34
    s_nop 1
    v_permlane16_swap_b32 v33, v34
    v_max_f32 v34, v34, v33
    v_sub_f32 v34, 0, v34
    v_min_f32 v34, s90, v34
    v_add_f32 v12, v12, v34
    v_add_f32 v13, v13, v34
    v_add_f32 v14, v14, v34
    v_add_f32 v15, v15, v34
    v_add_f32 v52, v52, v34
    v_add_f32 v53, v53, v34
    v_add_f32 v54, v54, v34
    v_add_f32 v55, v55, v34
    v_add_f32 v56, v56, v34
    v_add_f32 v57, v57, v34
    v_add_f32 v58, v58, v34
    v_add_f32 v59, v59, v34
    v_exp_f32 v29, v34
    v_max3_f32 v34, v60, v61, v62
    v_max3_f32 v34, v34, v63, v64
    v_max3_f32 v34, v34, v65, v66
    v_max_f32 v34, v34, v67
    v_mov_b32 v33, v34
    s_nop 1
    v_permlane32_swap_b32 v33, v34
    v_max_f32 v34, v34, v33
    v_mov_b32 v33, v34
    s_nop 1
    v_permlane16_swap_b32 v33, v34
    v_max_f32 v34, v34, v33
    v_sub_f32 v34, 0, v34
    v_min_f32 v34, s90, v34
    v_add_f32 v16, v16, v34
    v_add_f32 v17, v17, v34
    v_add_f32 v18, v18, v34
    v_add_f32 v19, v19, v34
    v_add_f32 v60, v60, v34
    v_add_f32 v61, v61, v34
    v_add_f32 v62, v62, v34
    v_add_f32 v63, v63, v34
    v_add_f32 v64, v64, v34
    v_add_f32 v65, v65, v34
    v_add_f32 v66, v66, v34
    v_add_f32 v67, v67, v34
    v_exp_f32 v30, v34
    v_max3_f32 v34, v68, v69, v70
    v_max3_f32 v34, v34, v71, v72
    v_max3_f32 v34, v34, v73, v74
    v_max_f32 v34, v34, v75
    v_mov_b32 v33, v34
    s_nop 1
    v_permlane32_swap_b32 v33, v34
    v_max_f32 v34, v34, v33
    v_mov_b32 v33, v34
    s_nop 1
    v_permlane16_swap_b32 v33, v34
    v_max_f32 v34, v34, v33
    v_sub_f32 v34, 0, v34
    v_min_f32 v34, s90, v34
    v_add_f32 v20, v20, v34
    v_add_f32 v21, v21, v34
    v_add_f32 v22, v22, v34
    v_add_f32 v23, v23, v34
    v_add_f32 v68, v68, v34
    v_add_f32 v69, v69, v34
    v_add_f32 v70, v70, v34
    v_add_f32 v71, v71, v34
    v_add_f32 v72, v72, v34
    v_add_f32 v73, v73, v34
    v_add_f32 v74, v74, v34
    v_add_f32 v75, v75, v34
    v_exp_f32 v31, v34
    s_mov_b32 s90, 0
    s_cmp_lg_u32 s85, 0
    s_mov_b32 s85, 0
    s_cbranch_scc1 L_exret1C
    v_mul_f32 v25, v25, v29
    v_accvgpr_read_b32 v33, a0
    v_accvgpr_read_b32 v34, a1
    v_mul_f32 v33, v33, v29
    v_mul_f32 v34, v34, v29
    v_accvgpr_write_b32 a0, v33
    v_accvgpr_write_b32 a1, v34
    v_accvgpr_read_b32 v33, a2
    v_accvgpr_read_b32 v34, a3
    v_mul_f32 v33, v33, v29
    v_mul_f32 v34, v34, v29
    v_accvgpr_write_b32 a2, v33
    v_accvgpr_write_b32 a3, v34
    v_accvgpr_read_b32 v33, a4
    v_accvgpr_read_b32 v34, a5
    v_mul_f32 v33, v33, v29
    v_mul_f32 v34, v34, v29
    v_accvgpr_write_b32 a4, v33
    v_accvgpr_write_b32 a5, v34
    v_accvgpr_read_b32 v33, a6
    v_accvgpr_read_b32 v34, a7
    v_mul_f32 v33, v33, v29
    v_mul_f32 v34, v34, v29
    v_accvgpr_write_b32 a6, v33
    v_accvgpr_write_b32 a7, v34
    v_accvgpr_read_b32 v33, a8
    v_accvgpr_read_b32 v34, a9
    v_mul_f32 v33, v33, v29
    v_mul_f32 v34, v34, v29
    v_accvgpr_write_b32 a8, v33
    v_accvgpr_write_b32 a9, v34
    v_accvgpr_read_b32 v33, a10
    v_accvgpr_read_b32 v34, a11
    v_mul_f32 v33, v33, v29
    v_mul_f32 v34, v34, v29
    v_accvgpr_write_b32 a10, v33
    v_accvgpr_write_b32 a11, v34
    v_accvgpr_read_b32 v33, a12
    v_accvgpr_read_b32 v34, a13
    v_mul_f32 v33, v33, v29
    v_mul_f32 v34, v34, v29
    v_accvgpr_write_b32 a12, v33
    v_accvgpr_write_b32 a13, v34
    v_accvgpr_read_b32 v33, a14
    v_accvgpr_read_b32 v34, a15
    v_mul_f32 v33, v33, v29
    v_mul_f32 v34, v34, v29
    v_accvgpr_write_b32 a14, v33
    v_accvgpr_write_b32 a15, v34
    v_accvgpr_read_b32 v33, a16
    v_accvgpr_read_b32 v34, a17
    v_mul_f32 v33, v33, v29
    v_mul_f32 v34, v34, v29
    v_accvgpr_write_b32 a16, v33
    v_accvgpr_write_b32 a17, v34
    v_accvgpr_read_b32 v33, a18
    v_accvgpr_read_b32 v34, a19
    v_mul_f32 v33, v33, v29
    v_mul_f32 v34, v34, v29
    v_accvgpr_write_b32 a18, v33
    v_accvgpr_write_b32 a19, v34
    v_accvgpr_read_b32 v33, a20
    v_accvgpr_read_b32 v34, a21
    v_mul_f32 v33, v33, v29
    v_mul_f32 v34, v34, v29
    v_accvgpr_write_b32 a20, v33
    v_accvgpr_write_b32 a21, v34
    v_accvgpr_read_b32 v33, a22
    v_accvgpr_read_b32 v34, a23
    v_mul_f32 v33, v33, v29
    v_mul_f32 v34, v34, v29
    v_accvgpr_write_b32 a22, v33
    v_accvgpr_write_b32 a23, v34
    v_accvgpr_read_b32 v33, a24
    v_accvgpr_read_b32 v34, a25
    v_mul_f32 v33, v33, v29
    v_mul_f32 v34, v34, v29
    v_accvgpr_write_b32 a24, v33
    v_accvgpr_write_b32 a25, v34
    v_accvgpr_read_b32 v33, a26
    v_accvgpr_read_b32 v34, a27
    v_mul_f32 v33, v33, v29
    v_mul_f32 v34, v34, v29
    v_accvgpr_write_b32 a26, v33
    v_accvgpr_write_b32 a27, v34
    v_accvgpr_read_b32 v33, a28
    v_accvgpr_read_b32 v34, a29
    v_mul_f32 v33, v33, v29
    v_mul_f32 v34, v34, v29
    v_accvgpr_write_b32 a28, v33
    v_accvgpr_write_b32 a29, v34
    v_accvgpr_read_b32 v33, a30
    v_accvgpr_read_b32 v34, a31
    v_mul_f32 v33, v33, v29
    v_mul_f32 v34, v34, v29
    v_accvgpr_write_b32 a30, v33
    v_accvgpr_write_b32 a31, v34
    v_mul_f32 v26, v26, v30
    v_accvgpr_read_b32 v33, a32
    v_accvgpr_read_b32 v34, a33
    v_mul_f32 v33, v33, v30
    v_mul_f32 v34, v34, v30
    v_accvgpr_write_b32 a32, v33
    v_accvgpr_write_b32 a33, v34
    v_accvgpr_read_b32 v33, a34
    v_accvgpr_read_b32 v34, a35
    v_mul_f32 v33, v33, v30
    v_mul_f32 v34, v34, v30
    v_accvgpr_write_b32 a34, v33
    v_accvgpr_write_b32 a35, v34
    v_accvgpr_read_b32 v33, a36
    v_accvgpr_read_b32 v34, a37
    v_mul_f32 v33, v33, v30
    v_mul_f32 v34, v34, v30
    v_accvgpr_write_b32 a36, v33
    v_accvgpr_write_b32 a37, v34
    v_accvgpr_read_b32 v33, a38
    v_accvgpr_read_b32 v34, a39
    v_mul_f32 v33, v33, v30
    v_mul_f32 v34, v34, v30
    v_accvgpr_write_b32 a38, v33
    v_accvgpr_write_b32 a39, v34
    v_accvgpr_read_b32 v33, a40
    v_accvgpr_read_b32 v34, a41
    v_mul_f32 v33, v33, v30
    v_mul_f32 v34, v34, v30
    v_accvgpr_write_b32 a40, v33
    v_accvgpr_write_b32 a41, v34
    v_accvgpr_read_b32 v33, a42
    v_accvgpr_read_b32 v34, a43
    v_mul_f32 v33, v33, v30
    v_mul_f32 v34, v34, v30
    v_accvgpr_write_b32 a42, v33
    v_accvgpr_write_b32 a43, v34
    v_accvgpr_read_b32 v33, a44
    v_accvgpr_read_b32 v34, a45
    v_mul_f32 v33, v33, v30
    v_mul_f32 v34, v34, v30
    v_accvgpr_write_b32 a44, v33
    v_accvgpr_write_b32 a45, v34
    v_accvgpr_read_b32 v33, a46
    v_accvgpr_read_b32 v34, a47
    v_mul_f32 v33, v33, v30
    v_mul_f32 v34, v34, v30
    v_accvgpr_write_b32 a46, v33
    v_accvgpr_write_b32 a47, v34
    v_accvgpr_read_b32 v33, a48
    v_accvgpr_read_b32 v34, a49
    v_mul_f32 v33, v33, v30
    v_mul_f32 v34, v34, v30
    v_accvgpr_write_b32 a48, v33
    v_accvgpr_write_b32 a49, v34
    v_accvgpr_read_b32 v33, a50
    v_accvgpr_read_b32 v34, a51
    v_mul_f32 v33, v33, v30
    v_mul_f32 v34, v34, v30
    v_accvgpr_write_b32 a50, v33
    v_accvgpr_write_b32 a51, v34
    v_accvgpr_read_b32 v33, a52
    v_accvgpr_read_b32 v34, a53
    v_mul_f32 v33, v33, v30
    v_mul_f32 v34, v34, v30
    v_accvgpr_write_b32 a52, v33
    v_accvgpr_write_b32 a53, v34
    v_accvgpr_read_b32 v33, a54
    v_accvgpr_read_b32 v34, a55
    v_mul_f32 v33, v33, v30
    v_mul_f32 v34, v34, v30
    v_accvgpr_write_b32 a54, v33
    v_accvgpr_write_b32 a55, v34
    v_accvgpr_read_b32 v33, a56
    v_accvgpr_read_b32 v34, a57
    v_mul_f32 v33, v33, v30
    v_mul_f32 v34, v34, v30
    v_accvgpr_write_b32 a56, v33
    v_accvgpr_write_b32 a57, v34
    v_accvgpr_read_b32 v33, a58
    v_accvgpr_read_b32 v34, a59
    v_mul_f32 v33, v33, v30
    v_mul_f32 v34, v34, v30
    v_accvgpr_write_b32 a58, v33
    v_accvgpr_write_b32 a59, v34
    v_accvgpr_read_b32 v33, a60
    v_accvgpr_read_b32 v34, a61
    v_mul_f32 v33, v33, v30
    v_mul_f32 v34, v34, v30
    v_accvgpr_write_b32 a60, v33
    v_accvgpr_write_b32 a61, v34
    v_accvgpr_read_b32 v33, a62
    v_accvgpr_read_b32 v34, a63
    v_mul_f32 v33, v33, v30
    v_mul_f32 v34, v34, v30
    v_accvgpr_write_b32 a62, v33
    v_accvgpr_write_b32 a63, v34
    v_mul_f32 v27, v27, v31
    v_accvgpr_read_b32 v33, a64
    v_accvgpr_read_b32 v34, a65
    v_mul_f32 v33, v33, v31
    v_mul_f32 v34, v34, v31
    v_accvgpr_write_b32 a64, v33
    v_accvgpr_write_b32 a65, v34
    v_accvgpr_read_b32 v33, a66
    v_accvgpr_read_b32 v34, a67
    v_mul_f32 v33, v33, v31
    v_mul_f32 v34, v34, v31
    v_accvgpr_write_b32 a66, v33
    v_accvgpr_write_b32 a67, v34
    v_accvgpr_read_b32 v33, a68
    v_accvgpr_read_b32 v34, a69
    v_mul_f32 v33, v33, v31
    v_mul_f32 v34, v34, v31
    v_accvgpr_write_b32 a68, v33
    v_accvgpr_write_b32 a69, v34
    v_accvgpr_read_b32 v33, a70
    v_accvgpr_read_b32 v34, a71
    v_mul_f32 v33, v33, v31
    v_mul_f32 v34, v34, v31
    v_accvgpr_write_b32 a70, v33
    v_accvgpr_write_b32 a71, v34
    v_accvgpr_read_b32 v33, a72
    v_accvgpr_read_b32 v34, a73
    v_mul_f32 v33, v33, v31
    v_mul_f32 v34, v34, v31
    v_accvgpr_write_b32 a72, v33
    v_accvgpr_write_b32 a73, v34
    v_accvgpr_read_b32 v33, a74
    v_accvgpr_read_b32 v34, a75
    v_mul_f32 v33, v33, v31
    v_mul_f32 v34, v34, v31
    v_accvgpr_write_b32 a74, v33
    v_accvgpr_write_b32 a75, v34
    v_accvgpr_read_b32 v33, a76
    v_accvgpr_read_b32 v34, a77
    v_mul_f32 v33, v33, v31
    v_mul_f32 v34, v34, v31
    v_accvgpr_write_b32 a76, v33
    v_accvgpr_write_b32 a77, v34
    v_accvgpr_read_b32 v33, a78
    v_accvgpr_read_b32 v34, a79
    v_mul_f32 v33, v33, v31
    v_mul_f32 v34, v34, v31
    v_accvgpr_write_b32 a78, v33
    v_accvgpr_write_b32 a79, v34
    v_accvgpr_read_b32 v33, a80
    v_accvgpr_read_b32 v34, a81
    v_mul_f32 v33, v33, v31
    v_mul_f32 v34, v34, v31
    v_accvgpr_write_b32 a80, v33
    v_accvgpr_write_b32 a81, v34
    v_accvgpr_read_b32 v33, a82
    v_accvgpr_read_b32 v34, a83
    v_mul_f32 v33, v33, v31
    v_mul_f32 v34, v34, v31
    v_accvgpr_write_b32 a82, v33
    v_accvgpr_write_b32 a83, v34
    v_accvgpr_read_b32 v33, a84
    v_accvgpr_read_b32 v34, a85
    v_mul_f32 v33, v33, v31
    v_mul_f32 v34, v34, v31
    v_accvgpr_write_b32 a84, v33
    v_accvgpr_write_b32 a85, v34
    v_accvgpr_read_b32 v33, a86
    v_accvgpr_read_b32 v34, a87
    v_mul_f32 v33, v33, v31
    v_mul_f32 v34, v34, v31
    v_accvgpr_write_b32 a86, v33
    v_accvgpr_write_b32 a87, v34
    v_accvgpr_read_b32 v33, a88
    v_accvgpr_read_b32 v34, a89
    v_mul_f32 v33, v33, v31
    v_mul_f32 v34, v34, v31
    v_accvgpr_write_b32 a88, v33
    v_accvgpr_write_b32 a89, v34
    v_accvgpr_read_b32 v33, a90
    v_accvgpr_read_b32 v34, a91
    v_mul_f32 v33, v33, v31
    v_mul_f32 v34, v34, v31
    v_accvgpr_write_b32 a90, v33
    v_accvgpr_write_b32 a91, v34
    v_accvgpr_read_b32 v33, a92
    v_accvgpr_read_b32 v34, a93
    v_mul_f32 v33, v33, v31
    v_mul_f32 v34, v34, v31
    v_accvgpr_write_b32 a92, v33
    v_accvgpr_write_b32 a93, v34
    v_accvgpr_read_b32 v33, a94
    v_accvgpr_read_b32 v34, a95
    v_mul_f32 v33, v33, v31
    v_mul_f32 v34, v34, v31
    v_accvgpr_write_b32 a94, v33
    v_accvgpr_write_b32 a95, v34
    s_nop 3
    s_branch L_exret1C
.globl oproj_kernel
.p2align 8
.type oproj_kernel,@function
oproj_kernel:
    s_cmp_ge_u32 s2, 256
    s_cbranch_scc1 L_op_end
    s_load_dwordx2 s[4:5], s[0:1], 80
    s_load_dwordx2 s[6:7], s[0:1], 96
    s_and_b32 s21, s2, 7
    s_lshr_b32 s22, s2, 3
    s_lshr_b32 s16, s21, 2
    s_and_b32 s21, s21, 3
    s_lshl_b32 s17, s21, 1
    s_lshr_b32 s23, s22, 4
    s_add_u32 s17, s17, s23
    s_bfe_u32 s18, s22, 0x10003
    s_and_b32 s19, s22, 7
    v_lshrrev_b32 v4, 6, v0
    s_nop 0
    v_readfirstlane_b32 s20, v4
    v_and_b32 v4, 63, v0
    v_lshlrev_b32 v1, 4, v4
    v_add_u32 v2, 4096, v1
    s_lshl_b32 s21, s16, 7
    s_add_u32 s21, s21, s20
    s_mul_i32 s22, s21, 104
    s_mul_i32 s23, s17, 13
    s_add_u32 s22, s22, s23
    s_mul_i32 s23, s18, 6
    s_add_u32 s22, s22, s23
    s_lshl_b32 s24, s22, 10
    s_lshl_b32 s22, s21, 5
    s_lshl_b32 s23, s19, 2
    s_add_u32 s22, s22, s23
    s_lshl_b32 s22, s22, 10
    s_add_u32 s25, s22, 27262976
    s_waitcnt lgkmcnt(0)
    s_mov_b32 s8, s6
    s_mov_b32 s9, s7
    s_mov_b32 s10, 35651584
    s_mov_b32 s11, 0x00020000
    s_mov_b32 s12, s4
    s_mov_b32 s13, s5
    s_mov_b32 s14, 3407872
    s_mov_b32 s15, 0x00020000
    buffer_load_dwordx4 v[36:39], v1, s[8:11], s25 offen
    buffer_load_dwordx4 v[40:43], v1, s[8:11], s25 offen offset:1024
    buffer_load_dwordx4 v[44:47], v1, s[8:11], s25 offen offset:2048
    buffer_load_dwordx4 v[48:51], v1, s[8:11], s25 offen offset:3072
    buffer_load_dwordx4 v[8:11], v1, s[8:11], s24 offen
    buffer_load_dwordx4 v[12:15], v1, s[8:11], s24 offen offset:1024
    buffer_load_dwordx4 v[16:19], v1, s[8:11], s24 offen offset:2048
    buffer_load_dwordx4 v[20:23], v1, s[8:11], s24 offen offset:3072
    buffer_load_dwordx4 v[24:27], v2, s[8:11], s24 offen
    buffer_load_dwordx4 v[28:31], v2, s[8:11], s24 offen offset:1024
    buffer_load_dwordx4 v[32:35], v2, s[8:11], s24 offen offset:2048
    s_add_u32 s24, s24, 425984
    s_add_u32 s25, s25, 131072
    buffer_load_dwordx4 v[80:83], v1, s[8:11], s25 offen
    buffer_load_dwordx4 v[84:87], v1, s[8:11], s25 offen offset:1024
    buffer_load_dwordx4 v[88:91], v1, s[8:11], s25 offen offset:2048
    buffer_load_dwordx4 v[92:95], v1, s[8:11], s25 offen offset:3072
    buffer_load_dwordx4 v[52:55], v1, s[8:11], s24 offen
    buffer_load_dwordx4 v[56:59], v1, s[8:11], s24 offen offset:1024
    buffer_load_dwordx4 v[60:63], v1, s[8:11], s24 offen offset:2048
    buffer_load_dwordx4 v[64:67], v1, s[8:11], s24 offen offset:3072
    buffer_load_dwordx4 v[68:71], v2, s[8:11], s24 offen
    buffer_load_dwordx4 v[72:75], v2, s[8:11], s24 offen offset:1024
    buffer_load_dwordx4 v[76:79], v2, s[8:11], s24 offen offset:2048
    s_add_u32 s24, s24, 425984
    s_add_u32 s25, s25, 131072
    buffer_load_dwordx4 v[124:127], v1, s[8:11], s25 offen
    buffer_load_dwordx4 v[128:131], v1, s[8:11], s25 offen offset:1024
    buffer_load_dwordx4 v[132:135], v1, s[8:11], s25 offen offset:2048
    buffer_load_dwordx4 v[136:139], v1, s[8:11], s25 offen offset:3072
    buffer_load_dwordx4 v[96:99], v1, s[8:11], s24 offen
    buffer_load_dwordx4 v[100:103], v1, s[8:11], s24 offen offset:1024
    buffer_load_dwordx4 v[104:107], v1, s[8:11], s24 offen offset:2048
    buffer_load_dwordx4 v[108:111], v1, s[8:11], s24 offen offset:3072
    buffer_load_dwordx4 v[112:115], v2, s[8:11], s24 offen
    buffer_load_dwordx4 v[116:119], v2, s[8:11], s24 offen offset:1024
    buffer_load_dwordx4 v[120:123], v2, s[8:11], s24 offen offset:2048
    s_add_u32 s24, s24, 425984
    s_add_u32 s25, s25, 131072
    buffer_load_dwordx4 v[168:171], v1, s[8:11], s25 offen
    buffer_load_dwordx4 v[172:175], v1, s[8:11], s25 offen offset:1024
    buffer_load_dwordx4 v[176:179], v1, s[8:11], s25 offen offset:2048
    buffer_load_dwordx4 v[180:183], v1, s[8:11], s25 offen offset:3072
    buffer_load_dwordx4 v[140:143], v1, s[8:11], s24 offen
    buffer_load_dwordx4 v[144:147], v1, s[8:11], s24 offen offset:1024
    buffer_load_dwordx4 v[148:151], v1, s[8:11], s24 offen offset:2048
    buffer_load_dwordx4 v[152:155], v1, s[8:11], s24 offen offset:3072
    buffer_load_dwordx4 v[156:159], v2, s[8:11], s24 offen
    buffer_load_dwordx4 v[160:163], v2, s[8:11], s24 offen offset:1024
    buffer_load_dwordx4 v[164:167], v2, s[8:11], s24 offen offset:2048
    s_add_u32 s24, s24, 425984
    s_add_u32 s25, s25, 131072
    s_waitcnt vmcnt(39)
    v_mfma_f32_16x16x32_bf16 a[0:3], v[36:39], v[8:11], 0
    v_mfma_f32_16x16x32_bf16 a[4:7], v[40:43], v[8:11], 0
    buffer_load_dwordx4 v[212:215], v1, s[8:11], s25 offen
    v_mfma_f32_16x16x32_bf16 a[8:11], v[44:47], v[8:11], 0
    v_mfma_f32_16x16x32_bf16 a[12:15], v[48:51], v[8:11], 0
    buffer_load_dwordx4 v[216:219], v1, s[8:11], s25 offen offset:1024
    s_waitcnt vmcnt(40)
    v_mfma_f32_16x16x32_bf16 a[16:19], v[36:39], v[12:15], 0
    v_mfma_f32_16x16x32_bf16 a[20:23], v[40:43], v[12:15], 0
    buffer_load_dwordx4 v[220:223], v1, s[8:11], s25 offen offset:2048
    v_mfma_f32_16x16x32_bf16 a[24:27], v[44:47], v[12:15], 0
    v_mfma_f32_16x16x32_bf16 a[28:31], v[48:51], v[12:15], 0
    buffer_load_dwordx4 v[224:227], v1, s[8:11], s25 offen offset:3072
    s_waitcnt vmcnt(41)
    v_mfma_f32_16x16x32_bf16 a[32:35], v[36:39], v[16:19], 0
    v_mfma_f32_16x16x32_bf16 a[36:39], v[40:43], v[16:19], 0
    buffer_load_dwordx4 v[184:187], v1, s[8:11], s24 offen
    v_mfma_f32_16x16x32_bf16 a[40:43], v[44:47], v[16:19], 0
    v_mfma_f32_16x16x32_bf16 a[44:47], v[48:51], v[16:19], 0
    buffer_load_dwordx4 v[188:191], v1, s[8:11], s24 offen offset:1024
    s_waitcnt vmcnt(42)
    v_mfma_f32_16x16x32_bf16 a[48:51], v[36:39], v[20:23], 0
    v_mfma_f32_16x16x32_bf16 a[52:55], v[40:43], v[20:23], 0
    buffer_load_dwordx4 v[192:195], v1, s[8:11], s24 offen offset:2048
    v_mfma_f32_16x16x32_bf16 a[56:59], v[44:47], v[20:23], 0
    v_mfma_f32_16x16x32_bf16 a[60:63], v[48:51], v[20:23], 0
    buffer_load_dwordx4 v[196:199], v1, s[8:11], s24 offen offset:3072
    s_waitcnt vmcnt(43)
    v_mfma_f32_16x16x32_bf16 a[64:67], v[36:39], v[24:27], 0
    v_mfma_f32_16x16x32_bf16 a[68:71], v[40:43], v[24:27], 0
    buffer_load_dwordx4 v[200:203], v2, s[8:11], s24 offen
    v_mfma_f32_16x16x32_bf16 a[72:75], v[44:47], v[24:27], 0
    v_mfma_f32_16x16x32_bf16 a[76:79], v[48:51], v[24:27], 0
    buffer_load_dwordx4 v[204:207], v2, s[8:11], s24 offen offset:1024
    s_waitcnt vmcnt(44)
    v_mfma_f32_16x16x32_bf16 a[80:83], v[36:39], v[28:31], 0
    v_mfma_f32_16x16x32_bf16 a[84:87], v[40:43], v[28:31], 0
    buffer_load_dwordx4 v[208:211], v2, s[8:11], s24 offen offset:2048
    v_mfma_f32_16x16x32_bf16 a[88:91], v[44:47], v[28:31], 0
    v_mfma_f32_16x16x32_bf16 a[92:95], v[48:51], v[28:31], 0
    s_add_u32 s24, s24, 425984
    s_add_u32 s25, s25, 131072
    s_waitcnt vmcnt(44)
    v_mfma_f32_16x16x32_bf16 a[96:99], v[36:39], v[32:35], 0
    v_mfma_f32_16x16x32_bf16 a[100:103], v[40:43], v[32:35], 0
    v_mfma_f32_16x16x32_bf16 a[104:107], v[44:47], v[32:35], 0
    v_mfma_f32_16x16x32_bf16 a[108:111], v[48:51], v[32:35], 0
    s_waitcnt vmcnt(39)
    v_mfma_f32_16x16x32_bf16 a[0:3], v[80:83], v[52:55], a[0:3]
    v_mfma_f32_16x16x32_bf16 a[4:7], v[84:87], v[52:55], a[4:7]
    buffer_load_dwordx4 v[36:39], v1, s[8:11], s25 offen
    v_mfma_f32_16x16x32_bf16 a[8:11], v[88:91], v[52:55], a[8:11]
    v_mfma_f32_16x16x32_bf16 a[12:15], v[92:95], v[52:55], a[12:15]
    buffer_load_dwordx4 v[40:43], v1, s[8:11], s25 offen offset:1024
    s_waitcnt vmcnt(40)
    v_mfma_f32_16x16x32_bf16 a[16:19], v[80:83], v[56:59], a[16:19]
    v_mfma_f32_16x16x32_bf16 a[20:23], v[84:87], v[56:59], a[20:23]
    buffer_load_dwordx4 v[44:47], v1, s[8:11], s25 offen offset:2048
    v_mfma_f32_16x16x32_bf16 a[24:27], v[88:91], v[56:59], a[24:27]
    v_mfma_f32_16x16x32_bf16 a[28:31], v[92:95], v[56:59], a[28:31]
    buffer_load_dwordx4 v[48:51], v1, s[8:11], s25 offen offset:3072
    s_waitcnt vmcnt(41)
    v_mfma_f32_16x16x32_bf16 a[32:35], v[80:83], v[60:63], a[32:35]
    v_mfma_f32_16x16x32_bf16 a[36:39], v[84:87], v[60:63], a[36:39]
    buffer_load_dwordx4 v[8:11], v1, s[8:11], s24 offen
    v_mfma_f32_16x16x32_bf16 a[40:43], v[88:91], v[60:63], a[40:43]
    v_mfma_f32_16x16x32_bf16 a[44:47], v[92:95], v[60:63], a[44:47]
    buffer_load_dwordx4 v[12:15], v1, s[8:11], s24 offen offset:1024
    s_waitcnt vmcnt(42)
    v_mfma_f32_16x16x32_bf16 a[48:51], v[80:83], v[64:67], a[48:51]
    v_mfma_f32_16x16x32_bf16 a[52:55], v[84:87], v[64:67], a[52:55]
    buffer_load_dwordx4 v[16:19], v1, s[8:11], s24 offen offset:2048
    v_mfma_f32_16x16x32_bf16 a[56:59], v[88:91], v[64:67], a[56:59]
    v_mfma_f32_16x16x32_bf16 a[60:63], v[92:95], v[64:67], a[60:63]
    buffer_load_dwordx4 v[20:23], v1, s[8:11], s24 offen offset:3072
    s_waitcnt vmcnt(43)
    v_mfma_f32_16x16x32_bf16 a[64:67], v[80:83], v[68:71], a[64:67]
    v_mfma_f32_16x16x32_bf16 a[68:71], v[84:87], v[68:71], a[68:71]
    buffer_load_dwordx4 v[24:27], v2, s[8:11], s24 offen
    v_mfma_f32_16x16x32_bf16 a[72:75], v[88:91], v[68:71], a[72:75]
    v_mfma_f32_16x16x32_bf16 a[76:79], v[92:95], v[68:71], a[76:79]
    buffer_load_dwordx4 v[28:31], v2, s[8:11], s24 offen offset:1024
    s_waitcnt vmcnt(44)
    v_mfma_f32_16x16x32_bf16 a[80:83], v[80:83], v[72:75], a[80:83]
    v_mfma_f32_16x16x32_bf16 a[84:87], v[84:87], v[72:75], a[84:87]
    buffer_load_dwordx4 v[32:35], v2, s[8:11], s24 offen offset:2048
    v_mfma_f32_16x16x32_bf16 a[88:91], v[88:91], v[72:75], a[88:91]
    v_mfma_f32_16x16x32_bf16 a[92:95], v[92:95], v[72:75], a[92:95]
    s_add_u32 s24, s24, 425984
    s_add_u32 s25, s25, 131072
    s_waitcnt vmcnt(44)
    v_mfma_f32_16x16x32_bf16 a[96:99], v[80:83], v[76:79], a[96:99]
    v_mfma_f32_16x16x32_bf16 a[100:103], v[84:87], v[76:79], a[100:103]
    v_mfma_f32_16x16x32_bf16 a[104:107], v[88:91], v[76:79], a[104:107]
    v_mfma_f32_16x16x32_bf16 a[108:111], v[92:95], v[76:79], a[108:111]
    s_waitcnt vmcnt(39)
    v_mfma_f32_16x16x32_bf16 a[0:3], v[124:127], v[96:99], a[0:3]
    v_mfma_f32_16x16x32_bf16 a[4:7], v[128:131], v[96:99], a[4:7]
    buffer_load_dwordx4 v[80:83], v1, s[8:11], s25 offen
    v_mfma_f32_16x16x32_bf16 a[8:11], v[132:135], v[96:99], a[8:11]
    v_mfma_f32_16x16x32_bf16 a[12:15], v[136:139], v[96:99], a[12:15]
    buffer_load_dwordx4 v[84:87], v1, s[8:11], s25 offen offset:1024
    s_waitcnt vmcnt(40)
    v_mfma_f32_16x16x32_bf16 a[16:19], v[124:127], v[100:103], a[16:19]
    v_mfma_f32_16x16x32_bf16 a[20:23], v[128:131], v[100:103], a[20:23]
    buffer_load_dwordx4 v[88:91], v1, s[8:11], s25 offen offset:2048
    v_mfma_f32_16x16x32_bf16 a[24:27], v[132:135], v[100:103], a[24:27]
    v_mfma_f32_16x16x32_bf16 a[28:31], v[136:139], v[100:103], a[28:31]
    buffer_load_dwordx4 v[92:95], v1, s[8:11], s25 offen offset:3072
    s_waitcnt vmcnt(41)
    v_mfma_f32_16x16x32_bf16 a[32:35], v[124:127], v[104:107], a[32:35]
    v_mfma_f32_16x16x32_bf16 a[36:39], v[128:131], v[104:107], a[36:39]
    buffer_load_dwordx4 v[52:55], v1, s[8:11], s24 offen
    v_mfma_f32_16x16x32_bf16 a[40:43], v[132:135], v[104:107], a[40:43]
    v_mfma_f32_16x16x32_bf16 a[44:47], v[136:139], v[104:107], a[44:47]
    buffer_load_dwordx4 v[56:59], v1, s[8:11], s24 offen offset:1024
    s_waitcnt vmcnt(42)
    v_mfma_f32_16x16x32_bf16 a[48:51], v[124:127], v[108:111], a[48:51]
    v_mfma_f32_16x16x32_bf16 a[52:55], v[128:131], v[108:111], a[52:55]
    buffer_load_dwordx4 v[60:63], v1, s[8:11], s24 offen offset:2048
    v_mfma_f32_16x16x32_bf16 a[56:59], v[132:135], v[108:111], a[56:59]
    v_mfma_f32_16x16x32_bf16 a[60:63], v[136:139], v[108:111], a[60:63]
    buffer_load_dwordx4 v[64:67], v1, s[8:11], s24 offen offset:3072
    s_waitcnt vmcnt(43)
    v_mfma_f32_16x16x32_bf16 a[64:67], v[124:127], v[112:115], a[64:67]
    v_mfma_f32_16x16x32_bf16 a[68:71], v[128:131], v[112:115], a[68:71]
    buffer_load_dwordx4 v[68:71], v2, s[8:11], s24 offen
    v_mfma_f32_16x16x32_bf16 a[72:75], v[132:135], v[112:115], a[72:75]
    v_mfma_f32_16x16x32_bf16 a[76:79], v[136:139], v[112:115], a[76:79]
    buffer_load_dwordx4 v[72:75], v2, s[8:11], s24 offen offset:1024
    s_waitcnt vmcnt(44)
    v_mfma_f32_16x16x32_bf16 a[80:83], v[124:127], v[116:119], a[80:83]
    v_mfma_f32_16x16x32_bf16 a[84:87], v[128:131], v[116:119], a[84:87]
    buffer_load_dwordx4 v[76:79], v2, s[8:11], s24 offen offset:2048
    v_mfma_f32_16x16x32_bf16 a[88:91], v[132:135], v[116:119], a[88:91]
    v_mfma_f32_16x16x32_bf16 a[92:95], v[136:139], v[116:119], a[92:95]
    s_add_u32 s24, s24, 425984
    s_add_u32 s25, s25, 131072
    s_waitcnt vmcnt(44)
    v_mfma_f32_16x16x32_bf16 a[96:99], v[124:127], v[120:123], a[96:99]
    v_mfma_f32_16x16x32_bf16 a[100:103], v[128:131], v[120:123], a[100:103]
    v_mfma_f32_16x16x32_bf16 a[104:107], v[132:135], v[120:123], a[104:107]
    v_mfma_f32_16x16x32_bf16 a[108:111], v[136:139], v[120:123], a[108:111]
    s_waitcnt vmcnt(39)
    v_mfma_f32_16x16x32_bf16 a[0:3], v[168:171], v[140:143], a[0:3]
    v_mfma_f32_16x16x32_bf16 a[4:7], v[172:175], v[140:143], a[4:7]
    buffer_load_dwordx4 v[124:127], v1, s[8:11], s25 offen
    v_mfma_f32_16x16x32_bf16 a[8:11], v[176:179], v[140:143], a[8:11]
    v_mfma_f32_16x16x32_bf16 a[12:15], v[180:183], v[140:143], a[12:15]
    buffer_load_dwordx4 v[128:131], v1, s[8:11], s25 offen offset:1024
    s_waitcnt vmcnt(40)
    v_mfma_f32_16x16x32_bf16 a[16:19], v[168:171], v[144:147], a[16:19]
    v_mfma_f32_16x16x32_bf16 a[20:23], v[172:175], v[144:147], a[20:23]
    buffer_load_dwordx4 v[132:135], v1, s[8:11], s25 offen offset:2048
    v_mfma_f32_16x16x32_bf16 a[24:27], v[176:179], v[144:147], a[24:27]
    v_mfma_f32_16x16x32_bf16 a[28:31], v[180:183], v[144:147], a[28:31]
    buffer_load_dwordx4 v[136:139], v1, s[8:11], s25 offen offset:3072
    s_waitcnt vmcnt(41)
    v_mfma_f32_16x16x32_bf16 a[32:35], v[168:171], v[148:151], a[32:35]
    v_mfma_f32_16x16x32_bf16 a[36:39], v[172:175], v[148:151], a[36:39]
    buffer_load_dwordx4 v[96:99], v1, s[8:11], s24 offen
    v_mfma_f32_16x16x32_bf16 a[40:43], v[176:179], v[148:151], a[40:43]
    v_mfma_f32_16x16x32_bf16 a[44:47], v[180:183], v[148:151], a[44:47]
    buffer_load_dwordx4 v[100:103], v1, s[8:11], s24 offen offset:1024
    s_waitcnt vmcnt(42)
    v_mfma_f32_16x16x32_bf16 a[48:51], v[168:171], v[152:155], a[48:51]
    v_mfma_f32_16x16x32_bf16 a[52:55], v[172:175], v[152:155], a[52:55]
    buffer_load_dwordx4 v[104:107], v1, s[8:11], s24 offen offset:2048
    v_mfma_f32_16x16x32_bf16 a[56:59], v[176:179], v[152:155], a[56:59]
    v_mfma_f32_16x16x32_bf16 a[60:63], v[180:183], v[152:155], a[60:63]
    buffer_load_dwordx4 v[108:111], v1, s[8:11], s24 offen offset:3072
    s_waitcnt vmcnt(43)
    v_mfma_f32_16x16x32_bf16 a[64:67], v[168:171], v[156:159], a[64:67]
    v_mfma_f32_16x16x32_bf16 a[68:71], v[172:175], v[156:159], a[68:71]
    buffer_load_dwordx4 v[112:115], v2, s[8:11], s24 offen
    v_mfma_f32_16x16x32_bf16 a[72:75], v[176:179], v[156:159], a[72:75]
    v_mfma_f32_16x16x32_bf16 a[76:79], v[180:183], v[156:159], a[76:79]
    buffer_load_dwordx4 v[116:119], v2, s[8:11], s24 offen offset:1024
    s_waitcnt vmcnt(44)
    v_mfma_f32_16x16x32_bf16 a[80:83], v[168:171], v[160:163], a[80:83]
    v_mfma_f32_16x16x32_bf16 a[84:87], v[172:175], v[160:163], a[84:87]
    buffer_load_dwordx4 v[120:123], v2, s[8:11], s24 offen offset:2048
    v_mfma_f32_16x16x32_bf16 a[88:91], v[176:179], v[160:163], a[88:91]
    v_mfma_f32_16x16x32_bf16 a[92:95], v[180:183], v[160:163], a[92:95]
    s_add_u32 s24, s24, 425984
    s_add_u32 s25, s25, 131072
    s_waitcnt vmcnt(44)
    v_mfma_f32_16x16x32_bf16 a[96:99], v[168:171], v[164:167], a[96:99]
    v_mfma_f32_16x16x32_bf16 a[100:103], v[172:175], v[164:167], a[100:103]
    v_mfma_f32_16x16x32_bf16 a[104:107], v[176:179], v[164:167], a[104:107]
    v_mfma_f32_16x16x32_bf16 a[108:111], v[180:183], v[164:167], a[108:111]
    s_waitcnt vmcnt(39)
    v_mfma_f32_16x16x32_bf16 a[0:3], v[212:215], v[184:187], a[0:3]
    v_mfma_f32_16x16x32_bf16 a[4:7], v[216:219], v[184:187], a[4:7]
    buffer_load_dwordx4 v[168:171], v1, s[8:11], s25 offen
    v_mfma_f32_16x16x32_bf16 a[8:11], v[220:223], v[184:187], a[8:11]
    v_mfma_f32_16x16x32_bf16 a[12:15], v[224:227], v[184:187], a[12:15]
    buffer_load_dwordx4 v[172:175], v1, s[8:11], s25 offen offset:1024
    s_waitcnt vmcnt(40)
    v_mfma_f32_16x16x32_bf16 a[16:19], v[212:215], v[188:191], a[16:19]
    v_mfma_f32_16x16x32_bf16 a[20:23], v[216:219], v[188:191], a[20:23]
    buffer_load_dwordx4 v[176:179], v1, s[8:11], s25 offen offset:2048
    v_mfma_f32_16x16x32_bf16 a[24:27], v[220:223], v[188:191], a[24:27]
    v_mfma_f32_16x16x32_bf16 a[28:31], v[224:227], v[188:191], a[28:31]
    buffer_load_dwordx4 v[180:183], v1, s[8:11], s25 offen offset:3072
    s_waitcnt vmcnt(41)
    v_mfma_f32_16x16x32_bf16 a[32:35], v[212:215], v[192:195], a[32:35]
    v_mfma_f32_16x16x32_bf16 a[36:39], v[216:219], v[192:195], a[36:39]
    buffer_load_dwordx4 v[140:143], v1, s[8:11], s24 offen
    v_mfma_f32_16x16x32_bf16 a[40:43], v[220:223], v[192:195], a[40:43]
    v_mfma_f32_16x16x32_bf16 a[44:47], v[224:227], v[192:195], a[44:47]
    buffer_load_dwordx4 v[144:147], v1, s[8:11], s24 offen offset:1024
    s_waitcnt vmcnt(42)
    v_mfma_f32_16x16x32_bf16 a[48:51], v[212:215], v[196:199], a[48:51]
    v_mfma_f32_16x16x32_bf16 a[52:55], v[216:219], v[196:199], a[52:55]
    buffer_load_dwordx4 v[148:151], v1, s[8:11], s24 offen offset:2048
    v_mfma_f32_16x16x32_bf16 a[56:59], v[220:223], v[196:199], a[56:59]
    v_mfma_f32_16x16x32_bf16 a[60:63], v[224:227], v[196:199], a[60:63]
    buffer_load_dwordx4 v[152:155], v1, s[8:11], s24 offen offset:3072
    s_waitcnt vmcnt(43)
    v_mfma_f32_16x16x32_bf16 a[64:67], v[212:215], v[200:203], a[64:67]
    v_mfma_f32_16x16x32_bf16 a[68:71], v[216:219], v[200:203], a[68:71]
    buffer_load_dwordx4 v[156:159], v2, s[8:11], s24 offen
    v_mfma_f32_16x16x32_bf16 a[72:75], v[220:223], v[200:203], a[72:75]
    v_mfma_f32_16x16x32_bf16 a[76:79], v[224:227], v[200:203], a[76:79]
    buffer_load_dwordx4 v[160:163], v2, s[8:11], s24 offen offset:1024
    s_waitcnt vmcnt(44)
    v_mfma_f32_16x16x32_bf16 a[80:83], v[212:215], v[204:207], a[80:83]
    v_mfma_f32_16x16x32_bf16 a[84:87], v[216:219], v[204:207], a[84:87]
    buffer_load_dwordx4 v[164:167], v2, s[8:11], s24 offen offset:2048
    v_mfma_f32_16x16x32_bf16 a[88:91], v[220:223], v[204:207], a[88:91]
    v_mfma_f32_16x16x32_bf16 a[92:95], v[224:227], v[204:207], a[92:95]
    s_add_u32 s24, s24, 425984
    s_add_u32 s25, s25, 131072
    s_waitcnt vmcnt(44)
    v_mfma_f32_16x16x32_bf16 a[96:99], v[212:215], v[208:211], a[96:99]
    v_mfma_f32_16x16x32_bf16 a[100:103], v[216:219], v[208:211], a[100:103]
    v_mfma_f32_16x16x32_bf16 a[104:107], v[220:223], v[208:211], a[104:107]
    v_mfma_f32_16x16x32_bf16 a[108:111], v[224:227], v[208:211], a[108:111]
    s_waitcnt vmcnt(39)
    v_mfma_f32_16x16x32_bf16 a[0:3], v[36:39], v[8:11], a[0:3]
    v_mfma_f32_16x16x32_bf16 a[4:7], v[40:43], v[8:11], a[4:7]
    buffer_load_dwordx4 v[212:215], v1, s[8:11], s25 offen
    v_mfma_f32_16x16x32_bf16 a[8:11], v[44:47], v[8:11], a[8:11]
    v_mfma_f32_16x16x32_bf16 a[12:15], v[48:51], v[8:11], a[12:15]
    buffer_load_dwordx4 v[216:219], v1, s[8:11], s25 offen offset:1024
    s_waitcnt vmcnt(40)
    v_mfma_f32_16x16x32_bf16 a[16:19], v[36:39], v[12:15], a[16:19]
    v_mfma_f32_16x16x32_bf16 a[20:23], v[40:43], v[12:15], a[20:23]
    buffer_load_dwordx4 v[220:223], v1, s[8:11], s25 offen offset:2048
    v_mfma_f32_16x16x32_bf16 a[24:27], v[44:47], v[12:15], a[24:27]
    v_mfma_f32_16x16x32_bf16 a[28:31], v[48:51], v[12:15], a[28:31]
    buffer_load_dwordx4 v[224:227], v1, s[8:11], s25 offen offset:3072
    s_waitcnt vmcnt(41)
    v_mfma_f32_16x16x32_bf16 a[32:35], v[36:39], v[16:19], a[32:35]
    v_mfma_f32_16x16x32_bf16 a[36:39], v[40:43], v[16:19], a[36:39]
    buffer_load_dwordx4 v[184:187], v1, s[8:11], s24 offen
    v_mfma_f32_16x16x32_bf16 a[40:43], v[44:47], v[16:19], a[40:43]
    v_mfma_f32_16x16x32_bf16 a[44:47], v[48:51], v[16:19], a[44:47]
    buffer_load_dwordx4 v[188:191], v1, s[8:11], s24 offen offset:1024
    s_waitcnt vmcnt(42)
    v_mfma_f32_16x16x32_bf16 a[48:51], v[36:39], v[20:23], a[48:51]
    v_mfma_f32_16x16x32_bf16 a[52:55], v[40:43], v[20:23], a[52:55]
    buffer_load_dwordx4 v[192:195], v1, s[8:11], s24 offen offset:2048
    v_mfma_f32_16x16x32_bf16 a[56:59], v[44:47], v[20:23], a[56:59]
    v_mfma_f32_16x16x32_bf16 a[60:63], v[48:51], v[20:23], a[60:63]
    buffer_load_dwordx4 v[196:199], v1, s[8:11], s24 offen offset:3072
    s_waitcnt vmcnt(43)
    v_mfma_f32_16x16x32_bf16 a[64:67], v[36:39], v[24:27], a[64:67]
    v_mfma_f32_16x16x32_bf16 a[68:71], v[40:43], v[24:27], a[68:71]
    buffer_load_dwordx4 v[200:203], v2, s[8:11], s24 offen
    v_mfma_f32_16x16x32_bf16 a[72:75], v[44:47], v[24:27], a[72:75]
    v_mfma_f32_16x16x32_bf16 a[76:79], v[48:51], v[24:27], a[76:79]
    buffer_load_dwordx4 v[204:207], v2, s[8:11], s24 offen offset:1024
    s_waitcnt vmcnt(44)
    v_mfma_f32_16x16x32_bf16 a[80:83], v[36:39], v[28:31], a[80:83]
    v_mfma_f32_16x16x32_bf16 a[84:87], v[40:43], v[28:31], a[84:87]
    buffer_load_dwordx4 v[208:211], v2, s[8:11], s24 offen offset:2048
    v_mfma_f32_16x16x32_bf16 a[88:91], v[44:47], v[28:31], a[88:91]
    v_mfma_f32_16x16x32_bf16 a[92:95], v[48:51], v[28:31], a[92:95]
    s_add_u32 s24, s24, 425984
    s_add_u32 s25, s25, 131072
    s_waitcnt vmcnt(44)
    v_mfma_f32_16x16x32_bf16 a[96:99], v[36:39], v[32:35], a[96:99]
    v_mfma_f32_16x16x32_bf16 a[100:103], v[40:43], v[32:35], a[100:103]
    v_mfma_f32_16x16x32_bf16 a[104:107], v[44:47], v[32:35], a[104:107]
    v_mfma_f32_16x16x32_bf16 a[108:111], v[48:51], v[32:35], a[108:111]
    s_waitcnt vmcnt(39)
    v_mfma_f32_16x16x32_bf16 a[0:3], v[80:83], v[52:55], a[0:3]
    v_mfma_f32_16x16x32_bf16 a[4:7], v[84:87], v[52:55], a[4:7]
    buffer_load_dwordx4 v[36:39], v1, s[8:11], s25 offen
    v_mfma_f32_16x16x32_bf16 a[8:11], v[88:91], v[52:55], a[8:11]
    v_mfma_f32_16x16x32_bf16 a[12:15], v[92:95], v[52:55], a[12:15]
    buffer_load_dwordx4 v[40:43], v1, s[8:11], s25 offen offset:1024
    s_waitcnt vmcnt(40)
    v_mfma_f32_16x16x32_bf16 a[16:19], v[80:83], v[56:59], a[16:19]
    v_mfma_f32_16x16x32_bf16 a[20:23], v[84:87], v[56:59], a[20:23]
    buffer_load_dwordx4 v[44:47], v1, s[8:11], s25 offen offset:2048
    v_mfma_f32_16x16x32_bf16 a[24:27], v[88:91], v[56:59], a[24:27]
    v_mfma_f32_16x16x32_bf16 a[28:31], v[92:95], v[56:59], a[28:31]
    buffer_load_dwordx4 v[48:51], v1, s[8:11], s25 offen offset:3072
    s_waitcnt vmcnt(41)
    v_mfma_f32_16x16x32_bf16 a[32:35], v[80:83], v[60:63], a[32:35]
    v_mfma_f32_16x16x32_bf16 a[36:39], v[84:87], v[60:63], a[36:39]
    buffer_load_dwordx4 v[8:11], v1, s[8:11], s24 offen
    v_mfma_f32_16x16x32_bf16 a[40:43], v[88:91], v[60:63], a[40:43]
    v_mfma_f32_16x16x32_bf16 a[44:47], v[92:95], v[60:63], a[44:47]
    buffer_load_dwordx4 v[12:15], v1, s[8:11], s24 offen offset:1024
    s_waitcnt vmcnt(42)
    v_mfma_f32_16x16x32_bf16 a[48:51], v[80:83], v[64:67], a[48:51]
    v_mfma_f32_16x16x32_bf16 a[52:55], v[84:87], v[64:67], a[52:55]
    buffer_load_dwordx4 v[16:19], v1, s[8:11], s24 offen offset:2048
    v_mfma_f32_16x16x32_bf16 a[56:59], v[88:91], v[64:67], a[56:59]
    v_mfma_f32_16x16x32_bf16 a[60:63], v[92:95], v[64:67], a[60:63]
    buffer_load_dwordx4 v[20:23], v1, s[8:11], s24 offen offset:3072
    s_waitcnt vmcnt(43)
    v_mfma_f32_16x16x32_bf16 a[64:67], v[80:83], v[68:71], a[64:67]
    v_mfma_f32_16x16x32_bf16 a[68:71], v[84:87], v[68:71], a[68:71]
    buffer_load_dwordx4 v[24:27], v2, s[8:11], s24 offen
    v_mfma_f32_16x16x32_bf16 a[72:75], v[88:91], v[68:71], a[72:75]
    v_mfma_f32_16x16x32_bf16 a[76:79], v[92:95], v[68:71], a[76:79]
    buffer_load_dwordx4 v[28:31], v2, s[8:11], s24 offen offset:1024
    s_waitcnt vmcnt(44)
    v_mfma_f32_16x16x32_bf16 a[80:83], v[80:83], v[72:75], a[80:83]
    v_mfma_f32_16x16x32_bf16 a[84:87], v[84:87], v[72:75], a[84:87]
    buffer_load_dwordx4 v[32:35], v2, s[8:11], s24 offen offset:2048
    v_mfma_f32_16x16x32_bf16 a[88:91], v[88:91], v[72:75], a[88:91]
    v_mfma_f32_16x16x32_bf16 a[92:95], v[92:95], v[72:75], a[92:95]
    s_add_u32 s24, s24, 425984
    s_add_u32 s25, s25, 131072
    s_waitcnt vmcnt(44)
    v_mfma_f32_16x16x32_bf16 a[96:99], v[80:83], v[76:79], a[96:99]
    v_mfma_f32_16x16x32_bf16 a[100:103], v[84:87], v[76:79], a[100:103]
    v_mfma_f32_16x16x32_bf16 a[104:107], v[88:91], v[76:79], a[104:107]
    v_mfma_f32_16x16x32_bf16 a[108:111], v[92:95], v[76:79], a[108:111]
    s_waitcnt vmcnt(39)
    v_mfma_f32_16x16x32_bf16 a[0:3], v[124:127], v[96:99], a[0:3]
    v_mfma_f32_16x16x32_bf16 a[4:7], v[128:131], v[96:99], a[4:7]
    buffer_load_dwordx4 v[80:83], v1, s[8:11], s25 offen
    v_mfma_f32_16x16x32_bf16 a[8:11], v[132:135], v[96:99], a[8:11]
    v_mfma_f32_16x16x32_bf16 a[12:15], v[136:139], v[96:99], a[12:15]
    buffer_load_dwordx4 v[84:87], v1, s[8:11], s25 offen offset:1024
    s_waitcnt vmcnt(40)
    v_mfma_f32_16x16x32_bf16 a[16:19], v[124:127], v[100:103], a[16:19]
    v_mfma_f32_16x16x32_bf16 a[20:23], v[128:131], v[100:103], a[20:23]
    buffer_load_dwordx4 v[88:91], v1, s[8:11], s25 offen offset:2048
    v_mfma_f32_16x16x32_bf16 a[24:27], v[132:135], v[100:103], a[24:27]
    v_mfma_f32_16x16x32_bf16 a[28:31], v[136:139], v[100:103], a[28:31]
    buffer_load_dwordx4 v[92:95], v1, s[8:11], s25 offen offset:3072
    s_waitcnt vmcnt(41)
    v_mfma_f32_16x16x32_bf16 a[32:35], v[124:127], v[104:107], a[32:35]
    v_mfma_f32_16x16x32_bf16 a[36:39], v[128:131], v[104:107], a[36:39]
    buffer_load_dwordx4 v[52:55], v1, s[8:11], s24 offen
    v_mfma_f32_16x16x32_bf16 a[40:43], v[132:135], v[104:107], a[40:43]
    v_mfma_f32_16x16x32_bf16 a[44:47], v[136:139], v[104:107], a[44:47]
    buffer_load_dwordx4 v[56:59], v1, s[8:11], s24 offen offset:1024
    s_waitcnt vmcnt(42)
    v_mfma_f32_16x16x32_bf16 a[48:51], v[124:127], v[108:111], a[48:51]
    v_mfma_f32_16x16x32_bf16 a[52:55], v[128:131], v[108:111], a[52:55]
    buffer_load_dwordx4 v[60:63], v1, s[8:11], s24 offen offset:2048
    v_mfma_f32_16x16x32_bf16 a[56:59], v[132:135], v[108:111], a[56:59]
    v_mfma_f32_16x16x32_bf16 a[60:63], v[136:139], v[108:111], a[60:63]
    buffer_load_dwordx4 v[64:67], v1, s[8:11], s24 offen offset:3072
    s_waitcnt vmcnt(43)
    v_mfma_f32_16x16x32_bf16 a[64:67], v[124:127], v[112:115], a[64:67]
    v_mfma_f32_16x16x32_bf16 a[68:71], v[128:131], v[112:115], a[68:71]
    buffer_load_dwordx4 v[68:71], v2, s[8:11], s24 offen
    v_mfma_f32_16x16x32_bf16 a[72:75], v[132:135], v[112:115], a[72:75]
    v_mfma_f32_16x16x32_bf16 a[76:79], v[136:139], v[112:115], a[76:79]
    buffer_load_dwordx4 v[72:75], v2, s[8:11], s24 offen offset:1024
    s_waitcnt vmcnt(44)
    v_mfma_f32_16x16x32_bf16 a[80:83], v[124:127], v[116:119], a[80:83]
    v_mfma_f32_16x16x32_bf16 a[84:87], v[128:131], v[116:119], a[84:87]
    buffer_load_dwordx4 v[76:79], v2, s[8:11], s24 offen offset:2048
    v_mfma_f32_16x16x32_bf16 a[88:91], v[132:135], v[116:119], a[88:91]
    v_mfma_f32_16x16x32_bf16 a[92:95], v[136:139], v[116:119], a[92:95]
    s_add_u32 s24, s24, 425984
    s_add_u32 s25, s25, 131072
    s_waitcnt vmcnt(44)
    v_mfma_f32_16x16x32_bf16 a[96:99], v[124:127], v[120:123], a[96:99]
    v_mfma_f32_16x16x32_bf16 a[100:103], v[128:131], v[120:123], a[100:103]
    v_mfma_f32_16x16x32_bf16 a[104:107], v[132:135], v[120:123], a[104:107]
    v_mfma_f32_16x16x32_bf16 a[108:111], v[136:139], v[120:123], a[108:111]
    s_waitcnt vmcnt(39)
    v_mfma_f32_16x16x32_bf16 a[0:3], v[168:171], v[140:143], a[0:3]
    v_mfma_f32_16x16x32_bf16 a[4:7], v[172:175], v[140:143], a[4:7]
    buffer_load_dwordx4 v[124:127], v1, s[8:11], s25 offen
    v_mfma_f32_16x16x32_bf16 a[8:11], v[176:179], v[140:143], a[8:11]
    v_mfma_f32_16x16x32_bf16 a[12:15], v[180:183], v[140:143], a[12:15]
    buffer_load_dwordx4 v[128:131], v1, s[8:11], s25 offen offset:1024
    s_waitcnt vmcnt(40)
    v_mfma_f32_16x16x32_bf16 a[16:19], v[168:171], v[144:147], a[16:19]
    v_mfma_f32_16x16x32_bf16 a[20:23], v[172:175], v[144:147], a[20:23]
    buffer_load_dwordx4 v[132:135], v1, s[8:11], s25 offen offset:2048
    v_mfma_f32_16x16x32_bf16 a[24:27], v[176:179], v[144:147], a[24:27]
    v_mfma_f32_16x16x32_bf16 a[28:31], v[180:183], v[144:147], a[28:31]
    buffer_load_dwordx4 v[136:139], v1, s[8:11], s25 offen offset:3072
    s_waitcnt vmcnt(41)
    v_mfma_f32_16x16x32_bf16 a[32:35], v[168:171], v[148:151], a[32:35]
    v_mfma_f32_16x16x32_bf16 a[36:39], v[172:175], v[148:151], a[36:39]
    buffer_load_dwordx4 v[96:99], v1, s[8:11], s24 offen
    v_mfma_f32_16x16x32_bf16 a[40:43], v[176:179], v[148:151], a[40:43]
    v_mfma_f32_16x16x32_bf16 a[44:47], v[180:183], v[148:151], a[44:47]
    buffer_load_dwordx4 v[100:103], v1, s[8:11], s24 offen offset:1024
    s_waitcnt vmcnt(42)
    v_mfma_f32_16x16x32_bf16 a[48:51], v[168:171], v[152:155], a[48:51]
    v_mfma_f32_16x16x32_bf16 a[52:55], v[172:175], v[152:155], a[52:55]
    buffer_load_dwordx4 v[104:107], v1, s[8:11], s24 offen offset:2048
    v_mfma_f32_16x16x32_bf16 a[56:59], v[176:179], v[152:155], a[56:59]
    v_mfma_f32_16x16x32_bf16 a[60:63], v[180:183], v[152:155], a[60:63]
    buffer_load_dwordx4 v[108:111], v1, s[8:11], s24 offen offset:3072
    s_waitcnt vmcnt(43)
    v_mfma_f32_16x16x32_bf16 a[64:67], v[168:171], v[156:159], a[64:67]
    v_mfma_f32_16x16x32_bf16 a[68:71], v[172:175], v[156:159], a[68:71]
    buffer_load_dwordx4 v[112:115], v2, s[8:11], s24 offen
    v_mfma_f32_16x16x32_bf16 a[72:75], v[176:179], v[156:159], a[72:75]
    v_mfma_f32_16x16x32_bf16 a[76:79], v[180:183], v[156:159], a[76:79]
    buffer_load_dwordx4 v[116:119], v2, s[8:11], s24 offen offset:1024
    s_waitcnt vmcnt(44)
    v_mfma_f32_16x16x32_bf16 a[80:83], v[168:171], v[160:163], a[80:83]
    v_mfma_f32_16x16x32_bf16 a[84:87], v[172:175], v[160:163], a[84:87]
    buffer_load_dwordx4 v[120:123], v2, s[8:11], s24 offen offset:2048
    v_mfma_f32_16x16x32_bf16 a[88:91], v[176:179], v[160:163], a[88:91]
    v_mfma_f32_16x16x32_bf16 a[92:95], v[180:183], v[160:163], a[92:95]
    s_add_u32 s24, s24, 425984
    s_add_u32 s25, s25, 131072
    s_waitcnt vmcnt(44)
    v_mfma_f32_16x16x32_bf16 a[96:99], v[168:171], v[164:167], a[96:99]
    v_mfma_f32_16x16x32_bf16 a[100:103], v[172:175], v[164:167], a[100:103]
    v_mfma_f32_16x16x32_bf16 a[104:107], v[176:179], v[164:167], a[104:107]
    v_mfma_f32_16x16x32_bf16 a[108:111], v[180:183], v[164:167], a[108:111]
    s_waitcnt vmcnt(39)
    v_mfma_f32_16x16x32_bf16 a[0:3], v[212:215], v[184:187], a[0:3]
    v_mfma_f32_16x16x32_bf16 a[4:7], v[216:219], v[184:187], a[4:7]
    buffer_load_dwordx4 v[168:171], v1, s[8:11], s25 offen
    v_mfma_f32_16x16x32_bf16 a[8:11], v[220:223], v[184:187], a[8:11]
    v_mfma_f32_16x16x32_bf16 a[12:15], v[224:227], v[184:187], a[12:15]
    buffer_load_dwordx4 v[172:175], v1, s[8:11], s25 offen offset:1024
    s_waitcnt vmcnt(40)
    v_mfma_f32_16x16x32_bf16 a[16:19], v[212:215], v[188:191], a[16:19]
    v_mfma_f32_16x16x32_bf16 a[20:23], v[216:219], v[188:191], a[20:23]
    buffer_load_dwordx4 v[176:179], v1, s[8:11], s25 offen offset:2048
    v_mfma_f32_16x16x32_bf16 a[24:27], v[220:223], v[188:191], a[24:27]
    v_mfma_f32_16x16x32_bf16 a[28:31], v[224:227], v[188:191], a[28:31]
    buffer_load_dwordx4 v[180:183], v1, s[8:11], s25 offen offset:3072
    s_waitcnt vmcnt(41)
    v_mfma_f32_16x16x32_bf16 a[32:35], v[212:215], v[192:195], a[32:35]
    v_mfma_f32_16x16x32_bf16 a[36:39], v[216:219], v[192:195], a[36:39]
    buffer_load_dwordx4 v[140:143], v1, s[8:11], s24 offen
    v_mfma_f32_16x16x32_bf16 a[40:43], v[220:223], v[192:195], a[40:43]
    v_mfma_f32_16x16x32_bf16 a[44:47], v[224:227], v[192:195], a[44:47]
    buffer_load_dwordx4 v[144:147], v1, s[8:11], s24 offen offset:1024
    s_waitcnt vmcnt(42)
    v_mfma_f32_16x16x32_bf16 a[48:51], v[212:215], v[196:199], a[48:51]
    v_mfma_f32_16x16x32_bf16 a[52:55], v[216:219], v[196:199], a[52:55]
    buffer_load_dwordx4 v[148:151], v1, s[8:11], s24 offen offset:2048
    v_mfma_f32_16x16x32_bf16 a[56:59], v[220:223], v[196:199], a[56:59]
    v_mfma_f32_16x16x32_bf16 a[60:63], v[224:227], v[196:199], a[60:63]
    buffer_load_dwordx4 v[152:155], v1, s[8:11], s24 offen offset:3072
    s_waitcnt vmcnt(43)
    v_mfma_f32_16x16x32_bf16 a[64:67], v[212:215], v[200:203], a[64:67]
    v_mfma_f32_16x16x32_bf16 a[68:71], v[216:219], v[200:203], a[68:71]
    buffer_load_dwordx4 v[156:159], v2, s[8:11], s24 offen
    v_mfma_f32_16x16x32_bf16 a[72:75], v[220:223], v[200:203], a[72:75]
    v_mfma_f32_16x16x32_bf16 a[76:79], v[224:227], v[200:203], a[76:79]
    buffer_load_dwordx4 v[160:163], v2, s[8:11], s24 offen offset:1024
    s_waitcnt vmcnt(44)
    v_mfma_f32_16x16x32_bf16 a[80:83], v[212:215], v[204:207], a[80:83]
    v_mfma_f32_16x16x32_bf16 a[84:87], v[216:219], v[204:207], a[84:87]
    buffer_load_dwordx4 v[164:167], v2, s[8:11], s24 offen offset:2048
    v_mfma_f32_16x16x32_bf16 a[88:91], v[220:223], v[204:207], a[88:91]
    v_mfma_f32_16x16x32_bf16 a[92:95], v[224:227], v[204:207], a[92:95]
    s_add_u32 s24, s24, 425984
    s_add_u32 s25, s25, 131072
    s_waitcnt vmcnt(44)
    v_mfma_f32_16x16x32_bf16 a[96:99], v[212:215], v[208:211], a[96:99]
    v_mfma_f32_16x16x32_bf16 a[100:103], v[216:219], v[208:211], a[100:103]
    v_mfma_f32_16x16x32_bf16 a[104:107], v[220:223], v[208:211], a[104:107]
    v_mfma_f32_16x16x32_bf16 a[108:111], v[224:227], v[208:211], a[108:111]
    s_waitcnt vmcnt(39)
    v_mfma_f32_16x16x32_bf16 a[0:3], v[36:39], v[8:11], a[0:3]
    v_mfma_f32_16x16x32_bf16 a[4:7], v[40:43], v[8:11], a[4:7]
    buffer_load_dwordx4 v[212:215], v1, s[8:11], s25 offen
    v_mfma_f32_16x16x32_bf16 a[8:11], v[44:47], v[8:11], a[8:11]
    v_mfma_f32_16x16x32_bf16 a[12:15], v[48:51], v[8:11], a[12:15]
    buffer_load_dwordx4 v[216:219], v1, s[8:11], s25 offen offset:1024
    s_waitcnt vmcnt(40)
    v_mfma_f32_16x16x32_bf16 a[16:19], v[36:39], v[12:15], a[16:19]
    v_mfma_f32_16x16x32_bf16 a[20:23], v[40:43], v[12:15], a[20:23]
    buffer_load_dwordx4 v[220:223], v1, s[8:11], s25 offen offset:2048
    v_mfma_f32_16x16x32_bf16 a[24:27], v[44:47], v[12:15], a[24:27]
    v_mfma_f32_16x16x32_bf16 a[28:31], v[48:51], v[12:15], a[28:31]
    buffer_load_dwordx4 v[224:227], v1, s[8:11], s25 offen offset:3072
    s_waitcnt vmcnt(41)
    v_mfma_f32_16x16x32_bf16 a[32:35], v[36:39], v[16:19], a[32:35]
    v_mfma_f32_16x16x32_bf16 a[36:39], v[40:43], v[16:19], a[36:39]
    buffer_load_dwordx4 v[184:187], v1, s[8:11], s24 offen
    v_mfma_f32_16x16x32_bf16 a[40:43], v[44:47], v[16:19], a[40:43]
    v_mfma_f32_16x16x32_bf16 a[44:47], v[48:51], v[16:19], a[44:47]
    buffer_load_dwordx4 v[188:191], v1, s[8:11], s24 offen offset:1024
    s_waitcnt vmcnt(42)
    v_mfma_f32_16x16x32_bf16 a[48:51], v[36:39], v[20:23], a[48:51]
    v_mfma_f32_16x16x32_bf16 a[52:55], v[40:43], v[20:23], a[52:55]
    buffer_load_dwordx4 v[192:195], v1, s[8:11], s24 offen offset:2048
    v_mfma_f32_16x16x32_bf16 a[56:59], v[44:47], v[20:23], a[56:59]
    v_mfma_f32_16x16x32_bf16 a[60:63], v[48:51], v[20:23], a[60:63]
    buffer_load_dwordx4 v[196:199], v1, s[8:11], s24 offen offset:3072
    s_waitcnt vmcnt(43)
    v_mfma_f32_16x16x32_bf16 a[64:67], v[36:39], v[24:27], a[64:67]
    v_mfma_f32_16x16x32_bf16 a[68:71], v[40:43], v[24:27], a[68:71]
    buffer_load_dwordx4 v[200:203], v2, s[8:11], s24 offen
    v_mfma_f32_16x16x32_bf16 a[72:75], v[44:47], v[24:27], a[72:75]
    v_mfma_f32_16x16x32_bf16 a[76:79], v[48:51], v[24:27], a[76:79]
    buffer_load_dwordx4 v[204:207], v2, s[8:11], s24 offen offset:1024
    s_waitcnt vmcnt(44)
    v_mfma_f32_16x16x32_bf16 a[80:83], v[36:39], v[28:31], a[80:83]
    v_mfma_f32_16x16x32_bf16 a[84:87], v[40:43], v[28:31], a[84:87]
    buffer_load_dwordx4 v[208:211], v2, s[8:11], s24 offen offset:2048
    v_mfma_f32_16x16x32_bf16 a[88:91], v[44:47], v[28:31], a[88:91]
    v_mfma_f32_16x16x32_bf16 a[92:95], v[48:51], v[28:31], a[92:95]
    s_add_u32 s24, s24, 425984
    s_add_u32 s25, s25, 131072
    s_waitcnt vmcnt(44)
    v_mfma_f32_16x16x32_bf16 a[96:99], v[36:39], v[32:35], a[96:99]
    v_mfma_f32_16x16x32_bf16 a[100:103], v[40:43], v[32:35], a[100:103]
    v_mfma_f32_16x16x32_bf16 a[104:107], v[44:47], v[32:35], a[104:107]
    v_mfma_f32_16x16x32_bf16 a[108:111], v[48:51], v[32:35], a[108:111]
    s_waitcnt vmcnt(39)
    v_mfma_f32_16x16x32_bf16 a[0:3], v[80:83], v[52:55], a[0:3]
    v_mfma_f32_16x16x32_bf16 a[4:7], v[84:87], v[52:55], a[4:7]
    buffer_load_dwordx4 v[36:39], v1, s[8:11], s25 offen
    v_mfma_f32_16x16x32_bf16 a[8:11], v[88:91], v[52:55], a[8:11]
    v_mfma_f32_16x16x32_bf16 a[12:15], v[92:95], v[52:55], a[12:15]
    buffer_load_dwordx4 v[40:43], v1, s[8:11], s25 offen offset:1024
    s_waitcnt vmcnt(40)
    v_mfma_f32_16x16x32_bf16 a[16:19], v[80:83], v[56:59], a[16:19]
    v_mfma_f32_16x16x32_bf16 a[20:23], v[84:87], v[56:59], a[20:23]
    buffer_load_dwordx4 v[44:47], v1, s[8:11], s25 offen offset:2048
    v_mfma_f32_16x16x32_bf16 a[24:27], v[88:91], v[56:59], a[24:27]
    v_mfma_f32_16x16x32_bf16 a[28:31], v[92:95], v[56:59], a[28:31]
    buffer_load_dwordx4 v[48:51], v1, s[8:11], s25 offen offset:3072
    s_waitcnt vmcnt(41)
    v_mfma_f32_16x16x32_bf16 a[32:35], v[80:83], v[60:63], a[32:35]
    v_mfma_f32_16x16x32_bf16 a[36:39], v[84:87], v[60:63], a[36:39]
    buffer_load_dwordx4 v[8:11], v1, s[8:11], s24 offen
    v_mfma_f32_16x16x32_bf16 a[40:43], v[88:91], v[60:63], a[40:43]
    v_mfma_f32_16x16x32_bf16 a[44:47], v[92:95], v[60:63], a[44:47]
    buffer_load_dwordx4 v[12:15], v1, s[8:11], s24 offen offset:1024
    s_waitcnt vmcnt(42)
    v_mfma_f32_16x16x32_bf16 a[48:51], v[80:83], v[64:67], a[48:51]
    v_mfma_f32_16x16x32_bf16 a[52:55], v[84:87], v[64:67], a[52:55]
    buffer_load_dwordx4 v[16:19], v1, s[8:11], s24 offen offset:2048
    v_mfma_f32_16x16x32_bf16 a[56:59], v[88:91], v[64:67], a[56:59]
    v_mfma_f32_16x16x32_bf16 a[60:63], v[92:95], v[64:67], a[60:63]
    buffer_load_dwordx4 v[20:23], v1, s[8:11], s24 offen offset:3072
    s_waitcnt vmcnt(43)
    v_mfma_f32_16x16x32_bf16 a[64:67], v[80:83], v[68:71], a[64:67]
    v_mfma_f32_16x16x32_bf16 a[68:71], v[84:87], v[68:71], a[68:71]
    buffer_load_dwordx4 v[24:27], v2, s[8:11], s24 offen
    v_mfma_f32_16x16x32_bf16 a[72:75], v[88:91], v[68:71], a[72:75]
    v_mfma_f32_16x16x32_bf16 a[76:79], v[92:95], v[68:71], a[76:79]
    buffer_load_dwordx4 v[28:31], v2, s[8:11], s24 offen offset:1024
    s_waitcnt vmcnt(44)
    v_mfma_f32_16x16x32_bf16 a[80:83], v[80:83], v[72:75], a[80:83]
    v_mfma_f32_16x16x32_bf16 a[84:87], v[84:87], v[72:75], a[84:87]
    buffer_load_dwordx4 v[32:35], v2, s[8:11], s24 offen offset:2048
    v_mfma_f32_16x16x32_bf16 a[88:91], v[88:91], v[72:75], a[88:91]
    v_mfma_f32_16x16x32_bf16 a[92:95], v[92:95], v[72:75], a[92:95]
    s_add_u32 s24, s24, 425984
    s_add_u32 s25, s25, 131072
    s_waitcnt vmcnt(44)
    v_mfma_f32_16x16x32_bf16 a[96:99], v[80:83], v[76:79], a[96:99]
    v_mfma_f32_16x16x32_bf16 a[100:103], v[84:87], v[76:79], a[100:103]
    v_mfma_f32_16x16x32_bf16 a[104:107], v[88:91], v[76:79], a[104:107]
    v_mfma_f32_16x16x32_bf16 a[108:111], v[92:95], v[76:79], a[108:111]
    s_waitcnt vmcnt(39)
    v_mfma_f32_16x16x32_bf16 a[0:3], v[124:127], v[96:99], a[0:3]
    v_mfma_f32_16x16x32_bf16 a[4:7], v[128:131], v[96:99], a[4:7]
    buffer_load_dwordx4 v[80:83], v1, s[8:11], s25 offen
    v_mfma_f32_16x16x32_bf16 a[8:11], v[132:135], v[96:99], a[8:11]
    v_mfma_f32_16x16x32_bf16 a[12:15], v[136:139], v[96:99], a[12:15]
    buffer_load_dwordx4 v[84:87], v1, s[8:11], s25 offen offset:1024
    s_waitcnt vmcnt(40)
    v_mfma_f32_16x16x32_bf16 a[16:19], v[124:127], v[100:103], a[16:19]
    v_mfma_f32_16x16x32_bf16 a[20:23], v[128:131], v[100:103], a[20:23]
    buffer_load_dwordx4 v[88:91], v1, s[8:11], s25 offen offset:2048
    v_mfma_f32_16x16x32_bf16 a[24:27], v[132:135], v[100:103], a[24:27]
    v_mfma_f32_16x16x32_bf16 a[28:31], v[136:139], v[100:103], a[28:31]
    buffer_load_dwordx4 v[92:95], v1, s[8:11], s25 offen offset:3072
    s_waitcnt vmcnt(41)
    v_mfma_f32_16x16x32_bf16 a[32:35], v[124:127], v[104:107], a[32:35]
    v_mfma_f32_16x16x32_bf16 a[36:39], v[128:131], v[104:107], a[36:39]
    buffer_load_dwordx4 v[52:55], v1, s[8:11], s24 offen
    v_mfma_f32_16x16x32_bf16 a[40:43], v[132:135], v[104:107], a[40:43]
    v_mfma_f32_16x16x32_bf16 a[44:47], v[136:139], v[104:107], a[44:47]
    buffer_load_dwordx4 v[56:59], v1, s[8:11], s24 offen offset:1024
    s_waitcnt vmcnt(42)
    v_mfma_f32_16x16x32_bf16 a[48:51], v[124:127], v[108:111], a[48:51]
    v_mfma_f32_16x16x32_bf16 a[52:55], v[128:131], v[108:111], a[52:55]
    buffer_load_dwordx4 v[60:63], v1, s[8:11], s24 offen offset:2048
    v_mfma_f32_16x16x32_bf16 a[56:59], v[132:135], v[108:111], a[56:59]
    v_mfma_f32_16x16x32_bf16 a[60:63], v[136:139], v[108:111], a[60:63]
    buffer_load_dwordx4 v[64:67], v1, s[8:11], s24 offen offset:3072
    s_waitcnt vmcnt(43)
    v_mfma_f32_16x16x32_bf16 a[64:67], v[124:127], v[112:115], a[64:67]
    v_mfma_f32_16x16x32_bf16 a[68:71], v[128:131], v[112:115], a[68:71]
    buffer_load_dwordx4 v[68:71], v2, s[8:11], s24 offen
    v_mfma_f32_16x16x32_bf16 a[72:75], v[132:135], v[112:115], a[72:75]
    v_mfma_f32_16x16x32_bf16 a[76:79], v[136:139], v[112:115], a[76:79]
    buffer_load_dwordx4 v[72:75], v2, s[8:11], s24 offen offset:1024
    s_waitcnt vmcnt(44)
    v_mfma_f32_16x16x32_bf16 a[80:83], v[124:127], v[116:119], a[80:83]
    v_mfma_f32_16x16x32_bf16 a[84:87], v[128:131], v[116:119], a[84:87]
    buffer_load_dwordx4 v[76:79], v2, s[8:11], s24 offen offset:2048
    v_mfma_f32_16x16x32_bf16 a[88:91], v[132:135], v[116:119], a[88:91]
    v_mfma_f32_16x16x32_bf16 a[92:95], v[136:139], v[116:119], a[92:95]
    s_add_u32 s24, s24, 425984
    s_add_u32 s25, s25, 131072
    s_waitcnt vmcnt(44)
    v_mfma_f32_16x16x32_bf16 a[96:99], v[124:127], v[120:123], a[96:99]
    v_mfma_f32_16x16x32_bf16 a[100:103], v[128:131], v[120:123], a[100:103]
    v_mfma_f32_16x16x32_bf16 a[104:107], v[132:135], v[120:123], a[104:107]
    v_mfma_f32_16x16x32_bf16 a[108:111], v[136:139], v[120:123], a[108:111]
    s_waitcnt vmcnt(39)
    v_mfma_f32_16x16x32_bf16 a[0:3], v[168:171], v[140:143], a[0:3]
    v_mfma_f32_16x16x32_bf16 a[4:7], v[172:175], v[140:143], a[4:7]
    buffer_load_dwordx4 v[124:127], v1, s[8:11], s25 offen
    v_mfma_f32_16x16x32_bf16 a[8:11], v[176:179], v[140:143], a[8:11]
    v_mfma_f32_16x16x32_bf16 a[12:15], v[180:183], v[140:143], a[12:15]
    buffer_load_dwordx4 v[128:131], v1, s[8:11], s25 offen offset:1024
    s_waitcnt vmcnt(40)
    v_mfma_f32_16x16x32_bf16 a[16:19], v[168:171], v[144:147], a[16:19]
    v_mfma_f32_16x16x32_bf16 a[20:23], v[172:175], v[144:147], a[20:23]
    buffer_load_dwordx4 v[132:135], v1, s[8:11], s25 offen offset:2048
    v_mfma_f32_16x16x32_bf16 a[24:27], v[176:179], v[144:147], a[24:27]
    v_mfma_f32_16x16x32_bf16 a[28:31], v[180:183], v[144:147], a[28:31]
    buffer_load_dwordx4 v[136:139], v1, s[8:11], s25 offen offset:3072
    s_waitcnt vmcnt(41)
    v_mfma_f32_16x16x32_bf16 a[32:35], v[168:171], v[148:151], a[32:35]
    v_mfma_f32_16x16x32_bf16 a[36:39], v[172:175], v[148:151], a[36:39]
    buffer_load_dwordx4 v[96:99], v1, s[8:11], s24 offen
    v_mfma_f32_16x16x32_bf16 a[40:43], v[176:179], v[148:151], a[40:43]
    v_mfma_f32_16x16x32_bf16 a[44:47], v[180:183], v[148:151], a[44:47]
    buffer_load_dwordx4 v[100:103], v1, s[8:11], s24 offen offset:1024
    s_waitcnt vmcnt(42)
    v_mfma_f32_16x16x32_bf16 a[48:51], v[168:171], v[152:155], a[48:51]
    v_mfma_f32_16x16x32_bf16 a[52:55], v[172:175], v[152:155], a[52:55]
    buffer_load_dwordx4 v[104:107], v1, s[8:11], s24 offen offset:2048
    v_mfma_f32_16x16x32_bf16 a[56:59], v[176:179], v[152:155], a[56:59]
    v_mfma_f32_16x16x32_bf16 a[60:63], v[180:183], v[152:155], a[60:63]
    buffer_load_dwordx4 v[108:111], v1, s[8:11], s24 offen offset:3072
    s_waitcnt vmcnt(43)
    v_mfma_f32_16x16x32_bf16 a[64:67], v[168:171], v[156:159], a[64:67]
    v_mfma_f32_16x16x32_bf16 a[68:71], v[172:175], v[156:159], a[68:71]
    buffer_load_dwordx4 v[112:115], v2, s[8:11], s24 offen
    v_mfma_f32_16x16x32_bf16 a[72:75], v[176:179], v[156:159], a[72:75]
    v_mfma_f32_16x16x32_bf16 a[76:79], v[180:183], v[156:159], a[76:79]
    buffer_load_dwordx4 v[116:119], v2, s[8:11], s24 offen offset:1024
    s_waitcnt vmcnt(44)
    v_mfma_f32_16x16x32_bf16 a[80:83], v[168:171], v[160:163], a[80:83]
    v_mfma_f32_16x16x32_bf16 a[84:87], v[172:175], v[160:163], a[84:87]
    buffer_load_dwordx4 v[120:123], v2, s[8:11], s24 offen offset:2048
    v_mfma_f32_16x16x32_bf16 a[88:91], v[176:179], v[160:163], a[88:91]
    v_mfma_f32_16x16x32_bf16 a[92:95], v[180:183], v[160:163], a[92:95]
    s_add_u32 s24, s24, 425984
    s_add_u32 s25, s25, 131072
    s_waitcnt vmcnt(44)
    v_mfma_f32_16x16x32_bf16 a[96:99], v[168:171], v[164:167], a[96:99]
    v_mfma_f32_16x16x32_bf16 a[100:103], v[172:175], v[164:167], a[100:103]
    v_mfma_f32_16x16x32_bf16 a[104:107], v[176:179], v[164:167], a[104:107]
    v_mfma_f32_16x16x32_bf16 a[108:111], v[180:183], v[164:167], a[108:111]
    s_waitcnt vmcnt(39)
    v_mfma_f32_16x16x32_bf16 a[0:3], v[212:215], v[184:187], a[0:3]
    v_mfma_f32_16x16x32_bf16 a[4:7], v[216:219], v[184:187], a[4:7]
    buffer_load_dwordx4 v[168:171], v1, s[8:11], s25 offen
    v_mfma_f32_16x16x32_bf16 a[8:11], v[220:223], v[184:187], a[8:11]
    v_mfma_f32_16x16x32_bf16 a[12:15], v[224:227], v[184:187], a[12:15]
    buffer_load_dwordx4 v[172:175], v1, s[8:11], s25 offen offset:1024
    s_waitcnt vmcnt(40)
    v_mfma_f32_16x16x32_bf16 a[16:19], v[212:215], v[188:191], a[16:19]
    v_mfma_f32_16x16x32_bf16 a[20:23], v[216:219], v[188:191], a[20:23]
    buffer_load_dwordx4 v[176:179], v1, s[8:11], s25 offen offset:2048
    v_mfma_f32_16x16x32_bf16 a[24:27], v[220:223], v[188:191], a[24:27]
    v_mfma_f32_16x16x32_bf16 a[28:31], v[224:227], v[188:191], a[28:31]
    buffer_load_dwordx4 v[180:183], v1, s[8:11], s25 offen offset:3072
    s_waitcnt vmcnt(41)
    v_mfma_f32_16x16x32_bf16 a[32:35], v[212:215], v[192:195], a[32:35]
    v_mfma_f32_16x16x32_bf16 a[36:39], v[216:219], v[192:195], a[36:39]
    buffer_load_dwordx4 v[140:143], v1, s[8:11], s24 offen
    v_mfma_f32_16x16x32_bf16 a[40:43], v[220:223], v[192:195], a[40:43]
    v_mfma_f32_16x16x32_bf16 a[44:47], v[224:227], v[192:195], a[44:47]
    buffer_load_dwordx4 v[144:147], v1, s[8:11], s24 offen offset:1024
    s_waitcnt vmcnt(42)
    v_mfma_f32_16x16x32_bf16 a[48:51], v[212:215], v[196:199], a[48:51]
    v_mfma_f32_16x16x32_bf16 a[52:55], v[216:219], v[196:199], a[52:55]
    buffer_load_dwordx4 v[148:151], v1, s[8:11], s24 offen offset:2048
    v_mfma_f32_16x16x32_bf16 a[56:59], v[220:223], v[196:199], a[56:59]
    v_mfma_f32_16x16x32_bf16 a[60:63], v[224:227], v[196:199], a[60:63]
    buffer_load_dwordx4 v[152:155], v1, s[8:11], s24 offen offset:3072
    s_waitcnt vmcnt(43)
    v_mfma_f32_16x16x32_bf16 a[64:67], v[212:215], v[200:203], a[64:67]
    v_mfma_f32_16x16x32_bf16 a[68:71], v[216:219], v[200:203], a[68:71]
    buffer_load_dwordx4 v[156:159], v2, s[8:11], s24 offen
    v_mfma_f32_16x16x32_bf16 a[72:75], v[220:223], v[200:203], a[72:75]
    v_mfma_f32_16x16x32_bf16 a[76:79], v[224:227], v[200:203], a[76:79]
    buffer_load_dwordx4 v[160:163], v2, s[8:11], s24 offen offset:1024
    s_waitcnt vmcnt(44)
    v_mfma_f32_16x16x32_bf16 a[80:83], v[212:215], v[204:207], a[80:83]
    v_mfma_f32_16x16x32_bf16 a[84:87], v[216:219], v[204:207], a[84:87]
    buffer_load_dwordx4 v[164:167], v2, s[8:11], s24 offen offset:2048
    v_mfma_f32_16x16x32_bf16 a[88:91], v[220:223], v[204:207], a[88:91]
    v_mfma_f32_16x16x32_bf16 a[92:95], v[224:227], v[204:207], a[92:95]
    s_add_u32 s24, s24, 425984
    s_add_u32 s25, s25, 131072
    s_waitcnt vmcnt(44)
    v_mfma_f32_16x16x32_bf16 a[96:99], v[212:215], v[208:211], a[96:99]
    v_mfma_f32_16x16x32_bf16 a[100:103], v[216:219], v[208:211], a[100:103]
    v_mfma_f32_16x16x32_bf16 a[104:107], v[220:223], v[208:211], a[104:107]
    v_mfma_f32_16x16x32_bf16 a[108:111], v[224:227], v[208:211], a[108:111]
    s_waitcnt vmcnt(39)
    v_mfma_f32_16x16x32_bf16 a[0:3], v[36:39], v[8:11], a[0:3]
    v_mfma_f32_16x16x32_bf16 a[4:7], v[40:43], v[8:11], a[4:7]
    buffer_load_dwordx4 v[212:215], v1, s[8:11], s25 offen
    v_mfma_f32_16x16x32_bf16 a[8:11], v[44:47], v[8:11], a[8:11]
    v_mfma_f32_16x16x32_bf16 a[12:15], v[48:51], v[8:11], a[12:15]
    buffer_load_dwordx4 v[216:219], v1, s[8:11], s25 offen offset:1024
    s_waitcnt vmcnt(40)
    v_mfma_f32_16x16x32_bf16 a[16:19], v[36:39], v[12:15], a[16:19]
    v_mfma_f32_16x16x32_bf16 a[20:23], v[40:43], v[12:15], a[20:23]
    buffer_load_dwordx4 v[220:223], v1, s[8:11], s25 offen offset:2048
    v_mfma_f32_16x16x32_bf16 a[24:27], v[44:47], v[12:15], a[24:27]
    v_mfma_f32_16x16x32_bf16 a[28:31], v[48:51], v[12:15], a[28:31]
    buffer_load_dwordx4 v[224:227], v1, s[8:11], s25 offen offset:3072
    s_waitcnt vmcnt(41)
    v_mfma_f32_16x16x32_bf16 a[32:35], v[36:39], v[16:19], a[32:35]
    v_mfma_f32_16x16x32_bf16 a[36:39], v[40:43], v[16:19], a[36:39]
    buffer_load_dwordx4 v[184:187], v1, s[8:11], s24 offen
    v_mfma_f32_16x16x32_bf16 a[40:43], v[44:47], v[16:19], a[40:43]
    v_mfma_f32_16x16x32_bf16 a[44:47], v[48:51], v[16:19], a[44:47]
    buffer_load_dwordx4 v[188:191], v1, s[8:11], s24 offen offset:1024
    s_waitcnt vmcnt(42)
    v_mfma_f32_16x16x32_bf16 a[48:51], v[36:39], v[20:23], a[48:51]
    v_mfma_f32_16x16x32_bf16 a[52:55], v[40:43], v[20:23], a[52:55]
    buffer_load_dwordx4 v[192:195], v1, s[8:11], s24 offen offset:2048
    v_mfma_f32_16x16x32_bf16 a[56:59], v[44:47], v[20:23], a[56:59]
    v_mfma_f32_16x16x32_bf16 a[60:63], v[48:51], v[20:23], a[60:63]
    buffer_load_dwordx4 v[196:199], v1, s[8:11], s24 offen offset:3072
    s_waitcnt vmcnt(43)
    v_mfma_f32_16x16x32_bf16 a[64:67], v[36:39], v[24:27], a[64:67]
    v_mfma_f32_16x16x32_bf16 a[68:71], v[40:43], v[24:27], a[68:71]
    buffer_load_dwordx4 v[200:203], v2, s[8:11], s24 offen
    v_mfma_f32_16x16x32_bf16 a[72:75], v[44:47], v[24:27], a[72:75]
    v_mfma_f32_16x16x32_bf16 a[76:79], v[48:51], v[24:27], a[76:79]
    buffer_load_dwordx4 v[204:207], v2, s[8:11], s24 offen offset:1024
    s_waitcnt vmcnt(44)
    v_mfma_f32_16x16x32_bf16 a[80:83], v[36:39], v[28:31], a[80:83]
    v_mfma_f32_16x16x32_bf16 a[84:87], v[40:43], v[28:31], a[84:87]
    buffer_load_dwordx4 v[208:211], v2, s[8:11], s24 offen offset:2048
    v_mfma_f32_16x16x32_bf16 a[88:91], v[44:47], v[28:31], a[88:91]
    v_mfma_f32_16x16x32_bf16 a[92:95], v[48:51], v[28:31], a[92:95]
    s_add_u32 s24, s24, 425984
    s_add_u32 s25, s25, 131072
    s_waitcnt vmcnt(44)
    v_mfma_f32_16x16x32_bf16 a[96:99], v[36:39], v[32:35], a[96:99]
    v_mfma_f32_16x16x32_bf16 a[100:103], v[40:43], v[32:35], a[100:103]
    v_mfma_f32_16x16x32_bf16 a[104:107], v[44:47], v[32:35], a[104:107]
    v_mfma_f32_16x16x32_bf16 a[108:111], v[48:51], v[32:35], a[108:111]
    s_waitcnt vmcnt(39)
    v_mfma_f32_16x16x32_bf16 a[0:3], v[80:83], v[52:55], a[0:3]
    v_mfma_f32_16x16x32_bf16 a[4:7], v[84:87], v[52:55], a[4:7]
    buffer_load_dwordx4 v[36:39], v1, s[8:11], s25 offen
    v_mfma_f32_16x16x32_bf16 a[8:11], v[88:91], v[52:55], a[8:11]
    v_mfma_f32_16x16x32_bf16 a[12:15], v[92:95], v[52:55], a[12:15]
    buffer_load_dwordx4 v[40:43], v1, s[8:11], s25 offen offset:1024
    s_waitcnt vmcnt(40)
    v_mfma_f32_16x16x32_bf16 a[16:19], v[80:83], v[56:59], a[16:19]
    v_mfma_f32_16x16x32_bf16 a[20:23], v[84:87], v[56:59], a[20:23]
    buffer_load_dwordx4 v[44:47], v1, s[8:11], s25 offen offset:2048
    v_mfma_f32_16x16x32_bf16 a[24:27], v[88:91], v[56:59], a[24:27]
    v_mfma_f32_16x16x32_bf16 a[28:31], v[92:95], v[56:59], a[28:31]
    buffer_load_dwordx4 v[48:51], v1, s[8:11], s25 offen offset:3072
    s_waitcnt vmcnt(41)
    v_mfma_f32_16x16x32_bf16 a[32:35], v[80:83], v[60:63], a[32:35]
    v_mfma_f32_16x16x32_bf16 a[36:39], v[84:87], v[60:63], a[36:39]
    buffer_load_dwordx4 v[8:11], v1, s[8:11], s24 offen
    v_mfma_f32_16x16x32_bf16 a[40:43], v[88:91], v[60:63], a[40:43]
    v_mfma_f32_16x16x32_bf16 a[44:47], v[92:95], v[60:63], a[44:47]
    buffer_load_dwordx4 v[12:15], v1, s[8:11], s24 offen offset:1024
    s_waitcnt vmcnt(42)
    v_mfma_f32_16x16x32_bf16 a[48:51], v[80:83], v[64:67], a[48:51]
    v_mfma_f32_16x16x32_bf16 a[52:55], v[84:87], v[64:67], a[52:55]
    buffer_load_dwordx4 v[16:19], v1, s[8:11], s24 offen offset:2048
    v_mfma_f32_16x16x32_bf16 a[56:59], v[88:91], v[64:67], a[56:59]
    v_mfma_f32_16x16x32_bf16 a[60:63], v[92:95], v[64:67], a[60:63]
    buffer_load_dwordx4 v[20:23], v1, s[8:11], s24 offen offset:3072
    s_waitcnt vmcnt(43)
    v_mfma_f32_16x16x32_bf16 a[64:67], v[80:83], v[68:71], a[64:67]
    v_mfma_f32_16x16x32_bf16 a[68:71], v[84:87], v[68:71], a[68:71]
    buffer_load_dwordx4 v[24:27], v2, s[8:11], s24 offen
    v_mfma_f32_16x16x32_bf16 a[72:75], v[88:91], v[68:71], a[72:75]
    v_mfma_f32_16x16x32_bf16 a[76:79], v[92:95], v[68:71], a[76:79]
    buffer_load_dwordx4 v[28:31], v2, s[8:11], s24 offen offset:1024
    s_waitcnt vmcnt(44)
    v_mfma_f32_16x16x32_bf16 a[80:83], v[80:83], v[72:75], a[80:83]
    v_mfma_f32_16x16x32_bf16 a[84:87], v[84:87], v[72:75], a[84:87]
    buffer_load_dwordx4 v[32:35], v2, s[8:11], s24 offen offset:2048
    v_mfma_f32_16x16x32_bf16 a[88:91], v[88:91], v[72:75], a[88:91]
    v_mfma_f32_16x16x32_bf16 a[92:95], v[92:95], v[72:75], a[92:95]
    s_add_u32 s24, s24, 425984
    s_add_u32 s25, s25, 131072
    s_waitcnt vmcnt(44)
    v_mfma_f32_16x16x32_bf16 a[96:99], v[80:83], v[76:79], a[96:99]
    v_mfma_f32_16x16x32_bf16 a[100:103], v[84:87], v[76:79], a[100:103]
    v_mfma_f32_16x16x32_bf16 a[104:107], v[88:91], v[76:79], a[104:107]
    v_mfma_f32_16x16x32_bf16 a[108:111], v[92:95], v[76:79], a[108:111]
    s_waitcnt vmcnt(39)
    v_mfma_f32_16x16x32_bf16 a[0:3], v[124:127], v[96:99], a[0:3]
    v_mfma_f32_16x16x32_bf16 a[4:7], v[128:131], v[96:99], a[4:7]
    buffer_load_dwordx4 v[80:83], v1, s[8:11], s25 offen
    v_mfma_f32_16x16x32_bf16 a[8:11], v[132:135], v[96:99], a[8:11]
    v_mfma_f32_16x16x32_bf16 a[12:15], v[136:139], v[96:99], a[12:15]
    buffer_load_dwordx4 v[84:87], v1, s[8:11], s25 offen offset:1024
    s_waitcnt vmcnt(40)
    v_mfma_f32_16x16x32_bf16 a[16:19], v[124:127], v[100:103], a[16:19]
    v_mfma_f32_16x16x32_bf16 a[20:23], v[128:131], v[100:103], a[20:23]
    buffer_load_dwordx4 v[88:91], v1, s[8:11], s25 offen offset:2048
    v_mfma_f32_16x16x32_bf16 a[24:27], v[132:135], v[100:103], a[24:27]
    v_mfma_f32_16x16x32_bf16 a[28:31], v[136:139], v[100:103], a[28:31]
    buffer_load_dwordx4 v[92:95], v1, s[8:11], s25 offen offset:3072
    s_waitcnt vmcnt(41)
    v_mfma_f32_16x16x32_bf16 a[32:35], v[124:127], v[104:107], a[32:35]
    v_mfma_f32_16x16x32_bf16 a[36:39], v[128:131], v[104:107], a[36:39]
    buffer_load_dwordx4 v[52:55], v1, s[8:11], s24 offen
    v_mfma_f32_16x16x32_bf16 a[40:43], v[132:135], v[104:107], a[40:43]
    v_mfma_f32_16x16x32_bf16 a[44:47], v[136:139], v[104:107], a[44:47]
    buffer_load_dwordx4 v[56:59], v1, s[8:11], s24 offen offset:1024
    s_waitcnt vmcnt(42)
    v_mfma_f32_16x16x32_bf16 a[48:51], v[124:127], v[108:111], a[48:51]
    v_mfma_f32_16x16x32_bf16 a[52:55], v[128:131], v[108:111], a[52:55]
    buffer_load_dwordx4 v[60:63], v1, s[8:11], s24 offen offset:2048
    v_mfma_f32_16x16x32_bf16 a[56:59], v[132:135], v[108:111], a[56:59]
    v_mfma_f32_16x16x32_bf16 a[60:63], v[136:139], v[108:111], a[60:63]
    buffer_load_dwordx4 v[64:67], v1, s[8:11], s24 offen offset:3072
    s_waitcnt vmcnt(43)
    v_mfma_f32_16x16x32_bf16 a[64:67], v[124:127], v[112:115], a[64:67]
    v_mfma_f32_16x16x32_bf16 a[68:71], v[128:131], v[112:115], a[68:71]
    buffer_load_dwordx4 v[68:71], v2, s[8:11], s24 offen
    v_mfma_f32_16x16x32_bf16 a[72:75], v[132:135], v[112:115], a[72:75]
    v_mfma_f32_16x16x32_bf16 a[76:79], v[136:139], v[112:115], a[76:79]
    buffer_load_dwordx4 v[72:75], v2, s[8:11], s24 offen offset:1024
    s_waitcnt vmcnt(44)
    v_mfma_f32_16x16x32_bf16 a[80:83], v[124:127], v[116:119], a[80:83]
    v_mfma_f32_16x16x32_bf16 a[84:87], v[128:131], v[116:119], a[84:87]
    buffer_load_dwordx4 v[76:79], v2, s[8:11], s24 offen offset:2048
    v_mfma_f32_16x16x32_bf16 a[88:91], v[132:135], v[116:119], a[88:91]
    v_mfma_f32_16x16x32_bf16 a[92:95], v[136:139], v[116:119], a[92:95]
    s_add_u32 s24, s24, 425984
    s_add_u32 s25, s25, 131072
    s_waitcnt vmcnt(44)
    v_mfma_f32_16x16x32_bf16 a[96:99], v[124:127], v[120:123], a[96:99]
    v_mfma_f32_16x16x32_bf16 a[100:103], v[128:131], v[120:123], a[100:103]
    v_mfma_f32_16x16x32_bf16 a[104:107], v[132:135], v[120:123], a[104:107]
    v_mfma_f32_16x16x32_bf16 a[108:111], v[136:139], v[120:123], a[108:111]
    s_waitcnt vmcnt(39)
    v_mfma_f32_16x16x32_bf16 a[0:3], v[168:171], v[140:143], a[0:3]
    v_mfma_f32_16x16x32_bf16 a[4:7], v[172:175], v[140:143], a[4:7]
    buffer_load_dwordx4 v[124:127], v1, s[8:11], s25 offen
    v_mfma_f32_16x16x32_bf16 a[8:11], v[176:179], v[140:143], a[8:11]
    v_mfma_f32_16x16x32_bf16 a[12:15], v[180:183], v[140:143], a[12:15]
    buffer_load_dwordx4 v[128:131], v1, s[8:11], s25 offen offset:1024
    s_waitcnt vmcnt(40)
    v_mfma_f32_16x16x32_bf16 a[16:19], v[168:171], v[144:147], a[16:19]
    v_mfma_f32_16x16x32_bf16 a[20:23], v[172:175], v[144:147], a[20:23]
    buffer_load_dwordx4 v[132:135], v1, s[8:11], s25 offen offset:2048
    v_mfma_f32_16x16x32_bf16 a[24:27], v[176:179], v[144:147], a[24:27]
    v_mfma_f32_16x16x32_bf16 a[28:31], v[180:183], v[144:147], a[28:31]
    buffer_load_dwordx4 v[136:139], v1, s[8:11], s25 offen offset:3072
    s_waitcnt vmcnt(41)
    v_mfma_f32_16x16x32_bf16 a[32:35], v[168:171], v[148:151], a[32:35]
    v_mfma_f32_16x16x32_bf16 a[36:39], v[172:175], v[148:151], a[36:39]
    buffer_load_dwordx4 v[96:99], v1, s[8:11], s24 offen
    v_mfma_f32_16x16x32_bf16 a[40:43], v[176:179], v[148:151], a[40:43]
    v_mfma_f32_16x16x32_bf16 a[44:47], v[180:183], v[148:151], a[44:47]
    buffer_load_dwordx4 v[100:103], v1, s[8:11], s24 offen offset:1024
    s_waitcnt vmcnt(42)
    v_mfma_f32_16x16x32_bf16 a[48:51], v[168:171], v[152:155], a[48:51]
    v_mfma_f32_16x16x32_bf16 a[52:55], v[172:175], v[152:155], a[52:55]
    buffer_load_dwordx4 v[104:107], v1, s[8:11], s24 offen offset:2048
    v_mfma_f32_16x16x32_bf16 a[56:59], v[176:179], v[152:155], a[56:59]
    v_mfma_f32_16x16x32_bf16 a[60:63], v[180:183], v[152:155], a[60:63]
    buffer_load_dwordx4 v[108:111], v1, s[8:11], s24 offen offset:3072
    s_waitcnt vmcnt(43)
    v_mfma_f32_16x16x32_bf16 a[64:67], v[168:171], v[156:159], a[64:67]
    v_mfma_f32_16x16x32_bf16 a[68:71], v[172:175], v[156:159], a[68:71]
    buffer_load_dwordx4 v[112:115], v2, s[8:11], s24 offen
    v_mfma_f32_16x16x32_bf16 a[72:75], v[176:179], v[156:159], a[72:75]
    v_mfma_f32_16x16x32_bf16 a[76:79], v[180:183], v[156:159], a[76:79]
    buffer_load_dwordx4 v[116:119], v2, s[8:11], s24 offen offset:1024
    s_waitcnt vmcnt(44)
    v_mfma_f32_16x16x32_bf16 a[80:83], v[168:171], v[160:163], a[80:83]
    v_mfma_f32_16x16x32_bf16 a[84:87], v[172:175], v[160:163], a[84:87]
    buffer_load_dwordx4 v[120:123], v2, s[8:11], s24 offen offset:2048
    v_mfma_f32_16x16x32_bf16 a[88:91], v[176:179], v[160:163], a[88:91]
    v_mfma_f32_16x16x32_bf16 a[92:95], v[180:183], v[160:163], a[92:95]
    s_add_u32 s24, s24, 425984
    s_add_u32 s25, s25, 131072
    s_waitcnt vmcnt(44)
    v_mfma_f32_16x16x32_bf16 a[96:99], v[168:171], v[164:167], a[96:99]
    v_mfma_f32_16x16x32_bf16 a[100:103], v[172:175], v[164:167], a[100:103]
    v_mfma_f32_16x16x32_bf16 a[104:107], v[176:179], v[164:167], a[104:107]
    v_mfma_f32_16x16x32_bf16 a[108:111], v[180:183], v[164:167], a[108:111]
    s_waitcnt vmcnt(39)
    v_mfma_f32_16x16x32_bf16 a[0:3], v[212:215], v[184:187], a[0:3]
    v_mfma_f32_16x16x32_bf16 a[4:7], v[216:219], v[184:187], a[4:7]
    buffer_load_dwordx4 v[168:171], v1, s[8:11], s25 offen
    v_mfma_f32_16x16x32_bf16 a[8:11], v[220:223], v[184:187], a[8:11]
    v_mfma_f32_16x16x32_bf16 a[12:15], v[224:227], v[184:187], a[12:15]
    buffer_load_dwordx4 v[172:175], v1, s[8:11], s25 offen offset:1024
    s_waitcnt vmcnt(40)
    v_mfma_f32_16x16x32_bf16 a[16:19], v[212:215], v[188:191], a[16:19]
    v_mfma_f32_16x16x32_bf16 a[20:23], v[216:219], v[188:191], a[20:23]
    buffer_load_dwordx4 v[176:179], v1, s[8:11], s25 offen offset:2048
    v_mfma_f32_16x16x32_bf16 a[24:27], v[220:223], v[188:191], a[24:27]
    v_mfma_f32_16x16x32_bf16 a[28:31], v[224:227], v[188:191], a[28:31]
    buffer_load_dwordx4 v[180:183], v1, s[8:11], s25 offen offset:3072
    s_waitcnt vmcnt(41)
    v_mfma_f32_16x16x32_bf16 a[32:35], v[212:215], v[192:195], a[32:35]
    v_mfma_f32_16x16x32_bf16 a[36:39], v[216:219], v[192:195], a[36:39]
    buffer_load_dwordx4 v[140:143], v1, s[8:11], s24 offen
    v_mfma_f32_16x16x32_bf16 a[40:43], v[220:223], v[192:195], a[40:43]
    v_mfma_f32_16x16x32_bf16 a[44:47], v[224:227], v[192:195], a[44:47]
    buffer_load_dwordx4 v[144:147], v1, s[8:11], s24 offen offset:1024
    s_waitcnt vmcnt(42)
    v_mfma_f32_16x16x32_bf16 a[48:51], v[212:215], v[196:199], a[48:51]
    v_mfma_f32_16x16x32_bf16 a[52:55], v[216:219], v[196:199], a[52:55]
    buffer_load_dwordx4 v[148:151], v1, s[8:11], s24 offen offset:2048
    v_mfma_f32_16x16x32_bf16 a[56:59], v[220:223], v[196:199], a[56:59]
    v_mfma_f32_16x16x32_bf16 a[60:63], v[224:227], v[196:199], a[60:63]
    buffer_load_dwordx4 v[152:155], v1, s[8:11], s24 offen offset:3072
    s_waitcnt vmcnt(43)
    v_mfma_f32_16x16x32_bf16 a[64:67], v[212:215], v[200:203], a[64:67]
    v_mfma_f32_16x16x32_bf16 a[68:71], v[216:219], v[200:203], a[68:71]
    buffer_load_dwordx4 v[156:159], v2, s[8:11], s24 offen
    v_mfma_f32_16x16x32_bf16 a[72:75], v[220:223], v[200:203], a[72:75]
    v_mfma_f32_16x16x32_bf16 a[76:79], v[224:227], v[200:203], a[76:79]
    buffer_load_dwordx4 v[160:163], v2, s[8:11], s24 offen offset:1024
    s_waitcnt vmcnt(44)
    v_mfma_f32_16x16x32_bf16 a[80:83], v[212:215], v[204:207], a[80:83]
    v_mfma_f32_16x16x32_bf16 a[84:87], v[216:219], v[204:207], a[84:87]
    buffer_load_dwordx4 v[164:167], v2, s[8:11], s24 offen offset:2048
    v_mfma_f32_16x16x32_bf16 a[88:91], v[220:223], v[204:207], a[88:91]
    v_mfma_f32_16x16x32_bf16 a[92:95], v[224:227], v[204:207], a[92:95]
    s_add_u32 s24, s24, 425984
    s_add_u32 s25, s25, 131072
    s_waitcnt vmcnt(44)
    v_mfma_f32_16x16x32_bf16 a[96:99], v[212:215], v[208:211], a[96:99]
    v_mfma_f32_16x16x32_bf16 a[100:103], v[216:219], v[208:211], a[100:103]
    v_mfma_f32_16x16x32_bf16 a[104:107], v[220:223], v[208:211], a[104:107]
    v_mfma_f32_16x16x32_bf16 a[108:111], v[224:227], v[208:211], a[108:111]
    s_waitcnt vmcnt(39)
    v_mfma_f32_16x16x32_bf16 a[0:3], v[36:39], v[8:11], a[0:3]
    v_mfma_f32_16x16x32_bf16 a[4:7], v[40:43], v[8:11], a[4:7]
    buffer_load_dwordx4 v[212:215], v1, s[8:11], s25 offen
    v_mfma_f32_16x16x32_bf16 a[8:11], v[44:47], v[8:11], a[8:11]
    v_mfma_f32_16x16x32_bf16 a[12:15], v[48:51], v[8:11], a[12:15]
    buffer_load_dwordx4 v[216:219], v1, s[8:11], s25 offen offset:1024
    s_waitcnt vmcnt(40)
    v_mfma_f32_16x16x32_bf16 a[16:19], v[36:39], v[12:15], a[16:19]
    v_mfma_f32_16x16x32_bf16 a[20:23], v[40:43], v[12:15], a[20:23]
    buffer_load_dwordx4 v[220:223], v1, s[8:11], s25 offen offset:2048
    v_mfma_f32_16x16x32_bf16 a[24:27], v[44:47], v[12:15], a[24:27]
    v_mfma_f32_16x16x32_bf16 a[28:31], v[48:51], v[12:15], a[28:31]
    buffer_load_dwordx4 v[224:227], v1, s[8:11], s25 offen offset:3072
    s_waitcnt vmcnt(41)
    v_mfma_f32_16x16x32_bf16 a[32:35], v[36:39], v[16:19], a[32:35]
    v_mfma_f32_16x16x32_bf16 a[36:39], v[40:43], v[16:19], a[36:39]
    buffer_load_dwordx4 v[184:187], v1, s[8:11], s24 offen
    v_mfma_f32_16x16x32_bf16 a[40:43], v[44:47], v[16:19], a[40:43]
    v_mfma_f32_16x16x32_bf16 a[44:47], v[48:51], v[16:19], a[44:47]
    buffer_load_dwordx4 v[188:191], v1, s[8:11], s24 offen offset:1024
    s_waitcnt vmcnt(42)
    v_mfma_f32_16x16x32_bf16 a[48:51], v[36:39], v[20:23], a[48:51]
    v_mfma_f32_16x16x32_bf16 a[52:55], v[40:43], v[20:23], a[52:55]
    buffer_load_dwordx4 v[192:195], v1, s[8:11], s24 offen offset:2048
    v_mfma_f32_16x16x32_bf16 a[56:59], v[44:47], v[20:23], a[56:59]
    v_mfma_f32_16x16x32_bf16 a[60:63], v[48:51], v[20:23], a[60:63]
    buffer_load_dwordx4 v[196:199], v1, s[8:11], s24 offen offset:3072
    s_waitcnt vmcnt(43)
    v_mfma_f32_16x16x32_bf16 a[64:67], v[36:39], v[24:27], a[64:67]
    v_mfma_f32_16x16x32_bf16 a[68:71], v[40:43], v[24:27], a[68:71]
    buffer_load_dwordx4 v[200:203], v2, s[8:11], s24 offen
    v_mfma_f32_16x16x32_bf16 a[72:75], v[44:47], v[24:27], a[72:75]
    v_mfma_f32_16x16x32_bf16 a[76:79], v[48:51], v[24:27], a[76:79]
    buffer_load_dwordx4 v[204:207], v2, s[8:11], s24 offen offset:1024
    s_waitcnt vmcnt(44)
    v_mfma_f32_16x16x32_bf16 a[80:83], v[36:39], v[28:31], a[80:83]
    v_mfma_f32_16x16x32_bf16 a[84:87], v[40:43], v[28:31], a[84:87]
    buffer_load_dwordx4 v[208:211], v2, s[8:11], s24 offen offset:2048
    v_mfma_f32_16x16x32_bf16 a[88:91], v[44:47], v[28:31], a[88:91]
    v_mfma_f32_16x16x32_bf16 a[92:95], v[48:51], v[28:31], a[92:95]
    s_add_u32 s24, s24, 425984
    s_add_u32 s25, s25, 131072
    s_waitcnt vmcnt(44)
    v_mfma_f32_16x16x32_bf16 a[96:99], v[36:39], v[32:35], a[96:99]
    v_mfma_f32_16x16x32_bf16 a[100:103], v[40:43], v[32:35], a[100:103]
    v_mfma_f32_16x16x32_bf16 a[104:107], v[44:47], v[32:35], a[104:107]
    v_mfma_f32_16x16x32_bf16 a[108:111], v[48:51], v[32:35], a[108:111]
    s_waitcnt vmcnt(39)
    v_mfma_f32_16x16x32_bf16 a[0:3], v[80:83], v[52:55], a[0:3]
    v_mfma_f32_16x16x32_bf16 a[4:7], v[84:87], v[52:55], a[4:7]
    buffer_load_dwordx4 v[36:39], v1, s[8:11], s25 offen
    v_mfma_f32_16x16x32_bf16 a[8:11], v[88:91], v[52:55], a[8:11]
    v_mfma_f32_16x16x32_bf16 a[12:15], v[92:95], v[52:55], a[12:15]
    buffer_load_dwordx4 v[40:43], v1, s[8:11], s25 offen offset:1024
    s_waitcnt vmcnt(40)
    v_mfma_f32_16x16x32_bf16 a[16:19], v[80:83], v[56:59], a[16:19]
    v_mfma_f32_16x16x32_bf16 a[20:23], v[84:87], v[56:59], a[20:23]
    buffer_load_dwordx4 v[44:47], v1, s[8:11], s25 offen offset:2048
    v_mfma_f32_16x16x32_bf16 a[24:27], v[88:91], v[56:59], a[24:27]
    v_mfma_f32_16x16x32_bf16 a[28:31], v[92:95], v[56:59], a[28:31]
    buffer_load_dwordx4 v[48:51], v1, s[8:11], s25 offen offset:3072
    s_waitcnt vmcnt(41)
    v_mfma_f32_16x16x32_bf16 a[32:35], v[80:83], v[60:63], a[32:35]
    v_mfma_f32_16x16x32_bf16 a[36:39], v[84:87], v[60:63], a[36:39]
    buffer_load_dwordx4 v[8:11], v1, s[8:11], s24 offen
    v_mfma_f32_16x16x32_bf16 a[40:43], v[88:91], v[60:63], a[40:43]
    v_mfma_f32_16x16x32_bf16 a[44:47], v[92:95], v[60:63], a[44:47]
    buffer_load_dwordx4 v[12:15], v1, s[8:11], s24 offen offset:1024
    s_waitcnt vmcnt(42)
    v_mfma_f32_16x16x32_bf16 a[48:51], v[80:83], v[64:67], a[48:51]
    v_mfma_f32_16x16x32_bf16 a[52:55], v[84:87], v[64:67], a[52:55]
    buffer_load_dwordx4 v[16:19], v1, s[8:11], s24 offen offset:2048
    v_mfma_f32_16x16x32_bf16 a[56:59], v[88:91], v[64:67], a[56:59]
    v_mfma_f32_16x16x32_bf16 a[60:63], v[92:95], v[64:67], a[60:63]
    buffer_load_dwordx4 v[20:23], v1, s[8:11], s24 offen offset:3072
    s_waitcnt vmcnt(43)
    v_mfma_f32_16x16x32_bf16 a[64:67], v[80:83], v[68:71], a[64:67]
    v_mfma_f32_16x16x32_bf16 a[68:71], v[84:87], v[68:71], a[68:71]
    buffer_load_dwordx4 v[24:27], v2, s[8:11], s24 offen
    v_mfma_f32_16x16x32_bf16 a[72:75], v[88:91], v[68:71], a[72:75]
    v_mfma_f32_16x16x32_bf16 a[76:79], v[92:95], v[68:71], a[76:79]
    buffer_load_dwordx4 v[28:31], v2, s[8:11], s24 offen offset:1024
    s_waitcnt vmcnt(44)
    v_mfma_f32_16x16x32_bf16 a[80:83], v[80:83], v[72:75], a[80:83]
    v_mfma_f32_16x16x32_bf16 a[84:87], v[84:87], v[72:75], a[84:87]
    buffer_load_dwordx4 v[32:35], v2, s[8:11], s24 offen offset:2048
    v_mfma_f32_16x16x32_bf16 a[88:91], v[88:91], v[72:75], a[88:91]
    v_mfma_f32_16x16x32_bf16 a[92:95], v[92:95], v[72:75], a[92:95]
    s_add_u32 s24, s24, 425984
    s_add_u32 s25, s25, 131072
    s_waitcnt vmcnt(44)
    v_mfma_f32_16x16x32_bf16 a[96:99], v[80:83], v[76:79], a[96:99]
    v_mfma_f32_16x16x32_bf16 a[100:103], v[84:87], v[76:79], a[100:103]
    v_mfma_f32_16x16x32_bf16 a[104:107], v[88:91], v[76:79], a[104:107]
    v_mfma_f32_16x16x32_bf16 a[108:111], v[92:95], v[76:79], a[108:111]
    s_waitcnt vmcnt(39)
    v_mfma_f32_16x16x32_bf16 a[0:3], v[124:127], v[96:99], a[0:3]
    v_mfma_f32_16x16x32_bf16 a[4:7], v[128:131], v[96:99], a[4:7]
    buffer_load_dwordx4 v[80:83], v1, s[8:11], s25 offen
    v_mfma_f32_16x16x32_bf16 a[8:11], v[132:135], v[96:99], a[8:11]
    v_mfma_f32_16x16x32_bf16 a[12:15], v[136:139], v[96:99], a[12:15]
    buffer_load_dwordx4 v[84:87], v1, s[8:11], s25 offen offset:1024
    s_waitcnt vmcnt(40)
    v_mfma_f32_16x16x32_bf16 a[16:19], v[124:127], v[100:103], a[16:19]
    v_mfma_f32_16x16x32_bf16 a[20:23], v[128:131], v[100:103], a[20:23]
    buffer_load_dwordx4 v[88:91], v1, s[8:11], s25 offen offset:2048
    v_mfma_f32_16x16x32_bf16 a[24:27], v[132:135], v[100:103], a[24:27]
    v_mfma_f32_16x16x32_bf16 a[28:31], v[136:139], v[100:103], a[28:31]
    buffer_load_dwordx4 v[92:95], v1, s[8:11], s25 offen offset:3072
    s_waitcnt vmcnt(41)
    v_mfma_f32_16x16x32_bf16 a[32:35], v[124:127], v[104:107], a[32:35]
    v_mfma_f32_16x16x32_bf16 a[36:39], v[128:131], v[104:107], a[36:39]
    buffer_load_dwordx4 v[52:55], v1, s[8:11], s24 offen
    v_mfma_f32_16x16x32_bf16 a[40:43], v[132:135], v[104:107], a[40:43]
    v_mfma_f32_16x16x32_bf16 a[44:47], v[136:139], v[104:107], a[44:47]
    buffer_load_dwordx4 v[56:59], v1, s[8:11], s24 offen offset:1024
    s_waitcnt vmcnt(42)
    v_mfma_f32_16x16x32_bf16 a[48:51], v[124:127], v[108:111], a[48:51]
    v_mfma_f32_16x16x32_bf16 a[52:55], v[128:131], v[108:111], a[52:55]
    buffer_load_dwordx4 v[60:63], v1, s[8:11], s24 offen offset:2048
    v_mfma_f32_16x16x32_bf16 a[56:59], v[132:135], v[108:111], a[56:59]
    v_mfma_f32_16x16x32_bf16 a[60:63], v[136:139], v[108:111], a[60:63]
    buffer_load_dwordx4 v[64:67], v1, s[8:11], s24 offen offset:3072
    s_waitcnt vmcnt(43)
    v_mfma_f32_16x16x32_bf16 a[64:67], v[124:127], v[112:115], a[64:67]
    v_mfma_f32_16x16x32_bf16 a[68:71], v[128:131], v[112:115], a[68:71]
    buffer_load_dwordx4 v[68:71], v2, s[8:11], s24 offen
    v_mfma_f32_16x16x32_bf16 a[72:75], v[132:135], v[112:115], a[72:75]
    v_mfma_f32_16x16x32_bf16 a[76:79], v[136:139], v[112:115], a[76:79]
    buffer_load_dwordx4 v[72:75], v2, s[8:11], s24 offen offset:1024
    s_waitcnt vmcnt(44)
    v_mfma_f32_16x16x32_bf16 a[80:83], v[124:127], v[116:119], a[80:83]
    v_mfma_f32_16x16x32_bf16 a[84:87], v[128:131], v[116:119], a[84:87]
    buffer_load_dwordx4 v[76:79], v2, s[8:11], s24 offen offset:2048
    v_mfma_f32_16x16x32_bf16 a[88:91], v[132:135], v[116:119], a[88:91]
    v_mfma_f32_16x16x32_bf16 a[92:95], v[136:139], v[116:119], a[92:95]
    s_add_u32 s24, s24, 425984
    s_add_u32 s25, s25, 131072
    s_waitcnt vmcnt(44)
    v_mfma_f32_16x16x32_bf16 a[96:99], v[124:127], v[120:123], a[96:99]
    v_mfma_f32_16x16x32_bf16 a[100:103], v[128:131], v[120:123], a[100:103]
    v_mfma_f32_16x16x32_bf16 a[104:107], v[132:135], v[120:123], a[104:107]
    v_mfma_f32_16x16x32_bf16 a[108:111], v[136:139], v[120:123], a[108:111]
    s_waitcnt vmcnt(39)
    v_mfma_f32_16x16x32_bf16 a[0:3], v[168:171], v[140:143], a[0:3]
    v_mfma_f32_16x16x32_bf16 a[4:7], v[172:175], v[140:143], a[4:7]
    buffer_load_dwordx4 v[124:127], v1, s[8:11], s25 offen
    v_mfma_f32_16x16x32_bf16 a[8:11], v[176:179], v[140:143], a[8:11]
    v_mfma_f32_16x16x32_bf16 a[12:15], v[180:183], v[140:143], a[12:15]
    buffer_load_dwordx4 v[128:131], v1, s[8:11], s25 offen offset:1024
    s_waitcnt vmcnt(40)
    v_mfma_f32_16x16x32_bf16 a[16:19], v[168:171], v[144:147], a[16:19]
    v_mfma_f32_16x16x32_bf16 a[20:23], v[172:175], v[144:147], a[20:23]
    buffer_load_dwordx4 v[132:135], v1, s[8:11], s25 offen offset:2048
    v_mfma_f32_16x16x32_bf16 a[24:27], v[176:179], v[144:147], a[24:27]
    v_mfma_f32_16x16x32_bf16 a[28:31], v[180:183], v[144:147], a[28:31]
    buffer_load_dwordx4 v[136:139], v1, s[8:11], s25 offen offset:3072
    s_waitcnt vmcnt(41)
    v_mfma_f32_16x16x32_bf16 a[32:35], v[168:171], v[148:151], a[32:35]
    v_mfma_f32_16x16x32_bf16 a[36:39], v[172:175], v[148:151], a[36:39]
    buffer_load_dwordx4 v[96:99], v1, s[8:11], s24 offen
    v_mfma_f32_16x16x32_bf16 a[40:43], v[176:179], v[148:151], a[40:43]
    v_mfma_f32_16x16x32_bf16 a[44:47], v[180:183], v[148:151], a[44:47]
    buffer_load_dwordx4 v[100:103], v1, s[8:11], s24 offen offset:1024
    s_waitcnt vmcnt(42)
    v_mfma_f32_16x16x32_bf16 a[48:51], v[168:171], v[152:155], a[48:51]
    v_mfma_f32_16x16x32_bf16 a[52:55], v[172:175], v[152:155], a[52:55]
    buffer_load_dwordx4 v[104:107], v1, s[8:11], s24 offen offset:2048
    v_mfma_f32_16x16x32_bf16 a[56:59], v[176:179], v[152:155], a[56:59]
    v_mfma_f32_16x16x32_bf16 a[60:63], v[180:183], v[152:155], a[60:63]
    buffer_load_dwordx4 v[108:111], v1, s[8:11], s24 offen offset:3072
    s_waitcnt vmcnt(43)
    v_mfma_f32_16x16x32_bf16 a[64:67], v[168:171], v[156:159], a[64:67]
    v_mfma_f32_16x16x32_bf16 a[68:71], v[172:175], v[156:159], a[68:71]
    buffer_load_dwordx4 v[112:115], v2, s[8:11], s24 offen
    v_mfma_f32_16x16x32_bf16 a[72:75], v[176:179], v[156:159], a[72:75]
    v_mfma_f32_16x16x32_bf16 a[76:79], v[180:183], v[156:159], a[76:79]
    buffer_load_dwordx4 v[116:119], v2, s[8:11], s24 offen offset:1024
    s_waitcnt vmcnt(44)
    v_mfma_f32_16x16x32_bf16 a[80:83], v[168:171], v[160:163], a[80:83]
    v_mfma_f32_16x16x32_bf16 a[84:87], v[172:175], v[160:163], a[84:87]
    buffer_load_dwordx4 v[120:123], v2, s[8:11], s24 offen offset:2048
    v_mfma_f32_16x16x32_bf16 a[88:91], v[176:179], v[160:163], a[88:91]
    v_mfma_f32_16x16x32_bf16 a[92:95], v[180:183], v[160:163], a[92:95]
    s_add_u32 s24, s24, 425984
    s_add_u32 s25, s25, 131072
    s_waitcnt vmcnt(44)
    v_mfma_f32_16x16x32_bf16 a[96:99], v[168:171], v[164:167], a[96:99]
    v_mfma_f32_16x16x32_bf16 a[100:103], v[172:175], v[164:167], a[100:103]
    v_mfma_f32_16x16x32_bf16 a[104:107], v[176:179], v[164:167], a[104:107]
    v_mfma_f32_16x16x32_bf16 a[108:111], v[180:183], v[164:167], a[108:111]
    s_waitcnt vmcnt(39)
    v_mfma_f32_16x16x32_bf16 a[0:3], v[212:215], v[184:187], a[0:3]
    v_mfma_f32_16x16x32_bf16 a[4:7], v[216:219], v[184:187], a[4:7]
    buffer_load_dwordx4 v[168:171], v1, s[8:11], s25 offen
    v_mfma_f32_16x16x32_bf16 a[8:11], v[220:223], v[184:187], a[8:11]
    v_mfma_f32_16x16x32_bf16 a[12:15], v[224:227], v[184:187], a[12:15]
    buffer_load_dwordx4 v[172:175], v1, s[8:11], s25 offen offset:1024
    s_waitcnt vmcnt(40)
    v_mfma_f32_16x16x32_bf16 a[16:19], v[212:215], v[188:191], a[16:19]
    v_mfma_f32_16x16x32_bf16 a[20:23], v[216:219], v[188:191], a[20:23]
    buffer_load_dwordx4 v[176:179], v1, s[8:11], s25 offen offset:2048
    v_mfma_f32_16x16x32_bf16 a[24:27], v[220:223], v[188:191], a[24:27]
    v_mfma_f32_16x16x32_bf16 a[28:31], v[224:227], v[188:191], a[28:31]
    buffer_load_dwordx4 v[180:183], v1, s[8:11], s25 offen offset:3072
    s_waitcnt vmcnt(41)
    v_mfma_f32_16x16x32_bf16 a[32:35], v[212:215], v[192:195], a[32:35]
    v_mfma_f32_16x16x32_bf16 a[36:39], v[216:219], v[192:195], a[36:39]
    buffer_load_dwordx4 v[140:143], v1, s[8:11], s24 offen
    v_mfma_f32_16x16x32_bf16 a[40:43], v[220:223], v[192:195], a[40:43]
    v_mfma_f32_16x16x32_bf16 a[44:47], v[224:227], v[192:195], a[44:47]
    buffer_load_dwordx4 v[144:147], v1, s[8:11], s24 offen offset:1024
    s_waitcnt vmcnt(42)
    v_mfma_f32_16x16x32_bf16 a[48:51], v[212:215], v[196:199], a[48:51]
    v_mfma_f32_16x16x32_bf16 a[52:55], v[216:219], v[196:199], a[52:55]
    buffer_load_dwordx4 v[148:151], v1, s[8:11], s24 offen offset:2048
    v_mfma_f32_16x16x32_bf16 a[56:59], v[220:223], v[196:199], a[56:59]
    v_mfma_f32_16x16x32_bf16 a[60:63], v[224:227], v[196:199], a[60:63]
    buffer_load_dwordx4 v[152:155], v1, s[8:11], s24 offen offset:3072
    s_waitcnt vmcnt(43)
    v_mfma_f32_16x16x32_bf16 a[64:67], v[212:215], v[200:203], a[64:67]
    v_mfma_f32_16x16x32_bf16 a[68:71], v[216:219], v[200:203], a[68:71]
    buffer_load_dwordx4 v[156:159], v2, s[8:11], s24 offen
    v_mfma_f32_16x16x32_bf16 a[72:75], v[220:223], v[200:203], a[72:75]
    v_mfma_f32_16x16x32_bf16 a[76:79], v[224:227], v[200:203], a[76:79]
    buffer_load_dwordx4 v[160:163], v2, s[8:11], s24 offen offset:1024
    s_waitcnt vmcnt(44)
    v_mfma_f32_16x16x32_bf16 a[80:83], v[212:215], v[204:207], a[80:83]
    v_mfma_f32_16x16x32_bf16 a[84:87], v[216:219], v[204:207], a[84:87]
    buffer_load_dwordx4 v[164:167], v2, s[8:11], s24 offen offset:2048
    v_mfma_f32_16x16x32_bf16 a[88:91], v[220:223], v[204:207], a[88:91]
    v_mfma_f32_16x16x32_bf16 a[92:95], v[224:227], v[204:207], a[92:95]
    s_add_u32 s24, s24, 425984
    s_add_u32 s25, s25, 131072
    s_waitcnt vmcnt(44)
    v_mfma_f32_16x16x32_bf16 a[96:99], v[212:215], v[208:211], a[96:99]
    v_mfma_f32_16x16x32_bf16 a[100:103], v[216:219], v[208:211], a[100:103]
    v_mfma_f32_16x16x32_bf16 a[104:107], v[220:223], v[208:211], a[104:107]
    v_mfma_f32_16x16x32_bf16 a[108:111], v[224:227], v[208:211], a[108:111]
    s_waitcnt vmcnt(39)
    v_mfma_f32_16x16x32_bf16 a[0:3], v[36:39], v[8:11], a[0:3]
    v_mfma_f32_16x16x32_bf16 a[4:7], v[40:43], v[8:11], a[4:7]
    buffer_load_dwordx4 v[212:215], v1, s[8:11], s25 offen
    v_mfma_f32_16x16x32_bf16 a[8:11], v[44:47], v[8:11], a[8:11]
    v_mfma_f32_16x16x32_bf16 a[12:15], v[48:51], v[8:11], a[12:15]
    buffer_load_dwordx4 v[216:219], v1, s[8:11], s25 offen offset:1024
    s_waitcnt vmcnt(40)
    v_mfma_f32_16x16x32_bf16 a[16:19], v[36:39], v[12:15], a[16:19]
    v_mfma_f32_16x16x32_bf16 a[20:23], v[40:43], v[12:15], a[20:23]
    buffer_load_dwordx4 v[220:223], v1, s[8:11], s25 offen offset:2048
    v_mfma_f32_16x16x32_bf16 a[24:27], v[44:47], v[12:15], a[24:27]
    v_mfma_f32_16x16x32_bf16 a[28:31], v[48:51], v[12:15], a[28:31]
    buffer_load_dwordx4 v[224:227], v1, s[8:11], s25 offen offset:3072
    s_waitcnt vmcnt(41)
    v_mfma_f32_16x16x32_bf16 a[32:35], v[36:39], v[16:19], a[32:35]
    v_mfma_f32_16x16x32_bf16 a[36:39], v[40:43], v[16:19], a[36:39]
    buffer_load_dwordx4 v[184:187], v1, s[8:11], s24 offen
    v_mfma_f32_16x16x32_bf16 a[40:43], v[44:47], v[16:19], a[40:43]
    v_mfma_f32_16x16x32_bf16 a[44:47], v[48:51], v[16:19], a[44:47]
    buffer_load_dwordx4 v[188:191], v1, s[8:11], s24 offen offset:1024
    s_waitcnt vmcnt(42)
    v_mfma_f32_16x16x32_bf16 a[48:51], v[36:39], v[20:23], a[48:51]
    v_mfma_f32_16x16x32_bf16 a[52:55], v[40:43], v[20:23], a[52:55]
    buffer_load_dwordx4 v[192:195], v1, s[8:11], s24 offen offset:2048
    v_mfma_f32_16x16x32_bf16 a[56:59], v[44:47], v[20:23], a[56:59]
    v_mfma_f32_16x16x32_bf16 a[60:63], v[48:51], v[20:23], a[60:63]
    buffer_load_dwordx4 v[196:199], v1, s[8:11], s24 offen offset:3072
    s_waitcnt vmcnt(43)
    v_mfma_f32_16x16x32_bf16 a[64:67], v[36:39], v[24:27], a[64:67]
    v_mfma_f32_16x16x32_bf16 a[68:71], v[40:43], v[24:27], a[68:71]
    buffer_load_dwordx4 v[200:203], v2, s[8:11], s24 offen
    v_mfma_f32_16x16x32_bf16 a[72:75], v[44:47], v[24:27], a[72:75]
    v_mfma_f32_16x16x32_bf16 a[76:79], v[48:51], v[24:27], a[76:79]
    buffer_load_dwordx4 v[204:207], v2, s[8:11], s24 offen offset:1024
    s_waitcnt vmcnt(44)
    v_mfma_f32_16x16x32_bf16 a[80:83], v[36:39], v[28:31], a[80:83]
    v_mfma_f32_16x16x32_bf16 a[84:87], v[40:43], v[28:31], a[84:87]
    buffer_load_dwordx4 v[208:211], v2, s[8:11], s24 offen offset:2048
    v_mfma_f32_16x16x32_bf16 a[88:91], v[44:47], v[28:31], a[88:91]
    v_mfma_f32_16x16x32_bf16 a[92:95], v[48:51], v[28:31], a[92:95]
    s_add_u32 s24, s24, 425984
    s_add_u32 s25, s25, 131072
    s_waitcnt vmcnt(44)
    v_mfma_f32_16x16x32_bf16 a[96:99], v[36:39], v[32:35], a[96:99]
    v_mfma_f32_16x16x32_bf16 a[100:103], v[40:43], v[32:35], a[100:103]
    v_mfma_f32_16x16x32_bf16 a[104:107], v[44:47], v[32:35], a[104:107]
    v_mfma_f32_16x16x32_bf16 a[108:111], v[48:51], v[32:35], a[108:111]
    s_waitcnt vmcnt(39)
    v_mfma_f32_16x16x32_bf16 a[0:3], v[80:83], v[52:55], a[0:3]
    v_mfma_f32_16x16x32_bf16 a[4:7], v[84:87], v[52:55], a[4:7]
    buffer_load_dwordx4 v[36:39], v1, s[8:11], s25 offen
    v_mfma_f32_16x16x32_bf16 a[8:11], v[88:91], v[52:55], a[8:11]
    v_mfma_f32_16x16x32_bf16 a[12:15], v[92:95], v[52:55], a[12:15]
    buffer_load_dwordx4 v[40:43], v1, s[8:11], s25 offen offset:1024
    s_waitcnt vmcnt(40)
    v_mfma_f32_16x16x32_bf16 a[16:19], v[80:83], v[56:59], a[16:19]
    v_mfma_f32_16x16x32_bf16 a[20:23], v[84:87], v[56:59], a[20:23]
    buffer_load_dwordx4 v[44:47], v1, s[8:11], s25 offen offset:2048
    v_mfma_f32_16x16x32_bf16 a[24:27], v[88:91], v[56:59], a[24:27]
    v_mfma_f32_16x16x32_bf16 a[28:31], v[92:95], v[56:59], a[28:31]
    buffer_load_dwordx4 v[48:51], v1, s[8:11], s25 offen offset:3072
    s_waitcnt vmcnt(41)
    v_mfma_f32_16x16x32_bf16 a[32:35], v[80:83], v[60:63], a[32:35]
    v_mfma_f32_16x16x32_bf16 a[36:39], v[84:87], v[60:63], a[36:39]
    buffer_load_dwordx4 v[8:11], v1, s[8:11], s24 offen
    v_mfma_f32_16x16x32_bf16 a[40:43], v[88:91], v[60:63], a[40:43]
    v_mfma_f32_16x16x32_bf16 a[44:47], v[92:95], v[60:63], a[44:47]
    buffer_load_dwordx4 v[12:15], v1, s[8:11], s24 offen offset:1024
    s_waitcnt vmcnt(42)
    v_mfma_f32_16x16x32_bf16 a[48:51], v[80:83], v[64:67], a[48:51]
    v_mfma_f32_16x16x32_bf16 a[52:55], v[84:87], v[64:67], a[52:55]
    buffer_load_dwordx4 v[16:19], v1, s[8:11], s24 offen offset:2048
    v_mfma_f32_16x16x32_bf16 a[56:59], v[88:91], v[64:67], a[56:59]
    v_mfma_f32_16x16x32_bf16 a[60:63], v[92:95], v[64:67], a[60:63]
    buffer_load_dwordx4 v[20:23], v1, s[8:11], s24 offen offset:3072
    s_waitcnt vmcnt(43)
    v_mfma_f32_16x16x32_bf16 a[64:67], v[80:83], v[68:71], a[64:67]
    v_mfma_f32_16x16x32_bf16 a[68:71], v[84:87], v[68:71], a[68:71]
    buffer_load_dwordx4 v[24:27], v2, s[8:11], s24 offen
    v_mfma_f32_16x16x32_bf16 a[72:75], v[88:91], v[68:71], a[72:75]
    v_mfma_f32_16x16x32_bf16 a[76:79], v[92:95], v[68:71], a[76:79]
    buffer_load_dwordx4 v[28:31], v2, s[8:11], s24 offen offset:1024
    s_waitcnt vmcnt(44)
    v_mfma_f32_16x16x32_bf16 a[80:83], v[80:83], v[72:75], a[80:83]
    v_mfma_f32_16x16x32_bf16 a[84:87], v[84:87], v[72:75], a[84:87]
    buffer_load_dwordx4 v[32:35], v2, s[8:11], s24 offen offset:2048
    v_mfma_f32_16x16x32_bf16 a[88:91], v[88:91], v[72:75], a[88:91]
    v_mfma_f32_16x16x32_bf16 a[92:95], v[92:95], v[72:75], a[92:95]
    s_add_u32 s24, s24, 425984
    s_add_u32 s25, s25, 131072
    s_waitcnt vmcnt(44)
    v_mfma_f32_16x16x32_bf16 a[96:99], v[80:83], v[76:79], a[96:99]
    v_mfma_f32_16x16x32_bf16 a[100:103], v[84:87], v[76:79], a[100:103]
    v_mfma_f32_16x16x32_bf16 a[104:107], v[88:91], v[76:79], a[104:107]
    v_mfma_f32_16x16x32_bf16 a[108:111], v[92:95], v[76:79], a[108:111]
    s_waitcnt vmcnt(39)
    v_mfma_f32_16x16x32_bf16 a[0:3], v[124:127], v[96:99], a[0:3]
    v_mfma_f32_16x16x32_bf16 a[4:7], v[128:131], v[96:99], a[4:7]
    buffer_load_dwordx4 v[80:83], v1, s[8:11], s25 offen
    v_mfma_f32_16x16x32_bf16 a[8:11], v[132:135], v[96:99], a[8:11]
    v_mfma_f32_16x16x32_bf16 a[12:15], v[136:139], v[96:99], a[12:15]
    buffer_load_dwordx4 v[84:87], v1, s[8:11], s25 offen offset:1024
    s_waitcnt vmcnt(40)
    v_mfma_f32_16x16x32_bf16 a[16:19], v[124:127], v[100:103], a[16:19]
    v_mfma_f32_16x16x32_bf16 a[20:23], v[128:131], v[100:103], a[20:23]
    buffer_load_dwordx4 v[88:91], v1, s[8:11], s25 offen offset:2048
    v_mfma_f32_16x16x32_bf16 a[24:27], v[132:135], v[100:103], a[24:27]
    v_mfma_f32_16x16x32_bf16 a[28:31], v[136:139], v[100:103], a[28:31]
    buffer_load_dwordx4 v[92:95], v1, s[8:11], s25 offen offset:3072
    s_waitcnt vmcnt(41)
    v_mfma_f32_16x16x32_bf16 a[32:35], v[124:127], v[104:107], a[32:35]
    v_mfma_f32_16x16x32_bf16 a[36:39], v[128:131], v[104:107], a[36:39]
    buffer_load_dwordx4 v[52:55], v1, s[8:11], s24 offen
    v_mfma_f32_16x16x32_bf16 a[40:43], v[132:135], v[104:107], a[40:43]
    v_mfma_f32_16x16x32_bf16 a[44:47], v[136:139], v[104:107], a[44:47]
    buffer_load_dwordx4 v[56:59], v1, s[8:11], s24 offen offset:1024
    s_waitcnt vmcnt(42)
    v_mfma_f32_16x16x32_bf16 a[48:51], v[124:127], v[108:111], a[48:51]
    v_mfma_f32_16x16x32_bf16 a[52:55], v[128:131], v[108:111], a[52:55]
    buffer_load_dwordx4 v[60:63], v1, s[8:11], s24 offen offset:2048
    v_mfma_f32_16x16x32_bf16 a[56:59], v[132:135], v[108:111], a[56:59]
    v_mfma_f32_16x16x32_bf16 a[60:63], v[136:139], v[108:111], a[60:63]
    buffer_load_dwordx4 v[64:67], v1, s[8:11], s24 offen offset:3072
    s_waitcnt vmcnt(43)
    v_mfma_f32_16x16x32_bf16 a[64:67], v[124:127], v[112:115], a[64:67]
    v_mfma_f32_16x16x32_bf16 a[68:71], v[128:131], v[112:115], a[68:71]
    buffer_load_dwordx4 v[68:71], v2, s[8:11], s24 offen
    v_mfma_f32_16x16x32_bf16 a[72:75], v[132:135], v[112:115], a[72:75]
    v_mfma_f32_16x16x32_bf16 a[76:79], v[136:139], v[112:115], a[76:79]
    buffer_load_dwordx4 v[72:75], v2, s[8:11], s24 offen offset:1024
    s_waitcnt vmcnt(44)
    v_mfma_f32_16x16x32_bf16 a[80:83], v[124:127], v[116:119], a[80:83]
    v_mfma_f32_16x16x32_bf16 a[84:87], v[128:131], v[116:119], a[84:87]
    buffer_load_dwordx4 v[76:79], v2, s[8:11], s24 offen offset:2048
    v_mfma_f32_16x16x32_bf16 a[88:91], v[132:135], v[116:119], a[88:91]
    v_mfma_f32_16x16x32_bf16 a[92:95], v[136:139], v[116:119], a[92:95]
    s_add_u32 s24, s24, 425984
    s_add_u32 s25, s25, 131072
    s_waitcnt vmcnt(44)
    v_mfma_f32_16x16x32_bf16 a[96:99], v[124:127], v[120:123], a[96:99]
    v_mfma_f32_16x16x32_bf16 a[100:103], v[128:131], v[120:123], a[100:103]
    v_mfma_f32_16x16x32_bf16 a[104:107], v[132:135], v[120:123], a[104:107]
    v_mfma_f32_16x16x32_bf16 a[108:111], v[136:139], v[120:123], a[108:111]
    s_waitcnt vmcnt(39)
    v_mfma_f32_16x16x32_bf16 a[0:3], v[168:171], v[140:143], a[0:3]
    v_mfma_f32_16x16x32_bf16 a[4:7], v[172:175], v[140:143], a[4:7]
    v_mfma_f32_16x16x32_bf16 a[8:11], v[176:179], v[140:143], a[8:11]
    v_mfma_f32_16x16x32_bf16 a[12:15], v[180:183], v[140:143], a[12:15]
    s_waitcnt vmcnt(38)
    v_mfma_f32_16x16x32_bf16 a[16:19], v[168:171], v[144:147], a[16:19]
    v_mfma_f32_16x16x32_bf16 a[20:23], v[172:175], v[144:147], a[20:23]
    v_mfma_f32_16x16x32_bf16 a[24:27], v[176:179], v[144:147], a[24:27]
    v_mfma_f32_16x16x32_bf16 a[28:31], v[180:183], v[144:147], a[28:31]
    s_waitcnt vmcnt(37)
    v_mfma_f32_16x16x32_bf16 a[32:35], v[168:171], v[148:151], a[32:35]
    v_mfma_f32_16x16x32_bf16 a[36:39], v[172:175], v[148:151], a[36:39]
    v_mfma_f32_16x16x32_bf16 a[40:43], v[176:179], v[148:151], a[40:43]
    v_mfma_f32_16x16x32_bf16 a[44:47], v[180:183], v[148:151], a[44:47]
    s_waitcnt vmcnt(36)
    v_mfma_f32_16x16x32_bf16 a[48:51], v[168:171], v[152:155], a[48:51]
    v_mfma_f32_16x16x32_bf16 a[52:55], v[172:175], v[152:155], a[52:55]
    v_mfma_f32_16x16x32_bf16 a[56:59], v[176:179], v[152:155], a[56:59]
    v_mfma_f32_16x16x32_bf16 a[60:63], v[180:183], v[152:155], a[60:63]
    s_waitcnt vmcnt(35)
    v_mfma_f32_16x16x32_bf16 a[64:67], v[168:171], v[156:159], a[64:67]
    v_mfma_f32_16x16x32_bf16 a[68:71], v[172:175], v[156:159], a[68:71]
    v_mfma_f32_16x16x32_bf16 a[72:75], v[176:179], v[156:159], a[72:75]
    v_mfma_f32_16x16x32_bf16 a[76:79], v[180:183], v[156:159], a[76:79]
    s_waitcnt vmcnt(34)
    v_mfma_f32_16x16x32_bf16 a[80:83], v[168:171], v[160:163], a[80:83]
    v_mfma_f32_16x16x32_bf16 a[84:87], v[172:175], v[160:163], a[84:87]
    v_mfma_f32_16x16x32_bf16 a[88:91], v[176:179], v[160:163], a[88:91]
    v_mfma_f32_16x16x32_bf16 a[92:95], v[180:183], v[160:163], a[92:95]
    s_waitcnt vmcnt(33)
    v_mfma_f32_16x16x32_bf16 a[96:99], v[168:171], v[164:167], a[96:99]
    v_mfma_f32_16x16x32_bf16 a[100:103], v[172:175], v[164:167], a[100:103]
    v_mfma_f32_16x16x32_bf16 a[104:107], v[176:179], v[164:167], a[104:107]
    v_mfma_f32_16x16x32_bf16 a[108:111], v[180:183], v[164:167], a[108:111]
    s_waitcnt vmcnt(28)
    v_mfma_f32_16x16x32_bf16 a[0:3], v[212:215], v[184:187], a[0:3]
    v_mfma_f32_16x16x32_bf16 a[4:7], v[216:219], v[184:187], a[4:7]
    v_mfma_f32_16x16x32_bf16 a[8:11], v[220:223], v[184:187], a[8:11]
    v_mfma_f32_16x16x32_bf16 a[12:15], v[224:227], v[184:187], a[12:15]
    s_waitcnt vmcnt(27)
    v_mfma_f32_16x16x32_bf16 a[16:19], v[212:215], v[188:191], a[16:19]
    v_mfma_f32_16x16x32_bf16 a[20:23], v[216:219], v[188:191], a[20:23]
    v_mfma_f32_16x16x32_bf16 a[24:27], v[220:223], v[188:191], a[24:27]
    v_mfma_f32_16x16x32_bf16 a[28:31], v[224:227], v[188:191], a[28:31]
    s_waitcnt vmcnt(26)
    v_mfma_f32_16x16x32_bf16 a[32:35], v[212:215], v[192:195], a[32:35]
    v_mfma_f32_16x16x32_bf16 a[36:39], v[216:219], v[192:195], a[36:39]
    v_mfma_f32_16x16x32_bf16 a[40:43], v[220:223], v[192:195], a[40:43]
    v_mfma_f32_16x16x32_bf16 a[44:47], v[224:227], v[192:195], a[44:47]
    s_waitcnt vmcnt(25)
    v_mfma_f32_16x16x32_bf16 a[48:51], v[212:215], v[196:199], a[48:51]
    v_mfma_f32_16x16x32_bf16 a[52:55], v[216:219], v[196:199], a[52:55]
    v_mfma_f32_16x16x32_bf16 a[56:59], v[220:223], v[196:199], a[56:59]
    v_mfma_f32_16x16x32_bf16 a[60:63], v[224:227], v[196:199], a[60:63]
    s_waitcnt vmcnt(24)
    v_mfma_f32_16x16x32_bf16 a[64:67], v[212:215], v[200:203], a[64:67]
    v_mfma_f32_16x16x32_bf16 a[68:71], v[216:219], v[200:203], a[68:71]
    v_mfma_f32_16x16x32_bf16 a[72:75], v[220:223], v[200:203], a[72:75]
    v_mfma_f32_16x16x32_bf16 a[76:79], v[224:227], v[200:203], a[76:79]
    s_waitcnt vmcnt(23)
    v_mfma_f32_16x16x32_bf16 a[80:83], v[212:215], v[204:207], a[80:83]
    v_mfma_f32_16x16x32_bf16 a[84:87], v[216:219], v[204:207], a[84:87]
    v_mfma_f32_16x16x32_bf16 a[88:91], v[220:223], v[204:207], a[88:91]
    v_mfma_f32_16x16x32_bf16 a[92:95], v[224:227], v[204:207], a[92:95]
    s_waitcnt vmcnt(22)
    v_mfma_f32_16x16x32_bf16 a[96:99], v[212:215], v[208:211], a[96:99]
    v_mfma_f32_16x16x32_bf16 a[100:103], v[216:219], v[208:211], a[100:103]
    v_mfma_f32_16x16x32_bf16 a[104:107], v[220:223], v[208:211], a[104:107]
    v_mfma_f32_16x16x32_bf16 a[108:111], v[224:227], v[208:211], a[108:111]
    s_waitcnt vmcnt(17)
    v_mfma_f32_16x16x32_bf16 a[0:3], v[36:39], v[8:11], a[0:3]
    v_mfma_f32_16x16x32_bf16 a[4:7], v[40:43], v[8:11], a[4:7]
    v_mfma_f32_16x16x32_bf16 a[8:11], v[44:47], v[8:11], a[8:11]
    v_mfma_f32_16x16x32_bf16 a[12:15], v[48:51], v[8:11], a[12:15]
    s_waitcnt vmcnt(16)
    v_mfma_f32_16x16x32_bf16 a[16:19], v[36:39], v[12:15], a[16:19]
    v_mfma_f32_16x16x32_bf16 a[20:23], v[40:43], v[12:15], a[20:23]
    v_mfma_f32_16x16x32_bf16 a[24:27], v[44:47], v[12:15], a[24:27]
    v_mfma_f32_16x16x32_bf16 a[28:31], v[48:51], v[12:15], a[28:31]
    s_waitcnt vmcnt(15)
    v_mfma_f32_16x16x32_bf16 a[32:35], v[36:39], v[16:19], a[32:35]
    v_mfma_f32_16x16x32_bf16 a[36:39], v[40:43], v[16:19], a[36:39]
    v_mfma_f32_16x16x32_bf16 a[40:43], v[44:47], v[16:19], a[40:43]
    v_mfma_f32_16x16x32_bf16 a[44:47], v[48:51], v[16:19], a[44:47]
    s_waitcnt vmcnt(14)
    v_mfma_f32_16x16x32_bf16 a[48:51], v[36:39], v[20:23], a[48:51]
    v_mfma_f32_16x16x32_bf16 a[52:55], v[40:43], v[20:23], a[52:55]
    v_mfma_f32_16x16x32_bf16 a[56:59], v[44:47], v[20:23], a[56:59]
    v_mfma_f32_16x16x32_bf16 a[60:63], v[48:51], v[20:23], a[60:63]
    s_waitcnt vmcnt(13)
    v_mfma_f32_16x16x32_bf16 a[64:67], v[36:39], v[24:27], a[64:67]
    v_mfma_f32_16x16x32_bf16 a[68:71], v[40:43], v[24:27], a[68:71]
    v_mfma_f32_16x16x32_bf16 a[72:75], v[44:47], v[24:27], a[72:75]
    v_mfma_f32_16x16x32_bf16 a[76:79], v[48:51], v[24:27], a[76:79]
    s_waitcnt vmcnt(12)
    v_mfma_f32_16x16x32_bf16 a[80:83], v[36:39], v[28:31], a[80:83]
    v_mfma_f32_16x16x32_bf16 a[84:87], v[40:43], v[28:31], a[84:87]
    v_mfma_f32_16x16x32_bf16 a[88:91], v[44:47], v[28:31], a[88:91]
    v_mfma_f32_16x16x32_bf16 a[92:95], v[48:51], v[28:31], a[92:95]
    s_waitcnt vmcnt(11)
    v_mfma_f32_16x16x32_bf16 a[96:99], v[36:39], v[32:35], a[96:99]
    v_mfma_f32_16x16x32_bf16 a[100:103], v[40:43], v[32:35], a[100:103]
    v_mfma_f32_16x16x32_bf16 a[104:107], v[44:47], v[32:35], a[104:107]
    v_mfma_f32_16x16x32_bf16 a[108:111], v[48:51], v[32:35], a[108:111]
    s_waitcnt vmcnt(6)
    v_mfma_f32_16x16x32_bf16 a[0:3], v[80:83], v[52:55], a[0:3]
    v_mfma_f32_16x16x32_bf16 a[4:7], v[84:87], v[52:55], a[4:7]
    v_mfma_f32_16x16x32_bf16 a[8:11], v[88:91], v[52:55], a[8:11]
    v_mfma_f32_16x16x32_bf16 a[12:15], v[92:95], v[52:55], a[12:15]
    s_waitcnt vmcnt(5)
    v_mfma_f32_16x16x32_bf16 a[16:19], v[80:83], v[56:59], a[16:19]
    v_mfma_f32_16x16x32_bf16 a[20:23], v[84:87], v[56:59], a[20:23]
    v_mfma_f32_16x16x32_bf16 a[24:27], v[88:91], v[56:59], a[24:27]
    v_mfma_f32_16x16x32_bf16 a[28:31], v[92:95], v[56:59], a[28:31]
    s_waitcnt vmcnt(4)
    v_mfma_f32_16x16x32_bf16 a[32:35], v[80:83], v[60:63], a[32:35]
    v_mfma_f32_16x16x32_bf16 a[36:39], v[84:87], v[60:63], a[36:39]
    v_mfma_f32_16x16x32_bf16 a[40:43], v[88:91], v[60:63], a[40:43]
    v_mfma_f32_16x16x32_bf16 a[44:47], v[92:95], v[60:63], a[44:47]
    s_waitcnt vmcnt(3)
    v_mfma_f32_16x16x32_bf16 a[48:51], v[80:83], v[64:67], a[48:51]
    v_mfma_f32_16x16x32_bf16 a[52:55], v[84:87], v[64:67], a[52:55]
    v_mfma_f32_16x16x32_bf16 a[56:59], v[88:91], v[64:67], a[56:59]
    v_mfma_f32_16x16x32_bf16 a[60:63], v[92:95], v[64:67], a[60:63]
    s_waitcnt vmcnt(2)
    v_mfma_f32_16x16x32_bf16 a[64:67], v[80:83], v[68:71], a[64:67]
    v_mfma_f32_16x16x32_bf16 a[68:71], v[84:87], v[68:71], a[68:71]
    v_mfma_f32_16x16x32_bf16 a[72:75], v[88:91], v[68:71], a[72:75]
    v_mfma_f32_16x16x32_bf16 a[76:79], v[92:95], v[68:71], a[76:79]
    s_waitcnt vmcnt(1)
    v_mfma_f32_16x16x32_bf16 a[80:83], v[80:83], v[72:75], a[80:83]
    v_mfma_f32_16x16x32_bf16 a[84:87], v[84:87], v[72:75], a[84:87]
    v_mfma_f32_16x16x32_bf16 a[88:91], v[88:91], v[72:75], a[88:91]
    v_mfma_f32_16x16x32_bf16 a[92:95], v[92:95], v[72:75], a[92:95]
    s_waitcnt vmcnt(0)
    v_mfma_f32_16x16x32_bf16 a[96:99], v[80:83], v[76:79], a[96:99]
    v_mfma_f32_16x16x32_bf16 a[100:103], v[84:87], v[76:79], a[100:103]
    v_mfma_f32_16x16x32_bf16 a[104:107], v[88:91], v[76:79], a[104:107]
    v_mfma_f32_16x16x32_bf16 a[108:111], v[92:95], v[76:79], a[108:111]
    s_nop 9
    s_mul_i32 s21, s20, 28672
    v_add_u32 v4, s21, v1
    ds_write_b128 v4, a[0:3] offset:0
    ds_write_b128 v4, a[4:7] offset:1024
    ds_write_b128 v4, a[8:11] offset:2048
    ds_write_b128 v4, a[12:15] offset:3072
    ds_write_b128 v4, a[16:19] offset:4096
    ds_write_b128 v4, a[20:23] offset:5120
    ds_write_b128 v4, a[24:27] offset:6144
    ds_write_b128 v4, a[28:31] offset:7168
    ds_write_b128 v4, a[32:35] offset:8192
    ds_write_b128 v4, a[36:39] offset:9216
    ds_write_b128 v4, a[40:43] offset:10240
    ds_write_b128 v4, a[44:47] offset:11264
    ds_write_b128 v4, a[48:51] offset:12288
    ds_write_b128 v4, a[52:55] offset:13312
    ds_write_b128 v4, a[56:59] offset:14336
    ds_write_b128 v4, a[60:63] offset:15360
    ds_write_b128 v4, a[64:67] offset:16384
    ds_write_b128 v4, a[68:71] offset:17408
    ds_write_b128 v4, a[72:75] offset:18432
    ds_write_b128 v4, a[76:79] offset:19456
    ds_write_b128 v4, a[80:83] offset:20480
    ds_write_b128 v4, a[84:87] offset:21504
    ds_write_b128 v4, a[88:91] offset:22528
    ds_write_b128 v4, a[92:95] offset:23552
    ds_write_b128 v4, a[96:99] offset:24576
    ds_write_b128 v4, a[100:103] offset:25600
    ds_write_b128 v4, a[104:107] offset:26624
    ds_write_b128 v4, a[108:111] offset:27648
    s_waitcnt lgkmcnt(0)
    s_barrier
    s_lshl_b32 s21, s20, 10
    v_add_u32 v4, s21, v1
    v_add_u32 v5, 57344, v4
    v_and_b32 v6, 15, v0
    v_lshlrev_b32 v6, 11, v6
    v_bfe_u32 v7, v0, 4, 2
    v_lshl_add_u32 v6, v7, 3, v6
    s_mul_i32 s21, s17, 208
    s_mul_i32 s22, s18, 96
    s_add_u32 s21, s21, s22
    s_lshl_b32 s21, s21, 11
    s_lshl_b32 s22, s16, 10
    s_add_u32 s21, s21, s22
    s_lshl_b32 s22, s19, 7
    s_add_u32 s21, s21, s22
    s_lshl_b32 s22, s20, 5
    s_add_u32 s21, s21, s22
    ds_read_b128 v[8:11], v4 offset:0
    ds_read_b128 v[12:15], v4 offset:28672
    ds_read_b128 v[16:19], v5 offset:0
    ds_read_b128 v[20:23], v5 offset:28672
    ds_read_b128 v[24:27], v4 offset:4096
    ds_read_b128 v[28:31], v4 offset:32768
    ds_read_b128 v[32:35], v5 offset:4096
    ds_read_b128 v[36:39], v5 offset:32768
    ds_read_b128 v[40:43], v4 offset:8192
    ds_read_b128 v[44:47], v4 offset:36864
    ds_read_b128 v[48:51], v5 offset:8192
    ds_read_b128 v[52:55], v5 offset:36864
    s_waitcnt lgkmcnt(8)
    v_add_f32 v8, v8, v12
    v_add_f32 v16, v16, v20
    v_add_f32 v9, v9, v13
    v_add_f32 v17, v17, v21
    v_add_f32 v10, v10, v14
    v_add_f32 v18, v18, v22
    v_add_f32 v11, v11, v15
    v_add_f32 v19, v19, v23
    v_add_f32 v8, v8, v16
    v_add_f32 v9, v9, v17
    v_add_f32 v10, v10, v18
    v_add_f32 v11, v11, v19
    v_cvt_pk_bf16_f32 v8, v8, v9
    v_cvt_pk_bf16_f32 v9, v10, v11
    s_add_u32 s22, s21, 0
    buffer_store_dwordx2 v[8:9], v6, s[12:15], s22 offen
    ds_read_b128 v[56:59], v4 offset:12288
    ds_read_b128 v[60:63], v4 offset:40960
    ds_read_b128 v[64:67], v5 offset:12288
    ds_read_b128 v[68:71], v5 offset:40960
    s_waitcnt lgkmcnt(8)
    v_add_f32 v24, v24, v28
    v_add_f32 v32, v32, v36
    v_add_f32 v25, v25, v29
    v_add_f32 v33, v33, v37
    v_add_f32 v26, v26, v30
    v_add_f32 v34, v34, v38
    v_add_f32 v27, v27, v31
    v_add_f32 v35, v35, v39
    v_add_f32 v24, v24, v32
    v_add_f32 v25, v25, v33
    v_add_f32 v26, v26, v34
    v_add_f32 v27, v27, v35
    v_cvt_pk_bf16_f32 v24, v24, v25
    v_cvt_pk_bf16_f32 v25, v26, v27
    s_add_u32 s22, s21, 32768
    buffer_store_dwordx2 v[24:25], v6, s[12:15], s22 offen
    ds_read_b128 v[72:75], v4 offset:16384
    ds_read_b128 v[76:79], v4 offset:45056
    ds_read_b128 v[80:83], v5 offset:16384
    ds_read_b128 v[84:87], v5 offset:45056
    s_waitcnt lgkmcnt(8)
    v_add_f32 v40, v40, v44
    v_add_f32 v48, v48, v52
    v_add_f32 v41, v41, v45
    v_add_f32 v49, v49, v53
    v_add_f32 v42, v42, v46
    v_add_f32 v50, v50, v54
    v_add_f32 v43, v43, v47
    v_add_f32 v51, v51, v55
    v_add_f32 v40, v40, v48
    v_add_f32 v41, v41, v49
    v_add_f32 v42, v42, v50
    v_add_f32 v43, v43, v51
    v_cvt_pk_bf16_f32 v40, v40, v41
    v_cvt_pk_bf16_f32 v41, v42, v43
    s_add_u32 s22, s21, 65536
    buffer_store_dwordx2 v[40:41], v6, s[12:15], s22 offen
    ds_read_b128 v[88:91], v4 offset:20480
    ds_read_b128 v[92:95], v4 offset:49152
    ds_read_b128 v[96:99], v5 offset:20480
    ds_read_b128 v[100:103], v5 offset:49152
    s_waitcnt lgkmcnt(8)
    v_add_f32 v56, v56, v60
    v_add_f32 v64, v64, v68
    v_add_f32 v57, v57, v61
    v_add_f32 v65, v65, v69
    v_add_f32 v58, v58, v62
    v_add_f32 v66, v66, v70
    v_add_f32 v59, v59, v63
    v_add_f32 v67, v67, v71
    v_add_f32 v56, v56, v64
    v_add_f32 v57, v57, v65
    v_add_f32 v58, v58, v66
    v_add_f32 v59, v59, v67
    v_cvt_pk_bf16_f32 v56, v56, v57
    v_cvt_pk_bf16_f32 v57, v58, v59
    s_add_u32 s22, s21, 98304
    buffer_store_dwordx2 v[56:57], v6, s[12:15], s22 offen
    ds_read_b128 v[104:107], v4 offset:24576
    ds_read_b128 v[108:111], v4 offset:53248
    ds_read_b128 v[112:115], v5 offset:24576
    ds_read_b128 v[116:119], v5 offset:53248
    s_waitcnt lgkmcnt(8)
    v_add_f32 v72, v72, v76
    v_add_f32 v80, v80, v84
    v_add_f32 v73, v73, v77
    v_add_f32 v81, v81, v85
    v_add_f32 v74, v74, v78
    v_add_f32 v82, v82, v86
    v_add_f32 v75, v75, v79
    v_add_f32 v83, v83, v87
    v_add_f32 v72, v72, v80
    v_add_f32 v73, v73, v81
    v_add_f32 v74, v74, v82
    v_add_f32 v75, v75, v83
    v_cvt_pk_bf16_f32 v72, v72, v73
    v_cvt_pk_bf16_f32 v73, v74, v75
    s_add_u32 s22, s21, 131072
    buffer_store_dwordx2 v[72:73], v6, s[12:15], s22 offen
    s_waitcnt lgkmcnt(4)
    v_add_f32 v88, v88, v92
    v_add_f32 v96, v96, v100
    v_add_f32 v89, v89, v93
    v_add_f32 v97, v97, v101
    v_add_f32 v90, v90, v94
    v_add_f32 v98, v98, v102
    v_add_f32 v91, v91, v95
    v_add_f32 v99, v99, v103
    v_add_f32 v88, v88, v96
    v_add_f32 v89, v89, v97
    v_add_f32 v90, v90, v98
    v_add_f32 v91, v91, v99
    v_cvt_pk_bf16_f32 v88, v88, v89
    v_cvt_pk_bf16_f32 v89, v90, v91
    s_add_u32 s22, s21, 163840
    buffer_store_dwordx2 v[88:89], v6, s[12:15], s22 offen
    s_waitcnt lgkmcnt(0)
    v_add_f32 v104, v104, v108
    v_add_f32 v112, v112, v116
    v_add_f32 v105, v105, v109
    v_add_f32 v113, v113, v117
    v_add_f32 v106, v106, v110
    v_add_f32 v114, v114, v118
    v_add_f32 v107, v107, v111
    v_add_f32 v115, v115, v119
    v_add_f32 v104, v104, v112
    v_add_f32 v105, v105, v113
    v_add_f32 v106, v106, v114
    v_add_f32 v107, v107, v115
    v_cvt_pk_bf16_f32 v104, v104, v105
    v_cvt_pk_bf16_f32 v105, v106, v107
    s_add_u32 s22, s21, 196608
    buffer_store_dwordx2 v[104:105], v6, s[12:15], s22 offen
L_op_end:
    s_endpgm
.section .rodata,"a"
.p2align 6
.amdhsa_kernel attn_kernel
  .amdhsa_next_free_vgpr 256
  .amdhsa_next_free_sgpr 102
  .amdhsa_accum_offset 80
  .amdhsa_group_segment_fixed_size 0
  .amdhsa_kernarg_size 104
  .amdhsa_user_sgpr_count 2
  .amdhsa_user_sgpr_kernarg_segment_ptr 1
  .amdhsa_system_sgpr_workgroup_id_x 1
.end_amdhsa_kernel
.p2align 6
.amdhsa_kernel oproj_kernel
  .amdhsa_next_free_vgpr 340
  .amdhsa_next_free_sgpr 64
  .amdhsa_accum_offset 228
  .amdhsa_group_segment_fixed_size 0
  .amdhsa_kernarg_size 104
  .amdhsa_user_sgpr_count 2
  .amdhsa_user_sgpr_kernarg_segment_ptr 1
  .amdhsa_system_sgpr_workgroup_id_x 1
.end_amdhsa_kernel
```
